```python
import torch

def _softmax(x, axis=-1):
    return torch.softmax(x, dim=axis)

def _gelu(x):
    return torch.nn.functional.gelu(x, approximate='tanh')

def _silu(x):
    return torch.nn.functional.silu(x)

def _sigmoid(x):
    return torch.sigmoid(x)

def _layernorm(x, axis=-1, eps=1e-05):
    m = x.mean(dim=axis, keepdim=True)
    v = x.var(dim=axis, keepdim=True, unbiased=False)
    return (x - m) / torch.sqrt(v + eps)

def _scatter_add(tgt, idx, src, axis=0):
    return tgt.clone().index_add_(axis, idx, src)

def _segment_sum(src, seg, n):
    out = torch.zeros((n,) + src.shape[1:], dtype=src.dtype)
    return out.index_add_(0, seg, src)

def _pad(x, pw):
    flat = tuple((v for pair in reversed(pw) for v in pair))
    return torch.nn.functional.pad(x, flat)
kernel_name = 'adaLN_cond__spectral_gfnet__mixer_channel_mlp__prompt'

def setup_inputs():

    _w = lambda a: (lambda t: t.to(torch.bfloat16) if t.is_floating_point() else t)(torch.as_tensor(a))

    def _A_setup():
        B, S, D = (1, 2048, 640)
        Df = D // 2 + 1
        return {'x': _w((lambda *s: torch.randn(*s, dtype=torch.bfloat16) * 0.05)(B, S, D)), 'w_r': _w((lambda *s: torch.randn(*s, dtype=torch.bfloat16) * 3.2)(S, Df) * 0.02), 'w_i': _w((lambda *s: torch.randn(*s, dtype=torch.bfloat16) * 3.2)(S, Df) * 0.02)}
    _A_in = _A_setup()

    def _B_setup():
        B, S, D, F = (1, 2048, 640, 1536)
        return {'x': _w((lambda *s: torch.randn(*s, dtype=torch.bfloat16) * 0.05)(B, S, D)), 'w1': _w((lambda *s: torch.randn(*s, dtype=torch.bfloat16) * 1.6)(D, F) * D ** (-0.5)), 'b1': _w((lambda *s: torch.randn(*s, dtype=torch.bfloat16) * 0.4)(F)), 'w2': _w((lambda *s: torch.randn(*s, dtype=torch.bfloat16) * 0.1)(F, D) * F ** (-0.5)), 'b2': _w((lambda *s: torch.randn(*s, dtype=torch.bfloat16) * 0.1)(D))}
    _B_in = _B_setup()
    return {'A_x': _A_in['x'], 'A_w_r': _A_in['w_r'], 'A_w_i': _A_in['w_i'], 'B_x': _B_in['x'], 'B_w1': _B_in['w1'], 'B_b1': _B_in['b1'], 'B_w2': _B_in['w2'], 'B_b2': _B_in['b2'], 'c': _w((lambda *s: torch.randn(*s, dtype=torch.bfloat16) * 0.1)(1, 640) * 8.0), 'w_mod': _w((lambda *s: torch.randn(*s, dtype=torch.bfloat16) * 0.1)(640, 6 * 640) * 640 ** (-0.5) * 8.0)}

def reference(A_x, A_w_r, A_w_i, B_x, B_w1, B_b1, B_w2, B_b2, c, w_mod):

    def _A_ref(x, w_r, w_i):
        B, S, D = x.shape
        X = (lambda x, axes=(-2, -1): torch.fft.rfft2(x.float(), dim=axes))(x, axes=(-2, -1))
        W = w_r + 1j * w_i
        X = X * W
        y = (lambda x, s, axes=(-2, -1): torch.fft.irfft2(x, s=s, dim=axes).to(torch.bfloat16))(X, (S, D), axes=(-2, -1))
        return y

    def _B_ref(x, w1, b1, w2, b2):
        y = _layernorm(x, axis=-1)
        h = _gelu(torch.einsum('bsd,df->bsf', y, w1) + b1)
        return torch.einsum('bsf,fd->bsd', h, w2) + b2
    x = A_x
    mod = (_silu(c) @ w_mod).reshape(c.shape[0], 6, 1, -1)
    sa, ca, ga, sb, cb, gb = (mod[:, 0].clone(), mod[:, 1].clone(), mod[:, 2].clone(), mod[:, 3].clone(), mod[:, 4].clone(), mod[:, 5].clone())
    h = _layernorm(x, axis=-1) * (1 + ca) + sa
    x = x + ga * _A_ref(h, A_w_r, A_w_i)
    h = _layernorm(x, axis=-1) * (1 + cb) + sb
    x = x + gb * _B_ref(h, B_w1, B_b1, B_w2, B_b2)
    return x
```

```asm
; @launch grid=(256,1,1) block=(256,1,1) lds=163840
.amdgcn_target "amdgcn-amd-amdhsa--gfx950"
.text
.p2align 12
.fill 832, 4, 0xbf810000
.globl adaLN_cond__spectral_gfnet__mixer_channel_mlp__prompt_kernel
.p2align 8
.type adaLN_cond__spectral_gfnet__mixer_channel_mlp__prompt_kernel,@function
adaLN_cond__spectral_gfnet__mixer_channel_mlp__prompt_kernel:
  s_cmp_ge_u32 s2, 256
  s_cbranch_scc1 L_end
  s_load_dwordx2 s[8:9], s[0:1], 64
  s_load_dwordx2 s[12:13], s[0:1], 72
  s_load_dwordx2 s[16:17], s[0:1], 0
  s_load_dwordx2 s[20:21], s[0:1], 96
  s_load_dwordx2 s[32:33], s[0:1], 48
  s_load_dwordx2 s[48:49], s[0:1], 8
  s_load_dwordx2 s[50:51], s[0:1], 16
  v_lshrrev_b32 v2, 6, v0
  v_and_b32 v1, 63, v0
  v_readfirstlane_b32 s53, v2
  s_lshr_b32 s73, s2, 3
  s_getpc_b64 s[6:7]
L_pc:
  s_lshl_b32 s61, s73, 7
  v_lshl_add_u32 v3, v0, 12, s61
  v_mov_b32 v97, s7
  v_add_co_u32 v4, vcc, s6, v3
  s_and_b32 s74, s2, 7
  s_mul_i32 s79, s74, 20
  v_addc_co_u32 v5, vcc, 0, v97, vcc
  v_cmp_gt_u32 vcc, (L_tabend-L_pc-4), v3
  s_add_u32 s79, s79, s73
  s_and_saveexec_b64 s[80:81], vcc
  s_cbranch_execz L_nopf
  global_load_dword v176, v[4:5], off
L_nopf:
  s_mov_b64 exec, -1
  s_lshr_b32 s61, s73, 3
  s_lshl2_add_u32 s56, s74, s61
  s_and_b32 s55, s73, 7
  s_lshl3_add_u32 s52, s56, s55
  v_and_b32 v10, 15, v1
  v_lshrrev_b32 v11, 4, v1
  s_and_b32 s62, s79, 3
  s_lshl2_add_u32 s60, s62, s53
  s_mul_i32 s60, s60, 80
  v_lshl_add_u32 v98, v1, 2, s60
  v_lshrrev_b32 v14, 2, v1
  v_and_b32 v15, 3, v1
  v_mul_u32_u24 v99, 7680, v14
  v_cmp_gt_u32 vcc, 32, v1
  v_mov_b32 v16, 2146435072
  v_lshl_add_u32 v99, v15, 4, v99
  v_cndmask_b32 v100, v16, v99, vcc
  s_mul_i32 s60, s60, 3840
  s_lshr_b32 s61, s79, 2
  s_lshl_b32 s61, s61, 6
  s_add_u32 s60, s60, s61
  s_mul_i32 s78, s53, 3072
  s_mov_b32 s10, 1280
  s_mov_b32 s11, 0x20000
  s_mov_b32 s14, 4915200
  s_mov_b32 s15, 0x20000
  s_mov_b32 s18, 2621440
  s_mov_b32 s19, 0x20000
  s_mov_b32 s22, 33554432
  s_mov_b32 s23, 0x20000
  s_mov_b32 s34, 1966080
  s_mov_b32 s35, 0x20000
  v_lshlrev_b32 v8, 2, v1
  s_lshl_b32 s62, s53, 9
  s_add_u32 s62, s62, s52
  s_mul_i32 s75, s62, 1280
  s_add_u32 s76, s75, 327680
  s_add_u32 m0, s78, 20480
  s_waitcnt lgkmcnt(0)
  s_cmp_ge_u32 s73, 20
  s_cbranch_scc1 L_skip_1
  buffer_load_dword v116, v98, s[8:11], 0 offen
  buffer_load_dwordx4 v99, s[12:15], s60 offen offset:0 lds
  s_add_u32 s60, s60, 121856
  buffer_load_dwordx4 v99, s[12:15], s60 offen offset:1024 lds
  s_add_u32 s60, s60, 121856
  buffer_load_dwordx4 v100, s[12:15], s60 offen offset:2048 lds
  s_branch L_crit
L_skip_1:
  s_mul_i32 s60, s74, 10
  s_max_u32 s61, s73, 22
  s_add_u32 s60, s60, s61
  s_sub_u32 s3, s60, 22
  s_mul_i32 s60, s53, 320
  v_lshl_add_u32 v104, v1, 3, s60
  buffer_load_dwordx2 v[104:105], v104, s[8:11], 0 offen
L_crit:
  s_load_dword s54, s[20:21], 0
  s_load_dwordx2 s[28:29], s[0:1], 32
  s_load_dwordx2 s[36:37], s[0:1], 40
  s_load_dwordx2 s[40:41], s[0:1], 56
  s_load_dwordx2 s[44:45], s[0:1], 80
  buffer_load_dword v106, v8, s[16:19], s75 offen offset:0
  buffer_load_dword v107, v8, s[16:19], s75 offen offset:256
  buffer_load_dword v108, v8, s[16:19], s75 offen offset:512
  buffer_load_dword v109, v8, s[16:19], s75 offen offset:768
  buffer_load_dword v110, v8, s[16:19], s75 offen offset:1024
  buffer_load_dword v111, v8, s[16:19], s76 offen offset:0
  buffer_load_dword v112, v8, s[16:19], s76 offen offset:256
  buffer_load_dword v113, v8, s[16:19], s76 offen offset:512
  buffer_load_dword v114, v8, s[16:19], s76 offen offset:768
  buffer_load_dword v115, v8, s[16:19], s76 offen offset:1024
  s_mov_b32 s26, 1314816
  s_mov_b32 s27, 0x20000
  s_mov_b32 s30, 1966080
  s_mov_b32 s31, 0x20000
  s_mov_b32 s38, 3072
  s_mov_b32 s39, 0x20000
  s_mov_b32 s42, 1280
  s_mov_b32 s43, 0x20000
  s_mov_b32 s46, 2621440
  s_mov_b32 s47, 0x20000
  v_lshlrev_b32 v7, 4, v1
  v_lshlrev_b32 v9, 3, v1
  v_and_b32 v12, 31, v1
  v_lshrrev_b32 v13, 5, v1
  s_mov_b32 s57, 0
  s_mov_b32 s58, 0xffff0000
  s_mul_i32 s77, s52, 11264
  s_add_u32 s77, s77, 327680
  s_lshl_b32 s60, s53, 5
  v_add_u32 v98, s60, v12
  v_mov_b32 v18, -1
  v_mov_b32 v19, -1
  v_mov_b32 v20, -1
  v_mov_b32 v21, -1
  s_cmp_ge_u32 s53, 2
  s_cselect_b32 s24, s50, s48
  s_cselect_b32 s25, s51, s49
  s_mul_i32 s60, s53, 6144
  s_add_u32 s61, s60, (L_tab-L_pc)
  v_add_u32 v4, s61, v7
  v_add_co_u32 v96, vcc, s6, v4
  v_lshlrev_b32 v99, 6, v14
  v_lshl_add_u32 v99, v15, 3, v99
  v_addc_co_u32 v97, vcc, 0, v97, vcc
  v_mov_b32 v101, 0
  v_mov_b32 v102, 0
  v_mov_b32 v103, 0
  v_and_b32 v5, 7, v1
  v_mul_u32_u24 v122, 20, v13
  v_bfe_u32 v2, v1, 3, 2
  s_lshl_b32 s60, s53, 2
  v_add3_u32 v122, v122, v2, s60
  v_lshlrev_b32 v3, 4, v5
  v_lshl_add_u32 v122, v122, 9, v3
  v_lshl_add_u32 v124, v12, 5, s60
  v_mul_u32_u24 v4, 2560, v13
  v_add_u32 v124, v124, v4
  v_add_u32 v125, 16, v124
  v_cvt_f32_u32 v127, v13
  s_lshr_b32 s61, s53, 1
  s_mul_i32 s70, s61, 1.0
  s_lshl3_add_u32 s62, s61, s53
  s_lshl_b32 s60, s62, 10
  s_add_u32 s60, s60, 8192
  v_and_b32 v2, 1, v2
  v_lshl_add_u32 v2, v2, 2, v11
  v_lshl_add_u32 v2, v2, 7, s60
  v_add_u32 v123, v2, v3
  s_mul_i32 s61, s61, 2304
  s_lshl_b32 s60, s53, 7
  s_add_u32 s60, s60, s61
  v_lshl_add_u32 v2, v10, 3, s60
  v_and_b32 v3, 1, v11
  v_lshl_add_u32 v2, v3, 2, v2
  v_lshrrev_b32 v4, 1, v4
  v_add_u32 v126, v2, v4
  v_and_b32 v136, 4, v1
  v_bfe_u32 v137, v1, 3, 1
  v_lshl_add_u32 v136, v137, 1, v136
  v_bfe_u32 v137, v1, 1, 1
  v_add_u32 v136, v136, v137
  v_and_b32 v137, 1, v1
  v_lshlrev_b32 v137, 9, v137
  v_lshl_add_u32 v138, v13, 10, s52
  v_mad_u32_u24 v138, v136, v138, v137
  v_lshlrev_b32 v139, 8, v136
  v_and_b32 v140, 2047, v138
  v_cvt_f32_u32 v140, v140
  v_mul_f32 v140, 0x3a000000, v140
  v_sin_f32 v141, v140
  v_cos_f32 v140, v140
  v_add_u32 v138, v138, v139
  v_mul_f32 v141, 0x1f800000, v141
  v_mul_f32 v140, 0x1f800000, v140
  v_cvt_pk_bf16_f32 v128, v140, v141
  v_and_b32 v140, 2047, v138
  v_cvt_f32_u32 v140, v140
  v_mul_f32 v140, 0x3a000000, v140
  v_sin_f32 v141, v140
  v_cos_f32 v140, v140
  v_add_u32 v138, v138, v139
  v_mul_f32 v141, 0x1f800000, v141
  v_mul_f32 v140, 0x1f800000, v140
  v_cvt_pk_bf16_f32 v129, v140, v141
  v_and_b32 v140, 2047, v138
  v_cvt_f32_u32 v140, v140
  v_mul_f32 v140, 0x3a000000, v140
  v_sin_f32 v141, v140
  v_cos_f32 v140, v140
  v_add_u32 v138, v138, v139
  v_mul_f32 v141, 0x1f800000, v141
  v_mul_f32 v140, 0x1f800000, v140
  v_cvt_pk_bf16_f32 v130, v140, v141
  v_and_b32 v140, 2047, v138
  v_cvt_f32_u32 v140, v140
  v_mul_f32 v140, 0x3a000000, v140
  v_sin_f32 v141, v140
  v_cos_f32 v140, v140
  v_add_u32 v138, v138, v139
  v_mul_f32 v141, 0x1f800000, v141
  v_mul_f32 v140, 0x1f800000, v140
  v_cvt_pk_bf16_f32 v131, v140, v141
  s_waitcnt lgkmcnt(0)
  s_mul_i32 s60, s54, 0x9e3779b1
  s_add_u32 s60, s60, 0x7f4a7c15
  s_lshr_b32 s61, s60, 15
  s_xor_b32 s60, s60, s61
  s_mul_i32 s60, s60, 0x85ebca6b
  s_lshr_b32 s61, s60, 13
  s_xor_b32 s60, s60, s61
  s_mov_b32 s65, 0x55555555
  s_or_b32 s60, s60, 16
  s_lshr_b32 s61, s54, 1
  s_and_b32 s61, s61, s65
  s_orn2_b32 s62, s54, s61
  s_and_b32 s62, s62, s65
  s_and_b32 s63, s60, s61
  s_xor_b32 s63, s63, s62
  s_andn2_b32 s64, s62, s60
  s_xor_b32 s64, s64, s61
  s_lshl1_add_u32 s54, s63, s64
  s_lshl1_add_u32 s61, s61, s62
  s_and_b32 s61, s61, 3
  s_lshr_b32 s62, s54, 2
  s_xor_b32 s62, s62, s54
  s_lshl_b32 s62, s62, 2
  s_cselect_b32 s61, 0, s61
  s_xor_b32 s54, s54, s61
  s_lshr_b32 s61, s54, 1
  s_xor_b32 s62, s61, s54
  s_and_b32 s61, s61, s65
  s_and_b32 s62, s62, s65
  s_lshl1_add_u32 s1, s62, s61
  s_mov_b32 s0, 0x40004000
  v_lshlrev_b32 v2, 3, v15
  v_lshrrev_b32_e64 v2, v2, s54
  v_bfe_u32 v136, v2, 0, 2
  v_bfe_u32 v137, v2, 2, 2
  v_bfe_u32 v138, v2, 4, 2
  v_bfe_u32 v139, v2, 6, 2
  s_cmp_ge_u32 s73, 20
  s_cbranch_scc1 L_far_2
  s_lshl_b32 s60, s53, 8
  v_add_u32 v144, s60, v8
  s_add_u32 s60, s60, 17920
  v_lshl_add_u32 v145, v11, 3, s60
  v_add_u32 v146, s78, v99
  s_lshl_b32 s60, s53, 7
  v_lshl_add_u32 v147, v11, 4, s60
  s_waitcnt vmcnt(10)
  v_lshlrev_b32 v140, 16, v116
  v_and_b32 v141, s58, v116
  v_mul_f32 v142, 0xbfb8aa3b, v140
  v_mul_f32 v143, 0xbfb8aa3b, v141
  v_exp_f32 v142, v142
  v_exp_f32 v143, v143
  v_add_f32 v142, 1.0, v142
  v_add_f32 v143, 1.0, v143
  v_rcp_f32 v142, v142
  v_rcp_f32 v143, v143
  v_mul_f32 v140, v140, v142
  v_mul_f32 v141, v141, v143
  v_cvt_pk_bf16_f32 v140, v140, v141
  ds_write_b32 v144, v140 offset:17920
  ds_read2_b64 v[148:151], v145 offset0:0 offset1:4
  ds_read2_b64 v[152:155], v145 offset0:8 offset1:12
  s_lshl_b32 s60, s79, 7
  s_add_u32 s60, s60, 4096
  v_mov_b32 v166, 0
  v_mov_b32 v167, 0
  v_mov_b32 v170, 0
  v_mov_b32 v171, 0
  s_lshr_b32 s48, s74, 1
  s_lshl_b32 s48, s48, 5
  s_add_u32 s48, s48, s73
  s_mul_i32 s48, s48, 40
  s_and_b32 s49, s74, 1
  s_lshl2_add_u32 s49, s49, s53
  s_add_u32 s48, s48, s49
  s_mul_i32 s48, s48, 384
  v_lshrrev_b32 v121, 3, v1
  v_min_u32 v121, 4, v121
  v_mul_u32_u24 v121, 3072, v121
  v_and_b32 v118, 7, v1
  v_min_u32 v118, 2, v118
  v_lshl_add_u32 v118, v118, 7, v121
  buffer_load_dword v118, v118, s[28:31], s48 offen
  ds_read_b64_tr_b16 v[156:157], v146 offset:20480
  ds_read_b64_tr_b16 v[158:159], v146 offset:21504
  ds_read_b64_tr_b16 v[164:165], v146 offset:22528
  ds_read_b64_tr_b16 v[160:161], v146 offset:20512
  ds_read_b64_tr_b16 v[162:163], v146 offset:21536
  ds_read_b64_tr_b16 v[168:169], v146 offset:22560
  s_waitcnt lgkmcnt(4)
  v_mfma_f32_16x16x32_bf16 v[178:181], v[156:159], v[148:151], 0
  s_waitcnt lgkmcnt(3)
  v_mfma_f32_16x16x32_bf16 v[178:181], v[164:167], v[152:155], v[178:181]
  s_waitcnt lgkmcnt(1)
  v_mfma_f32_16x16x32_bf16 v[182:185], v[160:163], v[148:151], 0
  s_waitcnt lgkmcnt(0)
  v_mfma_f32_16x16x32_bf16 v[182:185], v[168:171], v[152:155], v[182:185]
  s_mov_b32 exec_lo, 0x10001
  s_mov_b32 exec_hi, 0x10001
  s_nop 1
  ds_write_b128 v147, v[178:181] offset:19200
  s_nop 2
  ds_write_b128 v147, v[182:185] offset:19264
  s_mov_b64 exec, -1
  s_waitcnt lgkmcnt(0)
  s_barrier
  s_cmp_lg_u32 s53, 3
  s_cbranch_scc1 L_skip_4
  s_mov_b64 exec, 0xff
  ds_read_b128 v[156:159], v7 offset:19200
  ds_read_b128 v[160:163], v7 offset:19328
  ds_read_b128 v[164:167], v7 offset:19456
  ds_read_b128 v[168:171], v7 offset:19584
  s_waitcnt lgkmcnt(2)
  v_pk_add_f32 v[156:157], v[156:157], v[160:161]
  v_pk_add_f32 v[158:159], v[158:159], v[162:163]
  s_waitcnt lgkmcnt(0)
  v_pk_add_f32 v[164:165], v[164:165], v[168:169]
  v_pk_add_f32 v[166:167], v[166:167], v[170:171]
  v_pk_add_f32 v[156:157], v[156:157], v[164:165]
  v_pk_add_f32 v[158:159], v[158:159], v[166:167]
  v_bfi_b32 v156, 3, v136, v156
  v_bfi_b32 v157, 3, v137, v157
  v_bfi_b32 v158, 3, v138, v158
  v_bfi_b32 v159, 3, v139, v159
  buffer_store_dwordx4 v[156:159], v7, s[20:23], s60 offen sc1
  s_mov_b64 exec, -1
  s_nop 1
L_skip_4:
L_back_3:
  s_lshl2_add_u32 s71, s55, s53
  s_mul_i32 s71, s71, 96
  v_add_u32 v2, 0, v1
  v_mul_u32_u24 v2, 10923, v2
  v_lshrrev_b32 v3, 16, v2
  v_lshrrev_b32 v4, 4, v3
  v_bfe_u32 v5, v3, 1, 1
  s_lshl2_add_u32 s48, s73, s53
  s_mul_i32 s48, s48, 60
  s_add_u32 s48, s48, s74
  s_mul_i32 s48, s48, 640
  v_lshrrev_b32 v121, 3, v1
  v_min_u32 v121, 4, v121
  v_mul_u32_u24 v121, 7680, v121
  v_and_b32 v119, 7, v1
  v_min_u32 v119, 4, v119
  v_lshl_add_u32 v119, v119, 7, v121
  buffer_load_dword v119, v119, s[12:15], s48 offen offset:2560
  v_lshl_add_u32 v4, v4, 1, v5
  v_bfe_u32 v5, v3, 2, 2
  v_lshl_add_u32 v4, v4, 6, v5
  v_and_b32 v5, 1, v3
  v_lshl_add_u32 v4, v4, 1, v5
  v_lshlrev_b32 v4, 5, v4
  s_mul_i32 s48, s53, 6144
  s_add_u32 m0, s48, 77824
  s_nop 0
  global_load_lds_dwordx4 v[96:97], off offset:0
  v_sub_u32 v4, v4, v3
  v_mul_u32_u24 v4, 96, v4
  v_add_u32 v22, v4, v7
  v_add_u32 v2, 64, v1
  v_mul_u32_u24 v2, 10923, v2
  v_lshrrev_b32 v3, 16, v2
  global_load_lds_dwordx4 v[96:97], off offset:1024
  v_lshrrev_b32 v4, 4, v3
  v_bfe_u32 v5, v3, 1, 1
  v_lshl_add_u32 v4, v4, 1, v5
  v_bfe_u32 v5, v3, 2, 2
  v_lshl_add_u32 v4, v4, 6, v5
  v_and_b32 v5, 1, v3
  v_lshl_add_u32 v4, v4, 1, v5
  global_load_lds_dwordx4 v[96:97], off offset:2048
  v_lshlrev_b32 v4, 5, v4
  v_sub_u32 v4, v4, v3
  v_mul_u32_u24 v4, 96, v4
  v_add_u32 v23, v4, v7
  v_add_u32 v2, 128, v1
  v_mul_u32_u24 v2, 10923, v2
  global_load_lds_dwordx4 v[96:97], off offset:3072
  v_lshrrev_b32 v3, 16, v2
  v_lshrrev_b32 v4, 4, v3
  v_bfe_u32 v5, v3, 1, 1
  v_lshl_add_u32 v4, v4, 1, v5
  v_bfe_u32 v5, v3, 2, 2
  v_lshl_add_u32 v4, v4, 6, v5
  v_add_co_u32 v96, vcc, 4096, v96
  s_mul_i32 s48, s53, 6144
  s_add_u32 m0, s48, 81920
  v_addc_co_u32 v97, vcc, 0, v97, vcc
  global_load_lds_dwordx4 v[96:97], off offset:0
  v_and_b32 v5, 1, v3
  v_lshl_add_u32 v4, v4, 1, v5
  v_lshlrev_b32 v4, 5, v4
  v_sub_u32 v4, v4, v3
  v_mul_u32_u24 v4, 96, v4
  v_add_u32 v24, v4, v7
  global_load_lds_dwordx4 v[96:97], off offset:1024
  v_mov_b32 v143, 0
  v_mov_b32 v147, 0
  v_mov_b32 v151, 0
  v_mov_b32 v155, 0
  v_mul_u32_u24 v2, 6144, v13
  v_cmp_gt_u32 vcc, 84, v98
  v_lshl_add_u32 v2, v98, 2, v2
  v_mov_b32 v3, 336
  v_add_u32 v159, 1008, v2
  v_cndmask_b32 v3, 0, v3, vcc
  v_sub_u32 v158, v159, v3
  v_sub_u32 v157, v158, v3
  v_sub_u32 v156, v157, v3
  v_mul_u32_u24 v100, 5632, v13
  v_cmp_gt_u32 vcc, 88, v98
  v_lshl_add_u32 v100, v98, 4, v100
  v_lshlrev_b32 v2, 3, v15
  v_cndmask_b32 v100, v16, v100, vcc
  v_lshrrev_b32_e64 v2, v2, s54
  v_and_b32 v2, 0xff, v2
  v_lshl_or_b32 v2, v2, 15, v2
  v_lshlrev_b32 v160, 14, v2
  v_and_b32 v160, s0, v160
  v_lshlrev_b32 v161, 12, v2
  v_and_b32 v161, s0, v161
  v_lshlrev_b32 v162, 10, v2
  v_and_b32 v162, s0, v162
  v_lshlrev_b32 v163, 8, v2
  v_and_b32 v163, s0, v163
  s_mul_i32 s60, s74, 642
  s_lshl_b32 s61, s73, 5
  s_min_u32 s61, s61, 610
  s_add_u32 s60, s60, s61
  s_and_b32 s61, s53, 1
  s_mul_i32 s61, s61, 657408
  s_add_u32 s60, s60, s61
  s_mov_b32 s76, s60
  v_cvt_f32_u32 v2, v10
  v_cvt_f32_u32 v3, v11
  v_mul_f32 v5, 0x3b800000, v2
  v_mul_f32 v3, 4.0, v3
  v_mul_f32 v4, v3, v5
  s_add_u32 m0, s78, 114688
  s_add_u32 s48, s71, 0
  buffer_load_dwordx4 v22, s[28:31], s48 offen offset:0 lds
  v_sin_f32 v186, v4
  v_cos_f32 v182, v4
  v_add_f32 v4, v4, v5
  v_sin_f32 v187, v4
  v_cos_f32 v183, v4
  v_add_f32 v4, v4, v5
  v_sin_f32 v188, v4
  v_cos_f32 v184, v4
  v_add_f32 v4, v4, v5
  v_sin_f32 v189, v4
  v_cos_f32 v185, v4
  v_mul_f32 v5, 0x3b4ccccd, v2
  v_mul_f32 v4, v3, v5
  v_sin_f32 v168, v4
  v_cos_f32 v164, v4
  v_add_f32 v4, v4, v5
  v_sin_f32 v169, v4
  v_cos_f32 v165, v4
  v_add_f32 v4, v4, v5
  v_sin_f32 v170, v4
  v_cos_f32 v166, v4
  v_add_f32 v4, v4, v5
  v_sin_f32 v171, v4
  v_cos_f32 v167, v4
  v_mul_f32 v4, v3, v5
  v_fmac_f32 v4, 0.5, v5
  v_sin_f32 v178, v4
  v_cos_f32 v172, v4
  v_add_f32 v4, v4, v5
  v_sin_f32 v179, v4
  v_cos_f32 v173, v4
  v_add_f32 v4, v4, v5
  v_sin_f32 v180, v4
  v_cos_f32 v174, v4
  buffer_load_dwordx4 v23, s[28:31], s48 offen offset:1024 lds
  v_add_f32 v4, v4, v5
  v_sin_f32 v181, v4
  v_cos_f32 v175, v4
  v_mul_f32 v4, v3, v5
  v_sin_f32 v34, v4
  v_cos_f32 v30, v4
  v_add_f32 v4, v4, v5
  v_sin_f32 v35, v4
  v_cos_f32 v31, v4
  v_add_f32 v4, v4, v5
  v_sin_f32 v36, v4
  v_cos_f32 v32, v4
  v_add_f32 v4, v4, v5
  v_sin_f32 v37, v4
  v_cos_f32 v33, v4
  v_add_f32 v5, 0x3acccccd, v5
  v_mul_f32 v4, v3, v5
  v_sin_f32 v42, v4
  v_cos_f32 v38, v4
  v_add_f32 v4, v4, v5
  v_sin_f32 v43, v4
  v_cos_f32 v39, v4
  v_add_f32 v4, v4, v5
  v_sin_f32 v44, v4
  v_cos_f32 v40, v4
  v_add_f32 v4, v4, v5
  v_sin_f32 v45, v4
  v_cos_f32 v41, v4
  v_add_f32 v4, 0x3f800000, v3
  v_sub_f32 v5, 0x41300000, v3
  v_min_f32 v4, v4, v5
  v_med3_f32 v4, v4, 0, 2.0
  v_mul_f32 v4, 0x354ccccd, v4
  v_mul_f32 v30, v4, v30
  v_mul_f32 v34, v4, v34
  buffer_load_dwordx4 v24, s[28:31], s48 offen offset:2048 lds
  v_mul_f32 v38, v4, v38
  v_mul_f32 v42, v4, v42
  v_add_f32 v4, 0x40000000, v3
  v_sub_f32 v5, 0x41200000, v3
  v_min_f32 v4, v4, v5
  v_med3_f32 v4, v4, 0, 2.0
  v_mul_f32 v4, 0x354ccccd, v4
  v_mul_f32 v31, v4, v31
  v_mul_f32 v35, v4, v35
  v_mul_f32 v39, v4, v39
  v_mul_f32 v43, v4, v43
  v_add_f32 v4, 0x40400000, v3
  v_sub_f32 v5, 0x41100000, v3
  v_min_f32 v4, v4, v5
  v_med3_f32 v4, v4, 0, 2.0
  v_mul_f32 v4, 0x354ccccd, v4
  v_mul_f32 v32, v4, v32
  v_mul_f32 v36, v4, v36
  v_mul_f32 v40, v4, v40
  v_mul_f32 v44, v4, v44
  v_add_f32 v4, 0x40800000, v3
  v_sub_f32 v5, 0x41000000, v3
  v_min_f32 v4, v4, v5
  v_med3_f32 v4, v4, 0, 2.0
  v_mul_f32 v4, 0x354ccccd, v4
  v_mul_f32 v33, v4, v33
  v_mul_f32 v37, v4, v37
  v_mul_f32 v41, v4, v41
  v_mul_f32 v45, v4, v45
  s_waitcnt vmcnt(19)
  v_lshlrev_b32 v46, 16, v106
  v_and_b32 v50, s58, v106
  s_waitcnt vmcnt(18)
  v_lshlrev_b32 v47, 16, v107
  v_and_b32 v51, s58, v107
  s_waitcnt vmcnt(17)
  v_lshlrev_b32 v48, 16, v108
  s_add_u32 m0, s78, 126976
  s_add_u32 s48, s71, 24576
  buffer_load_dwordx4 v22, s[28:31], s48 offen offset:0 lds
  v_and_b32 v52, s58, v108
  s_waitcnt vmcnt(17)
  v_lshlrev_b32 v49, 16, v109
  v_and_b32 v53, s58, v109
  s_waitcnt vmcnt(16)
  v_lshlrev_b32 v54, 16, v110
  v_and_b32 v55, s58, v110
  s_waitcnt vmcnt(15)
  v_lshlrev_b32 v56, 16, v111
  v_and_b32 v60, s58, v111
  s_waitcnt vmcnt(14)
  v_lshlrev_b32 v57, 16, v112
  v_and_b32 v61, s58, v112
  s_waitcnt vmcnt(13)
  v_lshlrev_b32 v58, 16, v113
  v_and_b32 v62, s58, v113
  s_waitcnt vmcnt(12)
  v_lshlrev_b32 v59, 16, v114
  v_and_b32 v63, s58, v114
  s_waitcnt vmcnt(11)
  v_lshlrev_b32 v64, 16, v115
  v_and_b32 v65, s58, v115
  v_pk_add_f32 v[190:191], v[46:47], v[48:49]
  v_pk_mul_f32 v[194:195], v[46:47], v[46:47]
  v_pk_add_f32 v[192:193], v[56:57], v[58:59]
  v_pk_mul_f32 v[196:197], v[56:57], v[56:57]
  v_pk_fma_f32 v[194:195], v[48:49], v[48:49], v[194:195]
  v_pk_fma_f32 v[196:197], v[58:59], v[58:59], v[196:197]
  v_pk_add_f32 v[190:191], v[190:191], v[50:51]
  v_pk_fma_f32 v[194:195], v[50:51], v[50:51], v[194:195]
  v_pk_add_f32 v[192:193], v[192:193], v[60:61]
  v_pk_fma_f32 v[196:197], v[60:61], v[60:61], v[196:197]
  v_pk_add_f32 v[190:191], v[190:191], v[52:53]
  v_pk_fma_f32 v[194:195], v[52:53], v[52:53], v[194:195]
  v_pk_add_f32 v[192:193], v[192:193], v[62:63]
  v_pk_fma_f32 v[196:197], v[62:63], v[62:63], v[196:197]
  v_pk_add_f32 v[190:191], v[190:191], v[54:55]
  v_pk_fma_f32 v[194:195], v[54:55], v[54:55], v[194:195]
  v_pk_add_f32 v[192:193], v[192:193], v[64:65]
  v_pk_fma_f32 v[196:197], v[64:65], v[64:65], v[196:197]
  v_add_f32 v190, v190, v191
  v_add_f32 v192, v192, v193
  buffer_load_dwordx4 v23, s[28:31], s48 offen offset:1024 lds
  v_add_f32 v194, v194, v195
  v_add_f32 v196, v196, v197
  v_permlane32_swap_b32 v190, v192
  s_nop 0
  v_permlane32_swap_b32 v194, v196
  v_add_f32 v190, v190, v192
  v_add_f32 v194, v194, v196
  s_nop 1
  v_permlane16_swap_b32 v190, v194
  v_add_f32 v190, v190, v194
  s_nop 1
  v_add_f32_dpp v190, v190, v190 row_ror:8 row_mask:0xf bank_mask:0xf
  s_nop 1
  v_add_f32_dpp v190, v190, v190 row_ror:4 row_mask:0xf bank_mask:0xf
  s_nop 1
  v_add_f32_dpp v190, v190, v190 row_ror:2 row_mask:0xf bank_mask:0xf
  s_nop 1
  v_add_f32_dpp v190, v190, v190 row_ror:1 row_mask:0xf bank_mask:0xf
  v_mul_f32 v191, 0x3acccccd, v190
  v_mul_f32 v190, 0x3acccccd, v190
  s_nop 1
  v_permlane16_swap_b32 v190, v191
  v_fma_f32 v191, -v190, v190, v191
  v_max_f32 v191, 0, v191
  v_add_f32 v191, 0x3727c5ac, v191
  v_rsq_f32 v191, v191
  s_nop 0
  v_mul_f32_e64 v190, -v190, v191
  v_readlane_b32 s66, v191, 0
  v_readlane_b32 s68, v191, 32
  v_readlane_b32 s67, v190, 0
  v_readlane_b32 s69, v190, 32
  s_nop 0
  v_pk_fma_f32 v[104:105], v[46:47], s[66:67], s[66:67] op_sel:[0,0,1] op_sel_hi:[1,0,1]
  v_pk_fma_f32 v[190:191], v[56:57], s[68:69], s[68:69] op_sel:[0,0,1] op_sel_hi:[1,0,1]
  v_pk_fma_f32 v[106:107], v[48:49], s[66:67], s[66:67] op_sel:[0,0,1] op_sel_hi:[1,0,1]
  v_pk_fma_f32 v[192:193], v[58:59], s[68:69], s[68:69] op_sel:[0,0,1] op_sel_hi:[1,0,1]
  v_pk_fma_f32 v[108:109], v[50:51], s[66:67], s[66:67] op_sel:[0,0,1] op_sel_hi:[1,0,1]
  v_pk_fma_f32 v[194:195], v[60:61], s[68:69], s[68:69] op_sel:[0,0,1] op_sel_hi:[1,0,1]
  v_pk_fma_f32 v[110:111], v[52:53], s[66:67], s[66:67] op_sel:[0,0,1] op_sel_hi:[1,0,1]
  v_pk_fma_f32 v[196:197], v[62:63], s[68:69], s[68:69] op_sel:[0,0,1] op_sel_hi:[1,0,1]
  v_pk_fma_f32 v[112:113], v[54:55], s[66:67], s[66:67] op_sel:[0,0,1] op_sel_hi:[1,0,1]
  v_pk_fma_f32 v[198:199], v[64:65], s[68:69], s[68:69] op_sel:[0,0,1] op_sel_hi:[1,0,1]
  buffer_load_dwordx4 v24, s[28:31], s48 offen offset:2048 lds
  s_mov_b64 exec, 0
  s_cmp_eq_u32 s53, 0
  s_cbranch_scc1 L_pad_pg1
  s_cmp_eq_u32 s53, 1
  s_cbranch_scc1 L_pad_s0r0
  s_cmp_eq_u32 s53, 2
  s_cbranch_scc1 L_pad_pg2
  s_cmp_eq_u32 s53, 3
  s_cbranch_scc1 L_pad_ii
L_wret_5:
  s_mov_b64 exec, -1
  s_waitcnt vmcnt(6)
  s_waitcnt lgkmcnt(0)
  s_barrier
  s_mov_b32 s65, 4096
  buffer_load_dwordx4 v[216:219], v123, s[20:23], s65 offen sc1
  buffer_load_dwordx4 v[200:203], v122, s[20:23], s65 offen offset:0 sc1
  buffer_load_dwordx4 v[204:207], v122, s[20:23], s65 offen offset:128 sc1
  buffer_load_dwordx4 v[208:211], v122, s[20:23], s65 offen offset:256 sc1
  buffer_load_dwordx4 v[212:215], v122, s[20:23], s65 offen offset:384 sc1
  v_add_u32 v114, 77824, v7
  ds_read_b32 v25, v114 offset:12
  ds_read_b128 v[26:29], v114 offset:1024
  ds_read_b128 v[220:223], v114 offset:2048
  ds_read_b128 v[224:227], v114 offset:3072
  ds_read_b128 a[96:99], v114 offset:4096
  ds_read_b128 a[100:103], v114 offset:5120
  ds_read_b128 a[104:107], v114 offset:6144
  ds_read_b128 a[108:111], v114 offset:7168
  ds_read_b128 a[112:115], v114 offset:8192
  ds_read_b128 a[116:119], v114 offset:9216
  ds_read_b128 a[192:195], v114 offset:10240
  ds_read_b128 a[196:199], v114 offset:11264
  ds_read_b128 a[200:203], v114 offset:12288
  ds_read_b128 a[204:207], v114 offset:13312
  ds_read_b128 a[208:211], v114 offset:14336
  ds_read_b128 a[212:215], v114 offset:15360
  ds_read_b128 a[216:219], v114 offset:16384
  s_and_b32 s49, s53, 1
  s_lshl1_add_u32 s49, s73, s49
  s_mul_i32 s49, s49, 20544
  s_mul_i32 s48, s74, 642
  s_add_u32 s48, s48, s49
  s_and_b32 s48, s48, -4
  v_lshrrev_b32 v121, 3, v1
  v_min_u32 v121, 3, v121
  v_mul_u32_u24 v121, 5136, v121
  v_and_b32 v117, 7, v1
  v_min_u32 v117, 5, v117
  v_lshl_add_u32 v117, v117, 7, v121
  buffer_load_dword v117, v117, s[24:27], s48 offen
  ds_read_b128 a[220:223], v114 offset:17408
  ds_read_b128 a[224:227], v114 offset:18432
  ds_read_b128 a[228:231], v114 offset:19456
  ds_read_b128 a[232:235], v114 offset:20480
  ds_read_b128 a[236:239], v114 offset:21504
  ds_read_b128 a[240:243], v114 offset:22528
  s_add_u32 s60, s78, 20480
  s_waitcnt lgkmcnt(15)
  v_add_u32 v25, s78, v25
L_pad_pg1:
  s_cbranch_execz L_wret_5
  v_add_u32 v29, s76, v29
  v_add_u32 v220, s60, v220
  v_add_u32 v228, 1536, v220
  v_add_u32 v221, s60, v221
  v_add_u32 v229, 1536, v221
  v_add_u32 v222, s60, v222
  v_add_u32 v230, 1536, v222
  v_add_u32 v223, s60, v223
  v_add_u32 v231, 1536, v223
  s_mul_i32 s49, s53, 96
  s_add_u32 m0, s49, 19712
  s_lshl2_add_u32 s49, s55, s53
  s_mul_i32 s49, s49, 96
  s_mov_b64 exec, 0xffffff
  buffer_load_dword v8, s[36:39], s49 offen lds
  s_and_b32 s49, s53, 1
  s_cselect_b32 exec_lo, 0xff, -1
  s_cselect_b32 s48, 5, 7
  s_lshl_b32 s48, s55, s48
  s_lshl_b32 s49, s49, 7
  s_add_u32 m0, s49, 20096
  s_lshl3_add_u32 s49, s49, s48
  buffer_load_dword v8, s[40:43], s49 offen lds
  s_mov_b64 exec, -1
  s_lshl_b32 s48, s74, 5
  s_add_u32 s48, s48, s73
  s_lshl2_add_u32 s48, s48, s53
  s_mul_i32 s48, s48, 1920
  v_min_u32 v120, 14, v1
  v_lshlrev_b32 v120, 7, v120
  buffer_load_dword v120, v120, s[32:35], s48 offen
  s_waitcnt vmcnt(7)
  v_xor_b32 v200, v136, v200
  v_xor_b32 v201, v137, v201
  v_xor_b32 v202, v138, v202
  v_xor_b32 v203, v139, v203
  s_waitcnt vmcnt(6)
  v_xor_b32 v204, v136, v204
  v_xor_b32 v205, v137, v205
  v_xor_b32 v206, v138, v206
  v_xor_b32 v207, v139, v207
  s_waitcnt vmcnt(5)
  v_xor_b32 v208, v136, v208
  v_xor_b32 v209, v137, v209
  v_xor_b32 v210, v138, v210
  v_xor_b32 v211, v139, v211
  s_waitcnt vmcnt(4)
  v_xor_b32 v212, v136, v212
  v_xor_b32 v213, v137, v213
  v_xor_b32 v214, v138, v214
  v_xor_b32 v215, v139, v215
  v_xor_b32 v216, v136, v216
  v_xor_b32 v217, v137, v217
  v_xor_b32 v218, v138, v218
  v_xor_b32 v219, v139, v219
  v_or3_b32 v6, v200, v201, v202
  v_or3_b32 v6, v6, v203, v204
  v_or3_b32 v6, v6, v205, v206
  v_or3_b32 v6, v6, v207, v208
  v_or3_b32 v6, v6, v209, v210
  v_or3_b32 v6, v6, v211, v212
  v_or3_b32 v6, v6, v213, v214
  v_or3_b32 v6, v6, v215, v216
  v_or3_b32 v6, v6, v217, v218
  v_bitop3_b32 v6, v6, v219, 3 bitop3:0xa8
  v_cmp_ne_u32 vcc, 0, v6
  s_cbranch_vccnz L_slow_6
L_ok_7:
  v_permlane32_swap_b32 v216, v217
  v_permlane32_swap_b32 v218, v219
  v_add_f32 v216, v216, v217
  v_add_f32 v218, v218, v219
  v_pk_add_f32 v[200:201], v[200:201], v[204:205]
  v_pk_add_f32 v[208:209], v[208:209], v[212:213]
  v_pk_add_f32 v[202:203], v[202:203], v[206:207]
  v_pk_add_f32 v[210:211], v[210:211], v[214:215]
  v_pk_add_f32 v[200:201], v[200:201], v[208:209]
  v_permlane16_swap_b32 v216, v218
  v_pk_add_f32 v[202:203], v[202:203], v[210:211]
  v_cvt_pk_bf16_f32 v200, 0, v200
  v_cvt_pk_bf16_f32 v201, 0, v201
  v_add_f32 v216, v216, v218
  v_cvt_pk_bf16_f32 v202, 0, v202
  v_cvt_pk_bf16_f32 v203, 0, v203
  v_add_f32 v200, v127, v200
  v_add_f32 v201, v127, v201
  v_cvt_pk_bf16_f32 v216, 0, v216
  v_add_f32 v202, v127, v202
  v_add_f32 v203, v127, v203
  ds_write2st64_b32 v124, v200, v201 offset0:0 offset1:5
  ds_write2st64_b32 v125, v202, v203 offset0:0 offset1:5
  v_add_f32 v216, s70, v216
  ds_write_b32 v126, v216 offset:1024
  s_waitcnt lgkmcnt(0)
  s_barrier
  s_cmp_ge_u32 s73, 21
  s_cbranch_scc1 L_far_9
  ds_read_b128 v[210:213], v7 offset:2560
  ds_read_b128 v[214:217], v7 offset:3840
  ds_read2st64_b32 v[218:219], v8 offset0:14 offset1:19
  ds_read_b128 v[200:203], v7 offset:0
  ds_read_b128 v[204:207], v7 offset:1280
  ds_read2st64_b32 v[208:209], v8 offset0:4 offset1:9
  s_lshl_b32 s49, s53, 12
  s_add_u32 m0, s49, 49152
  s_mov_b32 s49, 0
  buffer_load_dwordx4 v29, s[24:27], s49 offen lds
  s_waitcnt lgkmcnt(2)
  v_pk_fma_f32 v[104:105], v[104:105], v[210:211], v[200:201]
  v_pk_fma_f32 v[106:107], v[106:107], v[212:213], v[202:203]
  s_waitcnt lgkmcnt(1)
  v_pk_fma_f32 v[108:109], v[108:109], v[214:215], v[204:205]
  v_pk_fma_f32 v[110:111], v[110:111], v[216:217], v[206:207]
  s_waitcnt lgkmcnt(0)
  v_pk_fma_f32 v[112:113], v[112:113], v[218:219], v[208:209]
  v_pk_fma_f32 v[190:191], v[190:191], v[210:211], v[200:201]
  v_pk_fma_f32 v[192:193], v[192:193], v[212:213], v[202:203]
  v_pk_fma_f32 v[194:195], v[194:195], v[214:215], v[204:205]
  v_pk_fma_f32 v[196:197], v[196:197], v[216:217], v[206:207]
  v_pk_fma_f32 v[198:199], v[198:199], v[218:219], v[208:209]
  v_cvt_pk_bf16_f32 v140, v104, v105
  v_cvt_pk_bf16_f32 v141, v106, v107
  v_cvt_pk_bf16_f32 v142, v112, v112
  v_cvt_pk_bf16_f32 v144, v108, v109
  v_cvt_pk_bf16_f32 v145, v110, v111
  v_mfma_f32_16x16x32_bf16 v[200:203], v[140:143], a[96:99], 0
  v_cvt_pk_bf16_f32 v146, v113, v113
  v_cvt_pk_bf16_f32 v148, v190, v191
  v_mfma_f32_16x16x32_bf16 v[204:207], v[140:143], a[100:103], 0
  v_cvt_pk_bf16_f32 v149, v192, v193
  v_cvt_pk_bf16_f32 v150, v198, v198
  v_mfma_f32_16x16x32_bf16 v[208:211], v[144:147], a[96:99], 0
  v_cvt_pk_bf16_f32 v152, v194, v195
  v_cvt_pk_bf16_f32 v153, v196, v197
  v_mfma_f32_16x16x32_bf16 v[212:215], v[144:147], a[100:103], 0
  v_cvt_pk_bf16_f32 v154, v199, v199
  v_mfma_f32_16x16x32_bf16 v[232:235], v[148:151], a[96:99], 0
  v_mfma_f32_16x16x32_bf16 v[236:239], v[148:151], a[100:103], 0
  v_mfma_f32_16x16x32_bf16 v[240:243], v[152:155], a[96:99], 0
  v_mfma_f32_16x16x32_bf16 v[244:247], v[152:155], a[100:103], 0
  s_lshl_b32 s49, s53, 12
  s_add_u32 m0, s49, 50176
  s_mov_b32 s49, 164352
  buffer_load_dwordx4 v29, s[24:27], s49 offen lds
  v_pk_mul_f32 v[104:105], v[204:205], v[168:169]
  v_pk_mul_f32 v[108:109], v[200:201], v[168:169]
  v_pk_mul_f32 v[106:107], v[206:207], v[170:171]
  v_pk_mul_f32 v[110:111], v[202:203], v[170:171]
  v_pk_fma_f32 v[104:105], v[200:201], v[164:165], v[104:105]
  v_pk_fma_f32 v[108:109], v[204:205], v[164:165], v[108:109] neg_lo:[0,0,1] neg_hi:[0,0,1]
  v_pk_fma_f32 v[106:107], v[202:203], v[166:167], v[106:107]
  v_pk_fma_f32 v[110:111], v[206:207], v[166:167], v[110:111] neg_lo:[0,0,1] neg_hi:[0,0,1]
  v_pk_mul_f32 v[248:249], v[212:213], v[178:179]
  v_pk_mul_f32 v[252:253], v[208:209], v[178:179]
  v_pk_mul_f32 v[250:251], v[214:215], v[180:181]
  v_pk_mul_f32 v[254:255], v[210:211], v[180:181]
  v_pk_fma_f32 v[248:249], v[208:209], v[172:173], v[248:249]
  v_pk_fma_f32 v[252:253], v[212:213], v[172:173], v[252:253] neg_lo:[0,0,1] neg_hi:[0,0,1]
  v_pk_fma_f32 v[250:251], v[210:211], v[174:175], v[250:251]
  v_pk_fma_f32 v[254:255], v[214:215], v[174:175], v[254:255] neg_lo:[0,0,1] neg_hi:[0,0,1]
  v_pk_mul_f32 v[190:191], v[236:237], v[168:169]
  v_pk_mul_f32 v[194:195], v[232:233], v[168:169]
  v_pk_mul_f32 v[192:193], v[238:239], v[170:171]
  v_pk_mul_f32 v[196:197], v[234:235], v[170:171]
  v_pk_fma_f32 v[190:191], v[232:233], v[164:165], v[190:191]
  v_pk_fma_f32 v[194:195], v[236:237], v[164:165], v[194:195] neg_lo:[0,0,1] neg_hi:[0,0,1]
  v_pk_fma_f32 v[192:193], v[234:235], v[166:167], v[192:193]
  v_pk_fma_f32 v[196:197], v[238:239], v[166:167], v[196:197] neg_lo:[0,0,1] neg_hi:[0,0,1]
  v_pk_mul_f32 v[66:67], v[244:245], v[178:179]
  v_pk_mul_f32 v[70:71], v[240:241], v[178:179]
  v_pk_mul_f32 v[68:69], v[246:247], v[180:181]
  v_pk_mul_f32 v[72:73], v[242:243], v[180:181]
  v_pk_fma_f32 v[66:67], v[240:241], v[172:173], v[66:67]
  v_pk_fma_f32 v[70:71], v[244:245], v[172:173], v[70:71] neg_lo:[0,0,1] neg_hi:[0,0,1]
  v_pk_fma_f32 v[68:69], v[242:243], v[174:175], v[68:69]
  v_pk_fma_f32 v[72:73], v[246:247], v[174:175], v[72:73] neg_lo:[0,0,1] neg_hi:[0,0,1]
  v_cvt_pk_bf16_f32 v140, v104, v108
  v_cvt_pk_bf16_f32 v141, v105, v109
  v_cvt_pk_bf16_f32 v142, v106, v110
  v_cvt_pk_bf16_f32 v143, v107, v111
  v_cvt_pk_bf16_f32 v144, v248, v252
  v_cvt_pk_bf16_f32 v145, v249, v253
  v_mfma_f32_16x16x32_bf16 v[104:107], a[104:107], v[140:143], 0
  v_cvt_pk_bf16_f32 v146, v250, v254
  v_cvt_pk_bf16_f32 v147, v251, v255
  v_mfma_f32_16x16x32_bf16 v[108:111], a[112:115], v[140:143], 0
  v_cvt_pk_bf16_f32 v136, -v248, -v252
  v_cvt_pk_bf16_f32 v137, -v249, -v253
  v_mfma_f32_16x16x32_bf16 v[200:203], a[108:111], v[144:147], v[104:107]
  v_cvt_pk_bf16_f32 v138, -v250, -v254
  v_cvt_pk_bf16_f32 v139, -v251, -v255
  v_mfma_f32_16x16x32_bf16 v[204:207], a[116:119], v[144:147], v[108:111]
  v_cvt_pk_bf16_f32 v148, v190, v194
  v_cvt_pk_bf16_f32 v149, v191, v195
  v_mfma_f32_16x16x32_bf16 v[208:211], a[108:111], v[136:139], v[104:107]
  v_cvt_pk_bf16_f32 v150, v192, v196
  v_cvt_pk_bf16_f32 v151, v193, v197
  v_mfma_f32_16x16x32_bf16 v[212:215], a[116:119], v[136:139], v[108:111]
  v_cvt_pk_bf16_f32 v152, v66, v70
  v_cvt_pk_bf16_f32 v153, v67, v71
  v_mfma_f32_16x16x32_bf16 v[190:193], a[104:107], v[148:151], 0
  v_cvt_pk_bf16_f32 v154, v68, v72
  v_cvt_pk_bf16_f32 v155, v69, v73
  v_mfma_f32_16x16x32_bf16 v[194:197], a[112:115], v[148:151], 0
  v_cvt_pk_bf16_f32 v112, -v66, -v70
  v_cvt_pk_bf16_f32 v113, -v67, -v71
  v_mfma_f32_16x16x32_bf16 v[232:235], a[108:111], v[152:155], v[190:193]
  v_cvt_pk_bf16_f32 v114, -v68, -v72
  v_cvt_pk_bf16_f32 v115, -v69, -v73
  v_mfma_f32_16x16x32_bf16 v[236:239], a[116:119], v[152:155], v[194:197]
  v_cvt_pk_bf16_f32 v248, v200, v201
  v_cvt_pk_bf16_f32 v249, v202, v203
  v_mfma_f32_16x16x32_bf16 v[240:243], a[108:111], v[112:115], v[190:193]
  v_cvt_pk_bf16_f32 v250, v204, v205
  v_cvt_pk_bf16_f32 v251, v206, v207
  v_mfma_f32_16x16x32_bf16 v[244:247], a[116:119], v[112:115], v[194:197]
  v_cvt_pk_bf16_f32 v252, v208, -v209
  v_cvt_pk_bf16_f32 v253, v210, -v211
  v_cvt_pk_bf16_f32 v254, v212, -v213
  v_cvt_pk_bf16_f32 v255, v214, -v215
  ds_write2_b32 v220, v248, v249 offset0:0 offset1:5
  ds_write2_b32 v220, v250, v251 offset0:40 offset1:45
  ds_write2_b32 v221, v252, v253 offset0:45 offset1:40
  ds_write2_b32 v221, v254, v255 offset0:5 offset1:0
  v_cvt_pk_bf16_f32 v66, v232, v233
  v_cvt_pk_bf16_f32 v67, v234, v235
  v_cvt_pk_bf16_f32 v68, v236, v237
  v_cvt_pk_bf16_f32 v69, v238, v239
  v_cvt_pk_bf16_f32 v70, v240, -v241
  v_cvt_pk_bf16_f32 v71, v242, -v243
  v_cvt_pk_bf16_f32 v72, v244, -v245
  v_cvt_pk_bf16_f32 v73, v246, -v247
  ds_write2_b32 v228, v66, v67 offset0:0 offset1:5
  ds_write2_b32 v228, v68, v69 offset0:40 offset1:45
  ds_write2_b32 v229, v70, v71 offset0:45 offset1:40
  ds_write2_b32 v229, v72, v73 offset0:5 offset1:0
  s_waitcnt lgkmcnt(0)
  s_barrier
  s_cmp_eq_u32 s53, 3
  s_cbranch_scc1 L_skip_11
  ds_read2st64_b32 v[136:137], v156 offset0:80 offset1:86
  ds_read2st64_b32 v[138:139], v156 offset0:92 offset1:98
  ds_read2st64_b32 v[122:123], v157 offset0:80 offset1:86
  ds_read2st64_b32 v[124:125], v157 offset0:92 offset1:98
  ds_read2st64_b32 v[164:165], v158 offset0:80 offset1:86
  ds_read2st64_b32 v[166:167], v158 offset0:92 offset1:98
  ds_read2st64_b32 v[168:169], v159 offset0:80 offset1:86
  ds_read2st64_b32 v[170:171], v159 offset0:92 offset1:98
  s_add_u32 s61, s77, 2816
  s_waitcnt lgkmcnt(6)
  v_mfma_f32_32x32x16_bf16 v[232:247], v[128:131], v[136:139], 0
  s_waitcnt lgkmcnt(4)
  v_mfma_f32_32x32x16_bf16 v[190:205], v[128:131], v[122:125], 0
  s_waitcnt lgkmcnt(2)
  s_nop 8
  v_cvt_pk_bf16_f32 v140, v232, v233
  v_bfi_b32 v140, s0, v160, v140
  v_cvt_pk_bf16_f32 v144, v234, v235
  v_mfma_f32_32x32x16_bf16 v[206:221], v[128:131], v[164:167], 0
  v_bfi_b32 v144, s0, v160, v144
  v_cvt_pk_bf16_f32 v148, v236, v237
  v_cvt_pk_bf16_f32 v141, v190, v191
  v_bfi_b32 v141, s0, v161, v141
  v_cvt_pk_bf16_f32 v145, v192, v193
  s_waitcnt lgkmcnt(0)
  v_mfma_f32_32x32x16_bf16 v[66:81], v[128:131], v[168:171], 0
  v_bfi_b32 v145, s0, v161, v145
  v_cvt_pk_bf16_f32 v149, v194, v195
  v_bfi_b32 v148, s0, v160, v148
  s_nop 1
  v_cvt_pk_bf16_f32 v142, v206, v207
  v_bfi_b32 v142, s0, v162, v142
  v_cvt_pk_bf16_f32 v146, v208, v209
  v_bfi_b32 v146, s0, v162, v146
  v_cvt_pk_bf16_f32 v150, v210, v211
  v_cvt_pk_bf16_f32 v152, v238, v239
  v_bfi_b32 v149, s0, v161, v149
  v_cvt_pk_bf16_f32 v143, v66, v67
  v_bfi_b32 v143, s0, v163, v143
  v_cvt_pk_bf16_f32 v147, v68, v69
  v_bfi_b32 v147, s0, v163, v147
  v_cvt_pk_bf16_f32 v151, v70, v71
  buffer_store_dwordx4 v[140:143], v100, s[20:23], s77 offen offset:0 sc1
  buffer_store_dwordx4 v[144:147], v100, s[20:23], s77 offen offset:1408 sc1
  v_cvt_pk_bf16_f32 v153, v196, v197
  v_bfi_b32 v150, s0, v162, v150
  v_cvt_pk_bf16_f32 v154, v212, v213
  v_bfi_b32 v151, s0, v163, v151
  v_cvt_pk_bf16_f32 v155, v72, v73
  v_bfi_b32 v152, s0, v160, v152
  v_bfi_b32 v153, s0, v161, v153
  v_bfi_b32 v154, s0, v162, v154
  v_bfi_b32 v155, s0, v163, v155
  buffer_store_dwordx4 v[148:151], v100, s[20:23], s61 offen offset:0 sc1
  buffer_store_dwordx4 v[152:155], v100, s[20:23], s61 offen offset:1408 sc1
  s_nop 1
L_skip_11:
  s_lshl_b32 s49, s53, 12
  s_add_u32 m0, s49, 51200
  s_mov_b32 s49, 328704
  buffer_load_dwordx4 v29, s[24:27], s49 offen lds
  s_lshl_b32 s49, s53, 12
  s_add_u32 m0, s49, 52224
  s_mov_b32 s49, 493056
  buffer_load_dwordx4 v29, s[24:27], s49 offen lds
  s_mov_b64 exec, 0
  s_cmp_eq_u32 s53, 0
  s_cbranch_scc1 L_pad_s1r
  s_cmp_eq_u32 s53, 1
  s_cbranch_scc1 L_pad_pg3
  s_cmp_eq_u32 s53, 2
  s_cbranch_scc1 L_pad_s2r
  s_cmp_eq_u32 s53, 3
  s_cbranch_scc1 L_pad_m2a
L_wret_12:
  s_mov_b64 exec, -1
  s_mul_i32 s61, s74, 1408
  s_mul_i32 s60, s53, 11264
  s_add_u32 s60, s60, s73
  s_lshl_b32 s60, s60, 6
  s_add_u32 s75, s60, s61
  s_lshl_b32 s60, s53, 12
  v_add_u32 v225, s60, v225
  s_lshl_b32 s60, s53, 4
  v_xor_b32 v226, s60, v226
  s_lshl_b32 s61, s53, 3
  s_cmp_eq_u32 s73, 20
  s_cselect_b32 s60, 30, s61
  v_add_u32 v227, s60, v227
  v_mov_b32 v2, s61
  s_add_u32 m0, s78, 139264
  s_add_u32 s48, s71, 49152
  buffer_load_dwordx4 v22, s[28:31], s48 offen offset:0 lds
  v_lshrrev_b32_e64 v2, v2, s1
  v_and_b32 v2, 0xff, v2
  v_lshl_or_b32 v2, v2, 15, v2
  v_lshlrev_b32 v164, 14, v2
  v_and_b32 v164, s0, v164
  v_lshlrev_b32 v165, 12, v2
  v_and_b32 v165, s0, v165
  v_lshlrev_b32 v166, 10, v2
  v_and_b32 v166, s0, v166
  v_lshlrev_b32 v167, 8, v2
  v_and_b32 v167, s0, v167
  v_and_b32 v168, 4, v1
  buffer_load_dwordx4 v23, s[28:31], s48 offen offset:1024 lds
  v_bfe_u32 v169, v1, 3, 1
  v_lshl_add_u32 v168, v169, 1, v168
  v_bfe_u32 v169, v1, 1, 1
  v_add_u32 v168, v168, v169
  v_and_b32 v169, 1, v1
  v_lshlrev_b32 v169, 9, v169
  v_lshl_add_u32 v171, v168, 8, s52
  v_lshlrev_b32 v170, 2, v13
  v_mul_u32_u24 v170, v170, v171
  v_sub_u32 v170, v170, v169
  v_and_b32 v172, 2047, v170
  buffer_load_dwordx4 v24, s[28:31], s48 offen offset:2048 lds
  v_cvt_f32_u32 v172, v172
  v_mul_f32 v172, 0x3a000000, v172
  v_sin_f32 v173, v172
  v_cos_f32 v172, v172
  v_add_u32 v170, v170, v171
  v_mul_f32 v173, 0x5f800000, v173
  v_mul_f32 v172, 0x5f800000, v172
  v_cvt_pk_bf16_f32 v132, v172, -v173
  v_and_b32 v172, 2047, v170
  v_cvt_f32_u32 v172, v172
  v_mul_f32 v172, 0x3a000000, v172
  v_sin_f32 v173, v172
  s_add_u32 m0, s78, 151552
  s_add_u32 s48, s71, 73728
  buffer_load_dwordx4 v22, s[28:31], s48 offen offset:0 lds
  v_cos_f32 v172, v172
  v_add_u32 v170, v170, v171
  v_mul_f32 v173, 0x5f800000, v173
  v_mul_f32 v172, 0x5f800000, v172
  v_cvt_pk_bf16_f32 v133, v172, -v173
  v_and_b32 v172, 2047, v170
  v_cvt_f32_u32 v172, v172
  v_mul_f32 v172, 0x3a000000, v172
  v_sin_f32 v173, v172
  v_cos_f32 v172, v172
  v_add_u32 v170, v170, v171
  v_mul_f32 v173, 0x5f800000, v173
  buffer_load_dwordx4 v23, s[28:31], s48 offen offset:1024 lds
  v_mul_f32 v172, 0x5f800000, v172
  v_cvt_pk_bf16_f32 v134, v172, -v173
  v_and_b32 v172, 2047, v170
  v_cvt_f32_u32 v172, v172
  v_mul_f32 v172, 0x3a000000, v172
  v_sin_f32 v173, v172
  v_cos_f32 v172, v172
  v_add_u32 v170, v170, v171
  v_mul_f32 v173, 0x5f800000, v173
  v_mul_f32 v172, 0x5f800000, v172
  v_cvt_pk_bf16_f32 v135, v172, -v173
  buffer_load_dwordx4 v24, s[28:31], s48 offen offset:2048 lds
  s_barrier
  s_add_u32 s65, s75, 327680
  buffer_load_dwordx4 v[136:139], v224, s[20:23], s65 offen sc1
  s_add_u32 s65, s75, 507904
  buffer_load_dwordx4 v[140:143], v224, s[20:23], s65 offen sc1
  s_add_u32 s65, s75, 688128
  buffer_load_dwordx4 v[144:147], v224, s[20:23], s65 offen sc1
  s_add_u32 s65, s75, 868352
  buffer_load_dwordx4 v[148:151], v224, s[20:23], s65 offen sc1
  s_waitcnt vmcnt(10)
  s_barrier
  ds_read_b64 v[102:103], v227 offset:49152
  ds_read_b64 v[104:105], v227 offset:49664
  ds_read_b64 v[106:107], v227 offset:50176
  ds_read_b64 v[108:109], v227 offset:50688
  ds_read_b64 v[110:111], v227 offset:57344
  ds_read_b64 v[112:113], v227 offset:57856
  ds_read_b64 v[114:115], v227 offset:58368
  ds_read_b64 v[116:117], v227 offset:58880
  s_waitcnt lgkmcnt(7)
  v_lshlrev_b32 v232, 16, v102
  v_and_b32 v236, s58, v102
  v_lshlrev_b32 v240, 16, v103
  v_and_b32 v244, s58, v103
  s_waitcnt lgkmcnt(6)
  v_lshlrev_b32 v233, 16, v104
  v_and_b32 v237, s58, v104
  v_lshlrev_b32 v241, 16, v105
  v_and_b32 v245, s58, v105
  s_waitcnt lgkmcnt(5)
  v_lshlrev_b32 v234, 16, v106
  v_and_b32 v238, s58, v106
  v_lshlrev_b32 v242, 16, v107
  v_and_b32 v246, s58, v107
  s_waitcnt lgkmcnt(4)
  v_lshlrev_b32 v235, 16, v108
  v_and_b32 v239, s58, v108
  v_lshlrev_b32 v243, 16, v109
  v_and_b32 v247, s58, v109
  s_waitcnt lgkmcnt(3)
  v_lshlrev_b32 v190, 16, v110
  v_and_b32 v194, s58, v110
  v_lshlrev_b32 v198, 16, v111
  v_and_b32 v202, s58, v111
  s_waitcnt lgkmcnt(2)
  v_lshlrev_b32 v191, 16, v112
  v_and_b32 v195, s58, v112
  v_lshlrev_b32 v199, 16, v113
  v_and_b32 v203, s58, v113
  s_waitcnt lgkmcnt(1)
  v_lshlrev_b32 v192, 16, v114
  v_and_b32 v196, s58, v114
  v_lshlrev_b32 v200, 16, v115
  v_and_b32 v204, s58, v115
  s_waitcnt lgkmcnt(0)
  v_lshlrev_b32 v193, 16, v116
  v_and_b32 v197, s58, v116
  v_lshlrev_b32 v201, 16, v117
  v_and_b32 v205, s58, v117
  s_waitcnt vmcnt(4)
  v_add_u32 v6, 114688, v25
  ds_read_b64_tr_b16 a[0:1], v6 offset:0
  ds_read_b64_tr_b16 a[2:3], v6 offset:1536
  ds_read_b64_tr_b16 a[4:5], v6 offset:32
  ds_read_b64_tr_b16 a[6:7], v6 offset:1568
  ds_read_b64_tr_b16 a[8:9], v6 offset:64
  ds_read_b64_tr_b16 a[10:11], v6 offset:1600
  ds_read_b64_tr_b16 a[12:13], v6 offset:12288
  ds_read_b64_tr_b16 a[14:15], v6 offset:13824
  ds_read_b64_tr_b16 a[16:17], v6 offset:12320
  ds_read_b64_tr_b16 a[18:19], v6 offset:13856
  ds_read_b64_tr_b16 a[20:21], v6 offset:12352
  ds_read_b64_tr_b16 a[22:23], v6 offset:13888
  ds_read_b64_tr_b16 a[24:25], v6 offset:24576
  ds_read_b64_tr_b16 a[26:27], v6 offset:26112
  ds_read_b64_tr_b16 a[28:29], v6 offset:24608
  ds_read_b64_tr_b16 a[30:31], v6 offset:26144
  ds_read_b64_tr_b16 a[32:33], v6 offset:24640
  ds_read_b64_tr_b16 a[34:35], v6 offset:26176
  ds_read_b64_tr_b16 a[36:37], v6 offset:36864
  ds_read_b64_tr_b16 a[38:39], v6 offset:38400
  ds_read_b64_tr_b16 a[40:41], v6 offset:36896
  ds_read_b64_tr_b16 a[42:43], v6 offset:38432
  ds_read_b64_tr_b16 a[44:45], v6 offset:36928
  ds_read_b64_tr_b16 a[46:47], v6 offset:38464
  s_waitcnt lgkmcnt(0)
  s_add_u32 m0, s78, 65536
  s_add_u32 s48, s71, 98304
  buffer_load_dwordx4 v22, s[28:31], s48 offen offset:0 lds
  buffer_load_dwordx4 v23, s[28:31], s48 offen offset:1024 lds
  buffer_load_dwordx4 v24, s[28:31], s48 offen offset:2048 lds
  s_waitcnt vmcnt(6)
  v_xor_b32 v102, v160, v136
  v_xor_b32 v106, v161, v137
  v_xor_b32 v110, v162, v138
  v_xor_b32 v114, v163, v139
  s_waitcnt vmcnt(5)
  v_xor_b32 v103, v160, v140
  v_xor_b32 v107, v161, v141
  v_xor_b32 v111, v162, v142
  v_xor_b32 v115, v163, v143
  s_waitcnt vmcnt(4)
  v_xor_b32 v104, v160, v144
  v_xor_b32 v108, v161, v145
  v_xor_b32 v112, v162, v146
  v_xor_b32 v116, v163, v147
  s_waitcnt vmcnt(3)
  v_xor_b32 v105, v160, v148
  v_xor_b32 v109, v161, v149
  v_xor_b32 v113, v162, v150
  v_xor_b32 v117, v163, v151
  v_or3_b32 v6, v102, v106, v110
  v_or3_b32 v6, v6, v114, v103
  v_or3_b32 v6, v6, v107, v111
  v_or3_b32 v6, v6, v115, v104
  v_or3_b32 v6, v6, v108, v112
  v_or3_b32 v6, v6, v116, v105
  v_or3_b32 v6, v6, v109, v113
  v_bitop3_b32 v6, v6, v117, s0 bitop3:0xa8
  v_cmp_ne_u32 vcc, 0, v6
  s_cbranch_vccnz L_slow_13
L_ok_14:
  ds_write_b128 v225, v[102:105] offset:32768
  ds_write_b128 v225, v[106:109] offset:33792
  ds_write_b128 v225, v[110:113] offset:34816
  ds_write_b128 v225, v[114:117] offset:35840
  s_lshl2_add_u32 s49, s52, s53
  s_mul_i32 s49, s49, 6144
  s_add_u32 s49, s49, 5832704
  buffer_store_dwordx4 v[18:21], v7, s[20:23], s49 offen offset:0 sc1
  s_waitcnt lgkmcnt(0)
  s_barrier
  ds_read_b128 v[136:139], v226 offset:32768
  ds_read_b128 v[140:143], v226 offset:33792
  ds_read_b128 v[144:147], v226 offset:34816
  ds_read_b128 v[148:151], v226 offset:35840
  s_add_u32 m0, s78, 77824
  s_add_u32 s48, s71, 122880
  buffer_load_dwordx4 v22, s[28:31], s48 offen offset:0 lds
  buffer_load_dwordx4 v23, s[28:31], s48 offen offset:1024 lds
  s_waitcnt lgkmcnt(3)
  v_mfma_f32_16x16x32_bf16 v[118:121], v[136:139], a[192:195], 0
  buffer_load_dwordx4 v24, s[28:31], s48 offen offset:2048 lds
  v_mfma_f32_16x16x32_bf16 v[122:125], v[136:139], a[196:199], 0
  s_waitcnt lgkmcnt(2)
  v_mfma_f32_16x16x32_bf16 v[168:171], v[140:143], a[192:195], 0
  v_mfma_f32_16x16x32_bf16 v[172:175], v[140:143], a[196:199], 0
  s_waitcnt lgkmcnt(1)
  v_mfma_f32_16x16x32_bf16 v[248:251], v[144:147], a[192:195], 0
  s_add_u32 m0, s78, 90112
  s_add_u32 s48, s71, 147456
  buffer_load_dwordx4 v22, s[28:31], s48 offen offset:0 lds
  v_mfma_f32_16x16x32_bf16 v[252:255], v[144:147], a[196:199], 0
  s_waitcnt lgkmcnt(0)
  v_mfma_f32_16x16x32_bf16 v[206:209], v[148:151], a[192:195], 0
  v_mfma_f32_16x16x32_bf16 v[210:213], v[148:151], a[196:199], 0
  buffer_load_dwordx4 v23, s[28:31], s48 offen offset:1024 lds
  v_pk_mul_f32 v[102:103], v[122:123], v[186:187]
  v_pk_mul_f32 v[106:107], v[118:119], v[186:187]
  v_pk_mul_f32 v[104:105], v[124:125], v[188:189]
  v_pk_mul_f32 v[108:109], v[120:121], v[188:189]
  v_pk_fma_f32 v[102:103], v[118:119], v[182:183], v[102:103]
  v_pk_fma_f32 v[106:107], v[122:123], v[182:183], v[106:107] neg_lo:[0,0,1] neg_hi:[0,0,1]
  v_pk_fma_f32 v[104:105], v[120:121], v[184:185], v[104:105]
  v_pk_fma_f32 v[108:109], v[124:125], v[184:185], v[108:109] neg_lo:[0,0,1] neg_hi:[0,0,1]
  v_pk_mul_f32 v[110:111], v[172:173], v[186:187]
  v_pk_mul_f32 v[114:115], v[168:169], v[186:187]
  v_pk_mul_f32 v[112:113], v[174:175], v[188:189]
  v_pk_mul_f32 v[116:117], v[170:171], v[188:189]
  v_pk_fma_f32 v[110:111], v[168:169], v[182:183], v[110:111]
  v_pk_fma_f32 v[114:115], v[172:173], v[182:183], v[114:115] neg_lo:[0,0,1] neg_hi:[0,0,1]
  v_pk_fma_f32 v[112:113], v[170:171], v[184:185], v[112:113]
  v_pk_fma_f32 v[116:117], v[174:175], v[184:185], v[116:117] neg_lo:[0,0,1] neg_hi:[0,0,1]
  v_pk_mul_f32 v[214:215], v[252:253], v[186:187]
  v_pk_mul_f32 v[218:219], v[248:249], v[186:187]
  v_pk_mul_f32 v[216:217], v[254:255], v[188:189]
  v_pk_mul_f32 v[220:221], v[250:251], v[188:189]
  v_pk_fma_f32 v[214:215], v[248:249], v[182:183], v[214:215]
  v_pk_fma_f32 v[218:219], v[252:253], v[182:183], v[218:219] neg_lo:[0,0,1] neg_hi:[0,0,1]
  buffer_load_dwordx4 v24, s[28:31], s48 offen offset:2048 lds
  v_pk_fma_f32 v[216:217], v[250:251], v[184:185], v[216:217]
  v_pk_fma_f32 v[220:221], v[254:255], v[184:185], v[220:221] neg_lo:[0,0,1] neg_hi:[0,0,1]
  v_pk_mul_f32 v[66:67], v[210:211], v[186:187]
  v_pk_mul_f32 v[70:71], v[206:207], v[186:187]
  v_pk_mul_f32 v[68:69], v[212:213], v[188:189]
  v_pk_mul_f32 v[72:73], v[208:209], v[188:189]
  v_pk_fma_f32 v[66:67], v[206:207], v[182:183], v[66:67]
  v_pk_fma_f32 v[70:71], v[210:211], v[182:183], v[70:71] neg_lo:[0,0,1] neg_hi:[0,0,1]
  v_pk_fma_f32 v[68:69], v[208:209], v[184:185], v[68:69]
  v_pk_fma_f32 v[72:73], v[212:213], v[184:185], v[72:73] neg_lo:[0,0,1] neg_hi:[0,0,1]
  v_cvt_pk_bf16_f32 v136, v102, v106
  v_cvt_pk_bf16_f32 v137, v103, v107
  s_add_u32 m0, s78, 102400
  s_add_u32 s48, s71, 172032
  buffer_load_dwordx4 v22, s[28:31], s48 offen offset:0 lds
  v_cvt_pk_bf16_f32 v138, v104, v108
  v_cvt_pk_bf16_f32 v139, v105, v109
  v_cvt_pk_bf16_f32 v140, v110, v114
  v_cvt_pk_bf16_f32 v141, v111, v115
  v_mfma_f32_16x16x32_bf16 v[118:121], a[192:195], v[136:139], 0
  v_cvt_pk_bf16_f32 v142, v112, v116
  v_cvt_pk_bf16_f32 v143, v113, v117
  v_mfma_f32_16x16x32_bf16 v[122:125], a[196:199], v[136:139], 0
  v_cvt_pk_bf16_f32 v144, v214, v218
  buffer_load_dwordx4 v23, s[28:31], s48 offen offset:1024 lds
  v_cvt_pk_bf16_f32 v145, v215, v219
  v_mfma_f32_16x16x32_bf16 v[168:171], a[192:195], v[140:143], 0
  v_cvt_pk_bf16_f32 v146, v216, v220
  v_cvt_pk_bf16_f32 v147, v217, v221
  v_mfma_f32_16x16x32_bf16 v[172:175], a[196:199], v[140:143], 0
  v_cvt_pk_bf16_f32 v148, v66, v70
  v_cvt_pk_bf16_f32 v149, v67, v71
  v_mfma_f32_16x16x32_bf16 v[248:251], a[192:195], v[144:147], 0
  v_cvt_pk_bf16_f32 v150, v68, v72
  v_cvt_pk_bf16_f32 v151, v69, v73
  buffer_load_dwordx4 v24, s[28:31], s48 offen offset:2048 lds
  v_mfma_f32_16x16x32_bf16 v[252:255], a[196:199], v[144:147], 0
  s_add_u32 m0, s78, 114688
  s_add_u32 s48, s71, 196608
  buffer_load_dwordx4 v22, s[28:31], s48 offen offset:0 lds
  v_mfma_f32_16x16x32_bf16 v[206:209], a[192:195], v[148:151], 0
L_pad_pg2:
  s_cbranch_execz L_wret_5
  v_mfma_f32_16x16x32_bf16 v[210:213], a[196:199], v[148:151], 0
  buffer_load_dwordx4 v23, s[28:31], s48 offen offset:1024 lds
  v_pk_mul_f32 v[102:103], v[122:123], v[190:191]
  v_pk_mul_f32 v[106:107], v[118:119], v[190:191]
  v_pk_mul_f32 v[104:105], v[124:125], v[192:193]
  v_pk_mul_f32 v[108:109], v[120:121], v[192:193]
  v_pk_fma_f32 v[102:103], v[118:119], v[232:233], v[102:103] neg_lo:[0,0,1] neg_hi:[0,0,1]
  v_pk_fma_f32 v[106:107], v[122:123], v[232:233], v[106:107]
  v_pk_fma_f32 v[104:105], v[120:121], v[234:235], v[104:105] neg_lo:[0,0,1] neg_hi:[0,0,1]
  v_pk_fma_f32 v[108:109], v[124:125], v[234:235], v[108:109]
  v_pk_mul_f32 v[110:111], v[172:173], v[194:195]
  v_pk_mul_f32 v[114:115], v[168:169], v[194:195]
  v_pk_mul_f32 v[112:113], v[174:175], v[196:197]
  v_pk_mul_f32 v[116:117], v[170:171], v[196:197]
  v_pk_fma_f32 v[110:111], v[168:169], v[236:237], v[110:111] neg_lo:[0,0,1] neg_hi:[0,0,1]
  v_pk_fma_f32 v[114:115], v[172:173], v[236:237], v[114:115]
  v_pk_fma_f32 v[112:113], v[170:171], v[238:239], v[112:113] neg_lo:[0,0,1] neg_hi:[0,0,1]
  v_pk_fma_f32 v[116:117], v[174:175], v[238:239], v[116:117]
  v_pk_mul_f32 v[214:215], v[252:253], v[198:199]
  v_pk_mul_f32 v[218:219], v[248:249], v[198:199]
  v_pk_mul_f32 v[216:217], v[254:255], v[200:201]
  v_pk_mul_f32 v[220:221], v[250:251], v[200:201]
  v_pk_fma_f32 v[214:215], v[248:249], v[240:241], v[214:215] neg_lo:[0,0,1] neg_hi:[0,0,1]
  v_pk_fma_f32 v[218:219], v[252:253], v[240:241], v[218:219]
  v_pk_fma_f32 v[216:217], v[250:251], v[242:243], v[216:217] neg_lo:[0,0,1] neg_hi:[0,0,1]
  v_pk_fma_f32 v[220:221], v[254:255], v[242:243], v[220:221]
  v_pk_mul_f32 v[66:67], v[210:211], v[202:203]
  buffer_load_dwordx4 v24, s[28:31], s48 offen offset:2048 lds
  v_pk_mul_f32 v[70:71], v[206:207], v[202:203]
  v_pk_mul_f32 v[68:69], v[212:213], v[204:205]
  v_pk_mul_f32 v[72:73], v[208:209], v[204:205]
  v_pk_fma_f32 v[66:67], v[206:207], v[244:245], v[66:67] neg_lo:[0,0,1] neg_hi:[0,0,1]
  v_pk_fma_f32 v[70:71], v[210:211], v[244:245], v[70:71]
  v_pk_fma_f32 v[68:69], v[208:209], v[246:247], v[68:69] neg_lo:[0,0,1] neg_hi:[0,0,1]
  v_pk_fma_f32 v[72:73], v[212:213], v[246:247], v[72:73]
  v_cvt_pk_bf16_f32 v136, v106, v102
  v_cvt_pk_bf16_f32 v137, v107, v103
  v_cvt_pk_bf16_f32 v138, v108, v104
  v_cvt_pk_bf16_f32 v139, v109, v105
  v_cvt_pk_bf16_f32 v140, v114, v110
  v_cvt_pk_bf16_f32 v141, v115, v111
  v_mfma_f32_16x16x32_bf16 v[118:121], v[136:139], a[196:199], 0
  v_cvt_pk_bf16_f32 v142, v116, v112
  v_cvt_pk_bf16_f32 v143, v117, v113
  v_mfma_f32_16x16x32_bf16 v[122:125], v[136:139], a[192:195], 0
  v_cvt_pk_bf16_f32 v144, v218, v214
  v_cvt_pk_bf16_f32 v145, v219, v215
  v_mfma_f32_16x16x32_bf16 v[168:171], v[140:143], a[196:199], 0
  v_cvt_pk_bf16_f32 v146, v220, v216
  v_cvt_pk_bf16_f32 v147, v221, v217
  v_mfma_f32_16x16x32_bf16 v[172:175], v[140:143], a[192:195], 0
  v_cvt_pk_bf16_f32 v148, v70, v66
  v_cvt_pk_bf16_f32 v149, v71, v67
  v_mfma_f32_16x16x32_bf16 v[248:251], v[144:147], a[196:199], 0
  v_cvt_pk_bf16_f32 v150, v72, v68
  v_cvt_pk_bf16_f32 v151, v73, v69
  v_mfma_f32_16x16x32_bf16 v[252:255], v[144:147], a[192:195], 0
  s_nop 0
  v_mfma_f32_16x16x32_bf16 v[206:209], v[148:151], a[196:199], 0
  v_mfma_f32_16x16x32_bf16 v[210:213], v[148:151], a[192:195], 0
  v_pk_mul_f32 v[102:103], v[122:123], v[186:187]
  v_pk_mul_f32 v[106:107], v[118:119], v[186:187]
  v_pk_mul_f32 v[104:105], v[124:125], v[188:189]
  v_pk_mul_f32 v[108:109], v[120:121], v[188:189]
  v_pk_fma_f32 v[102:103], v[118:119], v[182:183], v[102:103] neg_lo:[0,0,1] neg_hi:[0,0,1]
  v_pk_fma_f32 v[106:107], v[122:123], v[182:183], v[106:107]
  v_pk_fma_f32 v[104:105], v[120:121], v[184:185], v[104:105] neg_lo:[0,0,1] neg_hi:[0,0,1]
  v_pk_fma_f32 v[108:109], v[124:125], v[184:185], v[108:109]
  v_pk_mul_f32 v[110:111], v[172:173], v[186:187]
  v_pk_mul_f32 v[114:115], v[168:169], v[186:187]
  v_pk_mul_f32 v[112:113], v[174:175], v[188:189]
  v_pk_mul_f32 v[116:117], v[170:171], v[188:189]
  v_pk_fma_f32 v[110:111], v[168:169], v[182:183], v[110:111] neg_lo:[0,0,1] neg_hi:[0,0,1]
  v_pk_fma_f32 v[114:115], v[172:173], v[182:183], v[114:115]
  v_pk_fma_f32 v[112:113], v[170:171], v[184:185], v[112:113] neg_lo:[0,0,1] neg_hi:[0,0,1]
  v_pk_fma_f32 v[116:117], v[174:175], v[184:185], v[116:117]
  v_pk_mul_f32 v[214:215], v[252:253], v[186:187]
  v_pk_mul_f32 v[218:219], v[248:249], v[186:187]
  v_pk_mul_f32 v[216:217], v[254:255], v[188:189]
  v_pk_mul_f32 v[220:221], v[250:251], v[188:189]
  v_pk_fma_f32 v[214:215], v[248:249], v[182:183], v[214:215] neg_lo:[0,0,1] neg_hi:[0,0,1]
  v_pk_fma_f32 v[218:219], v[252:253], v[182:183], v[218:219]
  v_pk_fma_f32 v[216:217], v[250:251], v[184:185], v[216:217] neg_lo:[0,0,1] neg_hi:[0,0,1]
  v_pk_fma_f32 v[220:221], v[254:255], v[184:185], v[220:221]
  v_pk_mul_f32 v[66:67], v[210:211], v[186:187]
  v_pk_mul_f32 v[70:71], v[206:207], v[186:187]
  v_pk_mul_f32 v[68:69], v[212:213], v[188:189]
  v_pk_mul_f32 v[72:73], v[208:209], v[188:189]
  v_pk_fma_f32 v[66:67], v[206:207], v[182:183], v[66:67] neg_lo:[0,0,1] neg_hi:[0,0,1]
  v_pk_fma_f32 v[70:71], v[210:211], v[182:183], v[70:71]
  v_pk_fma_f32 v[68:69], v[208:209], v[184:185], v[68:69] neg_lo:[0,0,1] neg_hi:[0,0,1]
  v_pk_fma_f32 v[72:73], v[212:213], v[184:185], v[72:73]
  v_cvt_pk_bf16_f32 v136, v106, v102
  v_cvt_pk_bf16_f32 v137, v107, v103
  v_cvt_pk_bf16_f32 v138, v108, v104
  v_cvt_pk_bf16_f32 v139, v109, v105
  v_cvt_pk_bf16_f32 v140, v114, v110
  v_cvt_pk_bf16_f32 v141, v115, v111
  v_mfma_f32_16x16x32_bf16 v[118:121], a[196:199], v[136:139], 0
  v_cvt_pk_bf16_f32 v142, v116, v112
  v_cvt_pk_bf16_f32 v143, v117, v113
  v_mfma_f32_16x16x32_bf16 v[122:125], a[192:195], v[136:139], 0
  v_cvt_pk_bf16_f32 v144, v218, v214
  v_cvt_pk_bf16_f32 v145, v219, v215
  v_mfma_f32_16x16x32_bf16 v[168:171], a[196:199], v[140:143], 0
  v_cvt_pk_bf16_f32 v146, v220, v216
  v_cvt_pk_bf16_f32 v147, v221, v217
  v_mfma_f32_16x16x32_bf16 v[172:175], a[192:195], v[140:143], 0
  v_cvt_pk_bf16_f32 v148, v70, v66
  v_cvt_pk_bf16_f32 v149, v71, v67
  v_mfma_f32_16x16x32_bf16 v[248:251], a[196:199], v[144:147], 0
  v_cvt_pk_bf16_f32 v150, v72, v68
  v_cvt_pk_bf16_f32 v151, v73, v69
  v_mfma_f32_16x16x32_bf16 v[252:255], a[192:195], v[144:147], 0
  v_cvt_pk_bf16_f32 v232, v118, v122
  v_cvt_pk_bf16_f32 v236, v119, v123
  v_mfma_f32_16x16x32_bf16 v[206:209], a[196:199], v[148:151], 0
  v_cvt_pk_bf16_f32 v240, v120, v124
  v_cvt_pk_bf16_f32 v244, v121, v125
  v_mfma_f32_16x16x32_bf16 v[210:213], a[192:195], v[148:151], 0
  v_bfi_b32 v232, s0, v164, v232
  v_bfi_b32 v236, s0, v164, v236
  v_bfi_b32 v240, s0, v164, v240
  v_bfi_b32 v244, s0, v164, v244
  v_cvt_pk_bf16_f32 v233, v168, v172
  v_cvt_pk_bf16_f32 v237, v169, v173
  v_cvt_pk_bf16_f32 v241, v170, v174
  v_cvt_pk_bf16_f32 v245, v171, v175
  v_bfi_b32 v233, s0, v165, v233
  v_bfi_b32 v237, s0, v165, v237
  v_bfi_b32 v241, s0, v165, v241
  v_bfi_b32 v245, s0, v165, v245
  v_cvt_pk_bf16_f32 v234, v248, v252
  v_cvt_pk_bf16_f32 v238, v249, v253
  v_cvt_pk_bf16_f32 v242, v250, v254
  v_cvt_pk_bf16_f32 v246, v251, v255
  v_bfi_b32 v234, s0, v166, v234
  v_bfi_b32 v238, s0, v166, v238
  v_bfi_b32 v242, s0, v166, v242
  v_bfi_b32 v246, s0, v166, v246
  v_cvt_pk_bf16_f32 v235, v206, v210
  v_cvt_pk_bf16_f32 v239, v207, v211
  v_cvt_pk_bf16_f32 v243, v208, v212
  v_cvt_pk_bf16_f32 v247, v209, v213
  v_bfi_b32 v235, s0, v167, v235
  v_bfi_b32 v239, s0, v167, v239
  v_bfi_b32 v243, s0, v167, v243
  v_bfi_b32 v247, s0, v167, v247
  ds_write_b128 v226, v[232:235] offset:49152
  ds_write_b128 v226, v[236:239] offset:50176
  ds_write_b128 v226, v[240:243] offset:51200
  ds_write_b128 v226, v[244:247] offset:52224
  s_waitcnt lgkmcnt(0)
  s_barrier
  ds_read_b128 v[136:139], v225 offset:49152
  ds_read_b128 v[140:143], v225 offset:50176
  ds_read_b128 v[144:147], v225 offset:51200
  ds_read_b128 v[148:151], v225 offset:52224
  s_add_u32 s62, s75, 327680
  s_add_u32 s63, s75, 507904
  s_add_u32 s64, s75, 688128
  s_add_u32 s65, s75, 868352
  s_waitcnt lgkmcnt(3)
  buffer_store_dwordx4 v[136:139], v224, s[20:23], s62 offen sc1
  s_waitcnt lgkmcnt(2)
  buffer_store_dwordx4 v[140:143], v224, s[20:23], s63 offen sc1
  s_waitcnt lgkmcnt(1)
  buffer_store_dwordx4 v[144:147], v224, s[20:23], s64 offen sc1
  s_waitcnt lgkmcnt(0)
  buffer_store_dwordx4 v[148:151], v224, s[20:23], s65 offen sc1
  s_waitcnt vmcnt(4)
  v_add_u32 v6, 65536, v25
  ds_read_b64_tr_b16 a[48:49], v6 offset:0
  ds_read_b64_tr_b16 a[50:51], v6 offset:1536
  ds_read_b64_tr_b16 a[52:53], v6 offset:32
  ds_read_b64_tr_b16 a[54:55], v6 offset:1568
  ds_read_b64_tr_b16 a[56:57], v6 offset:64
  ds_read_b64_tr_b16 a[58:59], v6 offset:1600
  ds_read_b64_tr_b16 a[60:61], v6 offset:12288
  ds_read_b64_tr_b16 a[62:63], v6 offset:13824
  ds_read_b64_tr_b16 a[64:65], v6 offset:12320
  ds_read_b64_tr_b16 a[66:67], v6 offset:13856
  ds_read_b64_tr_b16 a[68:69], v6 offset:12352
  ds_read_b64_tr_b16 a[70:71], v6 offset:13888
  ds_read_b64_tr_b16 a[72:73], v6 offset:24576
  ds_read_b64_tr_b16 a[74:75], v6 offset:26112
  ds_read_b64_tr_b16 a[76:77], v6 offset:24608
  ds_read_b64_tr_b16 a[78:79], v6 offset:26144
  ds_read_b64_tr_b16 a[80:81], v6 offset:24640
  ds_read_b64_tr_b16 a[82:83], v6 offset:26176
  ds_read_b64_tr_b16 a[84:85], v6 offset:36864
  ds_read_b64_tr_b16 a[86:87], v6 offset:38400
  ds_read_b64_tr_b16 a[88:89], v6 offset:36896
  ds_read_b64_tr_b16 a[90:91], v6 offset:38432
  ds_read_b64_tr_b16 a[92:93], v6 offset:36928
  ds_read_b64_tr_b16 a[94:95], v6 offset:38464
  v_add_u32 v6, 114688, v25
  ds_read_b64_tr_b16 a[96:97], v6 offset:0
  ds_read_b64_tr_b16 a[98:99], v6 offset:1536
  ds_read_b64_tr_b16 a[100:101], v6 offset:32
  ds_read_b64_tr_b16 a[102:103], v6 offset:1568
  ds_read_b64_tr_b16 a[104:105], v6 offset:64
  ds_read_b64_tr_b16 a[106:107], v6 offset:1600
  s_waitcnt lgkmcnt(0)
L_back_10:
  s_cmp_eq_u32 s53, 3
  s_cbranch_scc1 L_far_18
L_back_19:
  v_lshlrev_b32 v2, 3, v15
  v_lshrrev_b32_e64 v2, v2, s1
  v_and_b32 v2, 0xff, v2
  s_add_u32 m0, s78, 126976
  s_add_u32 s48, s71, 221184
  buffer_load_dwordx4 v22, s[28:31], s48 offen offset:0 lds
  v_lshl_or_b32 v2, v2, 15, v2
  v_lshlrev_b32 v160, 14, v2
  buffer_load_dwordx4 v23, s[28:31], s48 offen offset:1024 lds
  v_and_b32 v160, s0, v160
  v_lshlrev_b32 v161, 12, v2
  v_and_b32 v161, s0, v161
  buffer_load_dwordx4 v24, s[28:31], s48 offen offset:2048 lds
  v_lshlrev_b32 v162, 10, v2
  v_and_b32 v162, s0, v162
  s_add_u32 m0, s78, 139264
  s_add_u32 s48, s71, 245760
  buffer_load_dwordx4 v22, s[28:31], s48 offen offset:0 lds
  v_lshlrev_b32 v163, 8, v2
  v_and_b32 v163, s0, v163
  v_cmp_gt_u32 vcc, 84, v98
  s_mul_i32 s60, s53, 2560
  s_add_u32 s51, s77, s60
  v_cndmask_b32 v100, v16, v100, vcc
  v_cndmask_b32 v160, 0, v160, vcc
  v_cndmask_b32 v161, 0, v161, vcc
  v_cndmask_b32 v162, 0, v162, vcc
  v_cndmask_b32 v163, 0, v163, vcc
  buffer_load_dwordx4 v23, s[28:31], s48 offen offset:1024 lds
  s_mul_i32 s60, s56, 196608
  s_mul_i32 s61, s55, 6144
  buffer_load_dwordx4 v24, s[28:31], s48 offen offset:2048 lds
  s_add_u32 s75, s60, s61
  s_add_u32 s75, s75, 5832704
  s_lshl2_add_u32 s60, s55, s53
  s_add_u32 m0, s78, 151552
  s_add_u32 s48, s71, 270336
  buffer_load_dwordx4 v22, s[28:31], s48 offen offset:0 lds
  s_mul_i32 s76, s60, 61440
  s_add_u32 s76, s76, 12124160
  buffer_load_dwordx4 v23, s[28:31], s48 offen offset:1024 lds
  s_lshl4_add_u32 s60, s56, s53
  s_mul_i32 s79, s60, 12288
  s_add_u32 s79, s79, 5832704
  buffer_load_dwordx4 v24, s[28:31], s48 offen offset:2048 lds
  s_and_b32 s60, s56, 0
  s_add_u32 s3, s79, 0
  s_add_u32 m0, s78, 65536
  s_add_u32 s48, s71, 294912
  buffer_load_dwordx4 v22, s[28:31], s48 offen offset:0 lds
  s_add_u32 s4, s79, 2048
  s_add_u32 s5, s79, 4096
  s_add_u32 s6, s79, 6144
  buffer_load_dwordx4 v23, s[28:31], s48 offen offset:1024 lds
  s_add_u32 s7, s79, 8192
  s_add_u32 s50, s79, 10240
  buffer_load_dwordx4 v24, s[28:31], s48 offen offset:2048 lds
  s_barrier
  s_cmp_eq_u32 s53, 3
  s_cbranch_scc1 L_far_20
  s_add_u32 s65, s77, 2816
  buffer_load_dwordx4 v[192:195], v100, s[20:23], s77 offen offset:0 sc1
  buffer_load_dwordx4 v[196:199], v100, s[20:23], s77 offen offset:1408 sc1
  buffer_load_dwordx4 v[200:203], v100, s[20:23], s65 offen offset:0 sc1
  buffer_load_dwordx4 v[204:207], v100, s[20:23], s65 offen offset:1408 sc1
L_back_21:
  s_lshl2_add_u32 s49, s52, s53
  s_mul_i32 s49, s49, 6144
  s_add_u32 s49, s49, 5832704
  buffer_store_dwordx4 v[18:21], v7, s[20:23], s49 offen offset:1024 sc1
  s_add_u32 m0, s78, 77824
  s_add_u32 s48, s71, 319488
  buffer_load_dwordx4 v22, s[28:31], s48 offen offset:0 lds
  buffer_load_dwordx4 v23, s[28:31], s48 offen offset:1024 lds
  buffer_load_dwordx4 v24, s[28:31], s48 offen offset:2048 lds
  s_add_u32 m0, s78, 90112
  s_add_u32 s48, s71, 344064
  buffer_load_dwordx4 v22, s[28:31], s48 offen offset:0 lds
  buffer_load_dwordx4 v23, s[28:31], s48 offen offset:1024 lds
  buffer_load_dwordx4 v24, s[28:31], s48 offen offset:2048 lds
  s_add_u32 m0, s78, 102400
  s_add_u32 s48, s71, 368640
  buffer_load_dwordx4 v22, s[28:31], s48 offen offset:0 lds
  buffer_load_dwordx4 v23, s[28:31], s48 offen offset:1024 lds
  buffer_load_dwordx4 v24, s[28:31], s48 offen offset:2048 lds
  s_waitcnt vmcnt(10)
  v_add_u32 v6, 114688, v25
  ds_read_b64_tr_b16 a[108:109], v6 offset:12288
  ds_read_b64_tr_b16 a[110:111], v6 offset:13824
  ds_read_b64_tr_b16 a[112:113], v6 offset:12320
  ds_read_b64_tr_b16 a[114:115], v6 offset:13856
  ds_read_b64_tr_b16 a[116:117], v6 offset:12352
  ds_read_b64_tr_b16 a[118:119], v6 offset:13888
  ds_read_b64_tr_b16 a[120:121], v6 offset:24576
  ds_read_b64_tr_b16 a[122:123], v6 offset:26112
  ds_read_b64_tr_b16 a[124:125], v6 offset:24608
  ds_read_b64_tr_b16 a[126:127], v6 offset:26144
  ds_read_b64_tr_b16 a[128:129], v6 offset:24640
  ds_read_b64_tr_b16 a[130:131], v6 offset:26176
  ds_read_b64_tr_b16 a[132:133], v6 offset:36864
  ds_read_b64_tr_b16 a[134:135], v6 offset:38400
  ds_read_b64_tr_b16 a[136:137], v6 offset:36896
  ds_read_b64_tr_b16 a[138:139], v6 offset:38432
  ds_read_b64_tr_b16 a[140:141], v6 offset:36928
  ds_read_b64_tr_b16 a[142:143], v6 offset:38464
  v_add_u32 v6, 65536, v25
  ds_read_b64_tr_b16 a[144:145], v6 offset:0
  ds_read_b64_tr_b16 a[146:147], v6 offset:1536
  ds_read_b64_tr_b16 a[148:149], v6 offset:32
  ds_read_b64_tr_b16 a[150:151], v6 offset:1568
  ds_read_b64_tr_b16 a[152:153], v6 offset:64
  ds_read_b64_tr_b16 a[154:155], v6 offset:1600
  s_waitcnt lgkmcnt(0)
  s_mov_b64 exec, 0
  s_cmp_eq_u32 s53, 0
  s_cbranch_scc1 L_pad_pg5
  s_cmp_eq_u32 s53, 1
  s_cbranch_scc1 L_pad_pg6
  s_cmp_eq_u32 s53, 2
  s_cbranch_scc1 L_pad_s3r0
  s_cmp_eq_u32 s53, 3
  s_cbranch_scc1 L_pad_s3r1
L_wret_25:
  s_mov_b64 exec, -1
  s_cmp_eq_u32 s53, 3
  s_cbranch_scc1 L_skip_26
  v_xor_b32 v66, v160, v192
  v_xor_b32 v70, v161, v193
  v_xor_b32 v74, v162, v194
  v_xor_b32 v78, v163, v195
  v_xor_b32 v67, v160, v196
  v_xor_b32 v71, v161, v197
  v_xor_b32 v75, v162, v198
  v_xor_b32 v79, v163, v199
  v_xor_b32 v68, v160, v200
  v_xor_b32 v72, v161, v201
  v_xor_b32 v76, v162, v202
  v_xor_b32 v80, v163, v203
  v_xor_b32 v69, v160, v204
  v_xor_b32 v73, v161, v205
  v_xor_b32 v77, v162, v206
  v_xor_b32 v81, v163, v207
  v_or3_b32 v6, v66, v70, v74
  v_or3_b32 v6, v6, v78, v67
  v_or3_b32 v6, v6, v71, v75
  v_or3_b32 v6, v6, v79, v68
  v_or3_b32 v6, v6, v72, v76
  v_or3_b32 v6, v6, v80, v69
  v_or3_b32 v6, v6, v73, v77
  v_bitop3_b32 v6, v6, v81, s0 bitop3:0xa8
  v_cmp_ne_u32 vcc, 0, v6
  s_cbranch_vccnz L_slow_27
L_ok_28:
  v_mfma_f32_32x32x16_bf16 v[136:151], v[132:135], v[66:69], 0
  v_mfma_f32_32x32x16_bf16 v[102:117], v[132:135], v[70:73], 0
  s_nop 10
  v_cvt_pk_bf16_f32 v66, v136, v137
  v_cvt_pk_bf16_f32 v67, v138, v139
  v_cvt_pk_bf16_f32 v68, v140, v141
  v_mfma_f32_32x32x16_bf16 v[232:247], v[132:135], v[74:77], 0
  ds_write2st64_b32 v156, v66, v67 offset0:80 offset1:86
  v_cvt_pk_bf16_f32 v69, v142, v143
  ds_write2st64_b32 v156, v68, v69 offset0:92 offset1:98
  v_mfma_f32_32x32x16_bf16 v[176:191], v[132:135], v[78:81], 0
  v_cvt_pk_bf16_f32 v70, v102, v103
  v_cvt_pk_bf16_f32 v71, v104, v105
  v_cvt_pk_bf16_f32 v72, v106, v107
  v_cvt_pk_bf16_f32 v73, v108, v109
  ds_write2st64_b32 v157, v70, v71 offset0:80 offset1:86
  ds_write2st64_b32 v157, v72, v73 offset0:92 offset1:98
  s_nop 1
  v_cvt_pk_bf16_f32 v74, v232, v233
  v_cvt_pk_bf16_f32 v75, v234, v235
  v_cvt_pk_bf16_f32 v76, v236, v237
  v_cvt_pk_bf16_f32 v77, v238, v239
  ds_write2st64_b32 v158, v74, v75 offset0:80 offset1:86
  ds_write2st64_b32 v158, v76, v77 offset0:92 offset1:98
  v_cvt_pk_bf16_f32 v78, v176, v177
  v_cvt_pk_bf16_f32 v79, v178, v179
  v_cvt_pk_bf16_f32 v80, v180, v181
  v_cvt_pk_bf16_f32 v81, v182, v183
  ds_write2st64_b32 v159, v78, v79 offset0:80 offset1:86
  ds_write2st64_b32 v159, v80, v81 offset0:92 offset1:98
L_skip_26:
  s_lshl2_add_u32 s49, s52, s53
  s_mul_i32 s49, s49, 6144
  s_add_u32 s49, s49, 5832704
  buffer_store_dwordx4 v[18:21], v7, s[20:23], s49 offen offset:2048 sc1
  s_lshl2_add_u32 s49, s52, s53
  s_mul_i32 s49, s49, 6144
  s_add_u32 s49, s49, 5835776
  buffer_store_dwordx4 v[18:21], v7, s[20:23], s49 offen offset:0 sc1
  s_waitcnt lgkmcnt(0)
  s_barrier
  ds_read2_b32 v[232:233], v222 offset0:0 offset1:5
  ds_read2_b32 v[234:235], v222 offset0:10 offset1:15
  ds_read2_b32 v[236:237], v223 offset0:15 offset1:10
  ds_read2_b32 v[238:239], v223 offset0:5 offset1:0
  ds_read2_b32 v[240:241], v230 offset0:0 offset1:5
  ds_read2_b32 v[242:243], v230 offset0:10 offset1:15
  ds_read2_b32 v[244:245], v231 offset0:15 offset1:10
  ds_read2_b32 v[246:247], v231 offset0:5 offset1:0
  ds_read_b128 v[66:69], v7 offset:5120
  ds_read_b128 v[70:73], v7 offset:6400
  ds_read2st64_b32 v[74:75], v8 offset0:24 offset1:29
  s_lshl2_add_u32 s49, s52, s53
  s_mul_i32 s49, s49, 6144
  s_add_u32 s49, s49, 5835776
  buffer_store_dwordx4 v[18:21], v7, s[20:23], s49 offen offset:1024 sc1
  s_waitcnt lgkmcnt(9)
  v_mfma_f32_16x16x32_bf16 v[160:163], v[232:235], a[200:203], 0
  v_mfma_f32_16x16x32_bf16 v[164:167], v[232:235], a[204:207], 0
  v_mfma_f32_16x16x32_bf16 v[168:171], v[232:235], a[208:211], 0
  v_mfma_f32_16x16x32_bf16 v[172:175], v[232:235], a[212:215], 0
  buffer_store_dwordx4 v[18:21], v7, s[20:23], s49 offen offset:2048 sc1
  s_waitcnt lgkmcnt(7)
  v_mfma_f32_16x16x32_bf16 v[160:163], v[236:239], a[216:219], v[160:163]
  v_mfma_f32_16x16x32_bf16 v[164:167], v[236:239], a[220:223], v[164:167]
  v_mfma_f32_16x16x32_bf16 v[168:171], v[236:239], a[224:227], v[168:171]
  v_mfma_f32_16x16x32_bf16 v[172:175], v[236:239], a[228:231], v[172:175]
  s_waitcnt lgkmcnt(5)
  v_mfma_f32_16x16x32_bf16 v[176:179], v[240:243], a[200:203], 0
  v_mfma_f32_16x16x32_bf16 v[180:183], v[240:243], a[204:207], 0
  v_mfma_f32_16x16x32_bf16 v[184:187], v[240:243], a[208:211], 0
  v_mfma_f32_16x16x32_bf16 v[188:191], v[240:243], a[212:215], 0
  s_waitcnt lgkmcnt(3)
  v_mfma_f32_16x16x32_bf16 v[176:179], v[244:247], a[216:219], v[176:179]
  v_mfma_f32_16x16x32_bf16 v[180:183], v[244:247], a[220:223], v[180:183]
  v_mfma_f32_16x16x32_bf16 v[184:187], v[244:247], a[224:227], v[184:187]
  v_mfma_f32_16x16x32_bf16 v[188:191], v[244:247], a[228:231], v[188:191]
  s_add_u32 m0, s78, 114688
  s_add_u32 s48, s71, 1572864
  buffer_load_dwordx4 v26, s[28:31], s48 offen offset:0 lds
  v_pk_mul_f32 v[248:249], v[164:165], v[34:35]
  v_pk_mul_f32 v[252:253], v[160:161], v[34:35]
  v_pk_mul_f32 v[250:251], v[166:167], v[36:37]
  v_pk_mul_f32 v[254:255], v[162:163], v[36:37]
  v_pk_fma_f32 v[160:161], v[160:161], v[30:31], v[248:249] neg_lo:[0,0,1] neg_hi:[0,0,1]
  v_pk_fma_f32 v[164:165], v[164:165], v[30:31], v[252:253]
  v_pk_fma_f32 v[162:163], v[162:163], v[32:33], v[250:251] neg_lo:[0,0,1] neg_hi:[0,0,1]
  v_pk_fma_f32 v[166:167], v[166:167], v[32:33], v[254:255]
  v_pk_mul_f32 v[192:193], v[172:173], v[42:43]
  v_pk_mul_f32 v[196:197], v[168:169], v[42:43]
  v_pk_mul_f32 v[194:195], v[174:175], v[44:45]
  v_pk_mul_f32 v[198:199], v[170:171], v[44:45]
  v_pk_fma_f32 v[168:169], v[168:169], v[38:39], v[192:193] neg_lo:[0,0,1] neg_hi:[0,0,1]
  v_pk_fma_f32 v[172:173], v[172:173], v[38:39], v[196:197]
  v_pk_fma_f32 v[170:171], v[170:171], v[40:41], v[194:195] neg_lo:[0,0,1] neg_hi:[0,0,1]
  v_pk_fma_f32 v[174:175], v[174:175], v[40:41], v[198:199]
  v_pk_mul_f32 v[248:249], v[180:181], v[34:35]
  v_pk_mul_f32 v[252:253], v[176:177], v[34:35]
  v_pk_mul_f32 v[250:251], v[182:183], v[36:37]
  v_pk_mul_f32 v[254:255], v[178:179], v[36:37]
  buffer_load_dwordx4 v27, s[28:31], s48 offen offset:1024 lds
  v_pk_fma_f32 v[176:177], v[176:177], v[30:31], v[248:249] neg_lo:[0,0,1] neg_hi:[0,0,1]
  v_pk_fma_f32 v[180:181], v[180:181], v[30:31], v[252:253]
  v_pk_fma_f32 v[178:179], v[178:179], v[32:33], v[250:251] neg_lo:[0,0,1] neg_hi:[0,0,1]
  v_pk_fma_f32 v[182:183], v[182:183], v[32:33], v[254:255]
  v_pk_mul_f32 v[192:193], v[188:189], v[42:43]
  v_pk_mul_f32 v[196:197], v[184:185], v[42:43]
  v_pk_mul_f32 v[194:195], v[190:191], v[44:45]
  v_pk_mul_f32 v[198:199], v[186:187], v[44:45]
  v_pk_fma_f32 v[184:185], v[184:185], v[38:39], v[192:193] neg_lo:[0,0,1] neg_hi:[0,0,1]
  v_pk_fma_f32 v[188:189], v[188:189], v[38:39], v[196:197]
  v_pk_fma_f32 v[186:187], v[186:187], v[40:41], v[194:195] neg_lo:[0,0,1] neg_hi:[0,0,1]
  v_pk_fma_f32 v[190:191], v[190:191], v[40:41], v[198:199]
  buffer_load_dwordx4 v28, s[28:31], s48 offen offset:2048 lds
  v_cvt_pk_bf16_f32 v232, v160, v164
  v_cvt_pk_bf16_f32 v233, v161, v165
  v_cvt_pk_bf16_f32 v234, v162, v166
  v_cvt_pk_bf16_f32 v235, v163, v167
  v_cvt_pk_bf16_f32 v236, v168, v172
  v_cvt_pk_bf16_f32 v237, v169, v173
  v_mfma_f32_16x16x32_bf16 v[200:203], a[232:235], v[232:235], 0
  v_cvt_pk_bf16_f32 v238, v170, v174
  v_cvt_pk_bf16_f32 v239, v171, v175
  v_mfma_f32_16x16x32_bf16 v[208:211], a[236:239], v[232:235], 0
  v_cvt_pk_bf16_f32 v240, v176, v180
  s_add_u32 m0, s78, 126976
  s_add_u32 s48, s71, 1671168
  buffer_load_dwordx4 v26, s[28:31], s48 offen offset:0 lds
  v_cvt_pk_bf16_f32 v241, v177, v181
  v_mfma_f32_16x16x32_bf16 v[204:207], a[232:235], v[236:239], 0
  v_cvt_pk_bf16_f32 v242, v178, v182
  v_cvt_pk_bf16_f32 v243, v179, v183
  v_mfma_f32_16x16x32_bf16 v[208:211], a[240:243], v[236:239], v[208:211]
  v_cvt_pk_bf16_f32 v244, v184, v188
  v_cvt_pk_bf16_f32 v245, v185, v189
  v_mfma_f32_16x16x32_bf16 v[76:79], a[232:235], v[240:243], 0
  v_cvt_pk_bf16_f32 v246, v186, v190
  buffer_load_dwordx4 v27, s[28:31], s48 offen offset:1024 lds
  v_cvt_pk_bf16_f32 v247, v187, v191
  v_mfma_f32_16x16x32_bf16 v[84:87], a[236:239], v[240:243], 0
  ds_read_b128 v[160:163], v7 offset:10240
  ds_read_b128 v[164:167], v7 offset:11520
  v_mfma_f32_16x16x32_bf16 v[80:83], a[232:235], v[244:247], 0
  ds_read2st64_b32 v[168:169], v8 offset0:44 offset1:49
  ds_read_b128 v[176:179], v7 offset:7680
  v_mfma_f32_16x16x32_bf16 v[84:87], a[240:243], v[244:247], v[84:87]
  ds_read_b128 v[180:183], v7 offset:8960
  ds_read2st64_b32 v[184:185], v8 offset0:34 offset1:39
  buffer_load_dwordx4 v28, s[28:31], s48 offen offset:2048 lds
  s_waitcnt lgkmcnt(8)
  v_pk_fma_f32 v[46:47], v[200:201], v[66:67], v[46:47]
  v_pk_fma_f32 v[56:57], v[76:77], v[66:67], v[56:57]
  v_pk_fma_f32 v[48:49], v[202:203], v[68:69], v[48:49]
  v_pk_fma_f32 v[58:59], v[78:79], v[68:69], v[58:59]
  v_pk_mul_f32 v[196:197], v[46:47], v[46:47]
  v_pk_mul_f32 v[198:199], v[56:57], v[56:57]
  s_waitcnt lgkmcnt(7)
  v_pk_fma_f32 v[50:51], v[204:205], v[70:71], v[50:51]
  v_pk_fma_f32 v[60:61], v[80:81], v[70:71], v[60:61]
  v_pk_add_f32 v[192:193], v[46:47], v[48:49]
  v_pk_add_f32 v[194:195], v[56:57], v[58:59]
  v_pk_fma_f32 v[196:197], v[48:49], v[48:49], v[196:197]
  v_pk_fma_f32 v[198:199], v[58:59], v[58:59], v[198:199]
  s_add_u32 m0, s78, 139264
  s_add_u32 s48, s71, 1769472
  buffer_load_dwordx4 v26, s[28:31], s48 offen offset:0 lds
  v_pk_fma_f32 v[52:53], v[206:207], v[72:73], v[52:53]
  v_pk_fma_f32 v[62:63], v[82:83], v[72:73], v[62:63]
  v_pk_add_f32 v[192:193], v[192:193], v[50:51]
  v_pk_fma_f32 v[196:197], v[50:51], v[50:51], v[196:197]
  v_pk_add_f32 v[194:195], v[194:195], v[60:61]
  v_pk_fma_f32 v[198:199], v[60:61], v[60:61], v[198:199]
  s_waitcnt lgkmcnt(6)
  v_pk_fma_f32 v[54:55], v[208:209], v[74:75], v[54:55]
  v_pk_fma_f32 v[64:65], v[84:85], v[74:75], v[64:65]
  v_pk_add_f32 v[192:193], v[192:193], v[52:53]
  v_pk_fma_f32 v[196:197], v[52:53], v[52:53], v[196:197]
  buffer_load_dwordx4 v27, s[28:31], s48 offen offset:1024 lds
  v_pk_add_f32 v[194:195], v[194:195], v[62:63]
  v_pk_fma_f32 v[198:199], v[62:63], v[62:63], v[198:199]
  v_pk_add_f32 v[192:193], v[192:193], v[54:55]
  v_pk_fma_f32 v[196:197], v[54:55], v[54:55], v[196:197]
  v_pk_add_f32 v[194:195], v[194:195], v[64:65]
  v_pk_fma_f32 v[198:199], v[64:65], v[64:65], v[198:199]
  v_add_f32 v192, v192, v193
  v_add_f32 v194, v194, v195
  v_add_f32 v196, v196, v197
  v_add_f32 v198, v198, v199
  v_permlane32_swap_b32 v192, v194
  buffer_load_dwordx4 v28, s[28:31], s48 offen offset:2048 lds
  v_permlane32_swap_b32 v196, v198
  v_add_f32 v192, v192, v194
  v_add_f32 v196, v196, v198
  v_cvt_pk_bf16_f32 v66, v46, v50
  v_cvt_pk_bf16_f32 v67, v47, v51
  v_permlane16_swap_b32 v192, v196
  v_add_f32 v192, v192, v196
  v_cvt_pk_bf16_f32 v68, v48, v52
  v_cvt_pk_bf16_f32 v69, v49, v53
  v_add_f32_dpp v192, v192, v192 row_ror:8 row_mask:0xf bank_mask:0xf
  s_add_u32 s49, s76, 0
L_pad_pg3:
  s_cbranch_execz L_wret_12
  buffer_load_dwordx4 v[96:99], v7, s[20:23], s49 offen offset:0 sc1
  v_cvt_pk_bf16_f32 v70, v54, v55
  v_cvt_pk_bf16_f32 v71, v56, v60
  v_add_f32_dpp v192, v192, v192 row_ror:4 row_mask:0xf bank_mask:0xf
  v_cvt_pk_bf16_f32 v72, v57, v61
  v_cvt_pk_bf16_f32 v73, v58, v62
  v_add_f32_dpp v192, v192, v192 row_ror:2 row_mask:0xf bank_mask:0xf
  v_cvt_pk_bf16_f32 v74, v59, v63
  v_cvt_pk_bf16_f32 v75, v64, v65
  v_add_f32_dpp v192, v192, v192 row_ror:1 row_mask:0xf bank_mask:0xf
  v_mul_f32 v193, 0x3acccccd, v192
  v_mul_f32 v192, 0x3acccccd, v192
  buffer_load_dwordx4 v[100:103], v7, s[20:23], s49 offen offset:1024 sc1
  s_nop 0
  v_permlane16_swap_b32 v192, v193
  v_fma_f32 v193, -v192, v192, v193
  v_max_f32 v193, 0, v193
  v_add_f32 v193, 0x3727c5ac, v193
  v_rsq_f32 v193, v193
  s_nop 0
  v_mul_f32_e64 v192, -v192, v193
  v_readlane_b32 s66, v193, 0
  v_readlane_b32 s68, v193, 32
  v_readlane_b32 s67, v192, 0
  v_readlane_b32 s69, v192, 32
  s_nop 0
  v_pk_fma_f32 v[200:201], v[46:47], s[66:67], s[66:67] op_sel:[0,0,1] op_sel_hi:[1,0,1]
  v_pk_fma_f32 v[76:77], v[56:57], s[68:69], s[68:69] op_sel:[0,0,1] op_sel_hi:[1,0,1]
  v_pk_fma_f32 v[202:203], v[48:49], s[66:67], s[66:67] op_sel:[0,0,1] op_sel_hi:[1,0,1]
  v_pk_fma_f32 v[78:79], v[58:59], s[68:69], s[68:69] op_sel:[0,0,1] op_sel_hi:[1,0,1]
  s_waitcnt lgkmcnt(2)
  v_pk_fma_f32 v[200:201], v[200:201], v[160:161], v[176:177]
  v_pk_fma_f32 v[76:77], v[76:77], v[160:161], v[176:177]
  v_pk_fma_f32 v[204:205], v[50:51], s[66:67], s[66:67] op_sel:[0,0,1] op_sel_hi:[1,0,1]
  v_pk_fma_f32 v[80:81], v[60:61], s[68:69], s[68:69] op_sel:[0,0,1] op_sel_hi:[1,0,1]
  v_pk_fma_f32 v[202:203], v[202:203], v[162:163], v[178:179]
  v_pk_fma_f32 v[78:79], v[78:79], v[162:163], v[178:179]
  v_pk_mul_f32 v[196:197], v[200:201], v[200:201]
  v_pk_mul_f32 v[198:199], v[76:77], v[76:77]
  v_pk_fma_f32 v[206:207], v[52:53], s[66:67], s[66:67] op_sel:[0,0,1] op_sel_hi:[1,0,1]
  v_pk_fma_f32 v[82:83], v[62:63], s[68:69], s[68:69] op_sel:[0,0,1] op_sel_hi:[1,0,1]
  s_waitcnt lgkmcnt(1)
  v_pk_fma_f32 v[204:205], v[204:205], v[164:165], v[180:181]
  v_pk_fma_f32 v[80:81], v[80:81], v[164:165], v[180:181]
  v_pk_add_f32 v[192:193], v[200:201], v[202:203]
  v_pk_add_f32 v[194:195], v[76:77], v[78:79]
  v_pk_fma_f32 v[196:197], v[202:203], v[202:203], v[196:197]
  v_pk_fma_f32 v[198:199], v[78:79], v[78:79], v[198:199]
  v_pk_fma_f32 v[208:209], v[54:55], s[66:67], s[66:67] op_sel:[0,0,1] op_sel_hi:[1,0,1]
  v_pk_fma_f32 v[84:85], v[64:65], s[68:69], s[68:69] op_sel:[0,0,1] op_sel_hi:[1,0,1]
  v_pk_fma_f32 v[206:207], v[206:207], v[166:167], v[182:183]
  v_pk_fma_f32 v[82:83], v[82:83], v[166:167], v[182:183]
  v_pk_add_f32 v[192:193], v[192:193], v[204:205]
  v_pk_fma_f32 v[196:197], v[204:205], v[204:205], v[196:197]
  v_pk_add_f32 v[194:195], v[194:195], v[80:81]
  v_pk_fma_f32 v[198:199], v[80:81], v[80:81], v[198:199]
  s_waitcnt lgkmcnt(0)
  v_pk_fma_f32 v[208:209], v[208:209], v[168:169], v[184:185]
  v_pk_fma_f32 v[84:85], v[84:85], v[168:169], v[184:185]
  v_pk_add_f32 v[192:193], v[192:193], v[206:207]
  v_pk_fma_f32 v[196:197], v[206:207], v[206:207], v[196:197]
  v_pk_add_f32 v[194:195], v[194:195], v[82:83]
  v_pk_fma_f32 v[198:199], v[82:83], v[82:83], v[198:199]
  v_pk_add_f32 v[192:193], v[192:193], v[208:209]
  v_pk_fma_f32 v[196:197], v[208:209], v[208:209], v[196:197]
  v_pk_add_f32 v[194:195], v[194:195], v[84:85]
  v_pk_fma_f32 v[198:199], v[84:85], v[84:85], v[198:199]
  v_add_f32 v192, v192, v193
  v_add_f32 v194, v194, v195
  v_add_f32 v196, v196, v197
  v_add_f32 v198, v198, v199
  v_permlane32_swap_b32 v192, v194
  s_nop 0
  v_permlane32_swap_b32 v196, v198
  v_add_f32 v192, v192, v194
  v_add_f32 v196, v196, v198
  s_nop 1
  v_permlane16_swap_b32 v192, v196
  v_add_f32 v192, v192, v196
  s_nop 1
  v_add_f32_dpp v192, v192, v192 row_ror:8 row_mask:0xf bank_mask:0xf
  s_nop 1
  v_add_f32_dpp v192, v192, v192 row_ror:4 row_mask:0xf bank_mask:0xf
  s_nop 1
  v_add_f32_dpp v192, v192, v192 row_ror:2 row_mask:0xf bank_mask:0xf
  s_nop 1
  v_add_f32_dpp v192, v192, v192 row_ror:1 row_mask:0xf bank_mask:0xf
  v_mul_f32 v193, 0x3acccccd, v192
  v_mul_f32 v192, 0x3acccccd, v192
  s_nop 1
  v_permlane16_swap_b32 v192, v193
  v_fma_f32 v193, -v192, v192, v193
  v_max_f32 v193, 0, v193
  v_add_f32 v193, 0x3727c5ac, v193
  v_rsq_f32 v193, v193
  s_nop 0
  v_mul_f32 v193, 0x37800000, v193
  v_mul_f32_e64 v192, -v192, v193
  v_readlane_b32 s66, v193, 0
  v_readlane_b32 s68, v193, 32
  v_readlane_b32 s67, v192, 0
  v_readlane_b32 s69, v192, 32
  s_nop 0
  v_pk_fma_f32 v[200:201], v[200:201], s[66:67], s[66:67] op_sel:[0,0,1] op_sel_hi:[1,0,1]
  v_pk_fma_f32 v[76:77], v[76:77], s[68:69], s[68:69] op_sel:[0,0,1] op_sel_hi:[1,0,1]
  v_pk_fma_f32 v[202:203], v[202:203], s[66:67], s[66:67] op_sel:[0,0,1] op_sel_hi:[1,0,1]
  v_pk_fma_f32 v[78:79], v[78:79], s[68:69], s[68:69] op_sel:[0,0,1] op_sel_hi:[1,0,1]
  v_pk_fma_f32 v[204:205], v[204:205], s[66:67], s[66:67] op_sel:[0,0,1] op_sel_hi:[1,0,1]
  v_pk_fma_f32 v[80:81], v[80:81], s[68:69], s[68:69] op_sel:[0,0,1] op_sel_hi:[1,0,1]
  v_pk_fma_f32 v[206:207], v[206:207], s[66:67], s[66:67] op_sel:[0,0,1] op_sel_hi:[1,0,1]
  v_pk_fma_f32 v[82:83], v[82:83], s[68:69], s[68:69] op_sel:[0,0,1] op_sel_hi:[1,0,1]
  v_pk_fma_f32 v[208:209], v[208:209], s[66:67], s[66:67] op_sel:[0,0,1] op_sel_hi:[1,0,1]
  v_pk_fma_f32 v[84:85], v[84:85], s[68:69], s[68:69] op_sel:[0,0,1] op_sel_hi:[1,0,1]
  v_cvt_pk_bf16_f32 v232, v200, v204
  v_cvt_pk_bf16_f32 v233, v201, v205
  v_cvt_pk_bf16_f32 v234, v202, v206
  v_cvt_pk_bf16_f32 v235, v203, v207
  v_cvt_pk_bf16_f32 v236, v208, v209
  v_cvt_pk_bf16_f32 v240, v76, v80
  v_cvt_pk_bf16_f32 v241, v77, v81
  v_cvt_pk_bf16_f32 v242, v78, v82
  v_cvt_pk_bf16_f32 v243, v79, v83
  v_cvt_pk_bf16_f32 v244, v84, v85
  s_waitcnt vmcnt(11)
  buffer_store_dwordx4 v[232:235], v7, s[20:23], s51 offen offset:0 sc1
  buffer_store_dword v236, v8, s[20:23], s51 offen offset:1024 sc1
  buffer_store_dwordx4 v[240:243], v7, s[20:23], s51 offen offset:1280 sc1
  buffer_store_dword v244, v8, s[20:23], s51 offen offset:2304 sc1
  s_nop 0
  v_add_u32 v2, s78, v8
  v_add_u32 v3, s78, v7
  ds_write2st64_b32 v2, v66, v67 offset0:80 offset1:81
  ds_write2st64_b32 v2, v68, v69 offset0:82 offset1:83
  ds_write2st64_b32 v2, v70, v71 offset0:84 offset1:85
  ds_write2st64_b32 v2, v72, v73 offset0:86 offset1:87
  ds_write2st64_b32 v2, v74, v75 offset0:88 offset1:89
  ds_read_b128 v[224:227], v3 offset:20480
  ds_read_b128 v[228:231], v3 offset:21504
  ds_read_b128 v[232:235], v3 offset:22528
  s_and_b32 s62, s55, 1
  s_lshl_b32 s62, s62, 9
  s_lshr_b32 s63, s55, 1
  s_lshl2_add_u32 s62, s63, s62
  v_lshl_add_u32 v2, v10, 5, s62
  s_add_u32 m0, s78, 151552
  s_add_u32 s48, s71, 1867776
  buffer_load_dwordx4 v26, s[28:31], s48 offen offset:0 lds
  v_add_u32 v3, 16, v2
  s_lshl_b32 s63, s55, 5
  v_lshl_add_u32 v4, v15, 3, s63
  v_add_u32 v5, 4, v4
  buffer_load_dwordx4 v27, s[28:31], s48 offen offset:1024 lds
  ds_read2st64_b32 v[236:237], v2 offset0:50 offset1:55
  ds_read2st64_b32 v[238:239], v3 offset0:50 offset1:55
  ds_read2st64_b32 v[240:241], v4 offset0:54 offset1:59
  ds_read2st64_b32 v[242:243], v5 offset0:54 offset1:59
  buffer_load_dwordx4 v28, s[28:31], s48 offen offset:2048 lds
  s_mul_i32 s62, s53, 96
  v_lshl_add_u32 v2, v11, 3, s62
  v_lshlrev_b32 v3, 3, v10
  v_lshlrev_b32 v4, 3, v15
  s_add_u32 s49, s76, 0
  buffer_load_dwordx4 v[104:107], v7, s[20:23], s49 offen offset:2048 sc1
  ds_read_b64 v[248:249], v2 offset:19712
  ds_read_b64 v[250:251], v2 offset:19744
  ds_read_b64 v[252:253], v2 offset:19776
  ds_read_b64 v[244:245], v3 offset:20096
  ds_read_b64 v[246:247], v4 offset:20224
  buffer_load_dwordx4 v[108:111], v7, s[20:23], s49 offen offset:3072 sc1
  v_lshrrev_b32 v2, 3, v1
  v_and_b32 v3, 7, v1
  s_and_b32 s62, s53, 1
  s_lshr_b32 s63, s53, 1
  s_add_u32 s49, s76, 4096
  buffer_load_dwordx4 v[112:115], v7, s[20:23], s49 offen offset:0 sc1
  s_lshl_b32 s64, s62, 2
  v_add_u32 v4, s64, v11
  v_xor_b32 v3, v4, v3
  v_mul_u32_u24 v17, 1280, v2
  buffer_load_dwordx4 v[116:119], v7, s[20:23], s49 offen offset:1024 sc1
  v_lshl_add_u32 v17, v3, 4, v17
  s_lshl3_add_u32 s64, s56, s62
  s_mul_i32 s64, s64, 11264
  s_mul_i32 s65, s63, 128
  buffer_load_dwordx4 v[120:123], v7, s[20:23], s49 offen offset:2048 sc1
  s_add_u32 s64, s64, s65
  v_add_u32 v17, s64, v17
  s_mul_i32 s63, s63, 2048
  s_lshl_b32 s62, s62, 10
  s_add_u32 s77, s62, s63
  buffer_load_dwordx4 v[124:127], v7, s[20:23], s49 offen offset:3072 sc1
  v_add_u32 v29, s77, v7
  s_waitcnt vmcnt(21)
  v_add_u32 v6, 65536, v25
  ds_read_b64_tr_b16 a[156:157], v6 offset:12288
  s_add_u32 s49, s76, 8192
  buffer_load_dwordx4 v[128:131], v7, s[20:23], s49 offen offset:0 sc1
  ds_read_b64_tr_b16 a[158:159], v6 offset:13824
  ds_read_b64_tr_b16 a[160:161], v6 offset:12320
  ds_read_b64_tr_b16 a[162:163], v6 offset:13856
  ds_read_b64_tr_b16 a[164:165], v6 offset:12352
  buffer_load_dwordx4 v[132:135], v7, s[20:23], s49 offen offset:1024 sc1
  ds_read_b64_tr_b16 a[166:167], v6 offset:13888
  ds_read_b64_tr_b16 a[168:169], v6 offset:24576
  ds_read_b64_tr_b16 a[170:171], v6 offset:26112
  ds_read_b64_tr_b16 a[172:173], v6 offset:24608
  s_add_u32 s49, s76, 10240
  buffer_load_dwordx4 v[136:139], v7, s[20:23], s49 offen offset:0 sc1
  ds_read_b64_tr_b16 a[174:175], v6 offset:26144
  ds_read_b64_tr_b16 a[176:177], v6 offset:24640
  ds_read_b64_tr_b16 a[178:179], v6 offset:26176
  ds_read_b64_tr_b16 a[180:181], v6 offset:36864
  ds_read_b64_tr_b16 a[182:183], v6 offset:38400
  buffer_load_dwordx4 v[140:143], v7, s[20:23], s49 offen offset:1024 sc1
  ds_read_b64_tr_b16 a[184:185], v6 offset:36896
  ds_read_b64_tr_b16 a[186:187], v6 offset:38432
  ds_read_b64_tr_b16 a[188:189], v6 offset:36928
  ds_read_b64_tr_b16 a[190:191], v6 offset:38464
  buffer_load_dwordx4 v[144:147], v7, s[20:23], s49 offen offset:2048 sc1
  v_add_u32 v6, 114688, v25
  ds_read_b64_tr_b16 a[192:193], v6 offset:0
  ds_read_b64_tr_b16 a[194:195], v6 offset:1536
  ds_read_b64_tr_b16 a[196:197], v6 offset:32
  buffer_load_dwordx4 v[148:151], v7, s[20:23], s49 offen offset:3072 sc1
  ds_read_b64_tr_b16 a[198:199], v6 offset:1568
  ds_read_b64_tr_b16 a[200:201], v6 offset:64
  ds_read_b64_tr_b16 a[202:203], v6 offset:1600
  s_waitcnt lgkmcnt(0)
  s_add_u32 s49, s76, 14336
  buffer_load_dwordx4 v[152:155], v7, s[20:23], s49 offen offset:0 sc1
  s_or_b32 s60, s52, s53
  s_cmp_eq_u32 s60, 0
  s_cbranch_scc1 L_far_30
L_back_31:
  s_barrier
  s_mov_b32 s65, 327680
  s_add_u32 m0, s77, 0
  s_nop 0
  buffer_load_dwordx4 v17, s[20:23], s65 offen offset:0 sc1 lds
  s_add_u32 m0, s77, 3840
  s_nop 0
  buffer_load_dwordx4 v17, s[20:23], s65 offen offset:256 sc1 lds
  s_add_u32 m0, s77, 7680
  s_nop 0
  buffer_load_dwordx4 v17, s[20:23], s65 offen offset:512 sc1 lds
  s_add_u32 m0, s77, 11520
  s_nop 0
  buffer_load_dwordx4 v17, s[20:23], s65 offen offset:768 sc1 lds
  s_add_u32 m0, s77, 15360
  s_nop 0
  buffer_load_dwordx4 v17, s[20:23], s65 offen offset:1024 sc1 lds
  s_waitcnt vmcnt(18)
  v_add_u32 v6, 114688, v25
  ds_read_b64_tr_b16 a[204:205], v6 offset:12288
  ds_read_b64_tr_b16 a[206:207], v6 offset:13824
  ds_read_b64_tr_b16 a[208:209], v6 offset:12320
  ds_read_b64_tr_b16 a[210:211], v6 offset:13856
  ds_read_b64_tr_b16 a[212:213], v6 offset:12352
  ds_read_b64_tr_b16 a[214:215], v6 offset:13888
  ds_read_b64_tr_b16 a[216:217], v6 offset:24576
  s_mov_b32 s65, 350208
  s_add_u32 m0, s77, 20480
  s_nop 0
  buffer_load_dwordx4 v17, s[20:23], s65 offen offset:0 sc1 lds
  ds_read_b64_tr_b16 a[218:219], v6 offset:26112
  ds_read_b64_tr_b16 a[220:221], v6 offset:24608
  ds_read_b64_tr_b16 a[222:223], v6 offset:26144
  ds_read_b64_tr_b16 a[224:225], v6 offset:24640
  ds_read_b64_tr_b16 a[226:227], v6 offset:26176
  ds_read_b64_tr_b16 a[228:229], v6 offset:36864
  ds_read_b64_tr_b16 a[230:231], v6 offset:38400
  ds_read_b64_tr_b16 a[232:233], v6 offset:36896
  ds_read_b64_tr_b16 a[234:235], v6 offset:38432
  s_add_u32 m0, s77, 24320
  s_nop 0
  buffer_load_dwordx4 v17, s[20:23], s65 offen offset:256 sc1 lds
  ds_read_b64_tr_b16 a[236:237], v6 offset:36928
  ds_read_b64_tr_b16 a[238:239], v6 offset:38464
  s_waitcnt lgkmcnt(0)
  v_mul_f32 v236, 0x47800000, v236
  v_mul_f32 v237, 0x47800000, v237
  v_mul_f32 v238, 0x47800000, v238
  v_mul_f32 v239, 0x47800000, v239
  v_mul_f32 v240, 0x47800000, v240
  v_mul_f32 v241, 0x47800000, v241
  s_add_u32 m0, s77, 28160
  s_nop 0
  buffer_load_dwordx4 v17, s[20:23], s65 offen offset:512 sc1 lds
  v_mul_f32 v242, 0x47800000, v242
  v_mul_f32 v243, 0x47800000, v243
  v_accvgpr_write_b32 a240, v236
  v_accvgpr_write_b32 a241, v237
  v_accvgpr_write_b32 a242, v238
  v_accvgpr_write_b32 a243, v239
  v_accvgpr_write_b32 a244, v240
  v_accvgpr_write_b32 a245, v241
  v_accvgpr_write_b32 a246, v242
  s_add_u32 m0, s77, 32000
  s_nop 0
  buffer_load_dwordx4 v17, s[20:23], s65 offen offset:768 sc1 lds
  v_accvgpr_write_b32 a247, v243
  v_lshrrev_b32 v4, 1, v10
  v_xor_b32 v4, v4, v11
  v_lshlrev_b32 v4, 4, v4
  v_lshl_add_u32 v94, v10, 7, v4
  v_xor_b32 v95, 64, v94
  v_lshlrev_b32 v30, 16, v248
  v_and_b32 v31, s58, v248
  v_lshlrev_b32 v32, 16, v249
  s_add_u32 m0, s77, 35840
  s_nop 0
  buffer_load_dwordx4 v17, s[20:23], s65 offen offset:1024 sc1 lds
  v_and_b32 v33, s58, v249
  v_lshlrev_b32 v34, 16, v250
  v_and_b32 v35, s58, v250
  v_lshlrev_b32 v36, 16, v251
  v_and_b32 v37, s58, v251
  v_lshlrev_b32 v38, 16, v252
  v_and_b32 v39, s58, v252
  v_lshlrev_b32 v40, 16, v253
  v_and_b32 v41, s58, v253
  s_mov_b32 s65, 372736
  s_add_u32 m0, s77, 40960
  s_nop 0
  buffer_load_dwordx4 v17, s[20:23], s65 offen offset:0 sc1 lds
  v_mul_f32 v30, 0x37800000, v30
  v_mul_f32 v31, 0x37800000, v31
  v_mul_f32 v32, 0x37800000, v32
  v_mul_f32 v33, 0x37800000, v33
  v_mul_f32 v34, 0x37800000, v34
  v_mul_f32 v35, 0x37800000, v35
  v_mul_f32 v36, 0x37800000, v36
  v_mul_f32 v37, 0x37800000, v37
  v_mul_f32 v38, 0x37800000, v38
  s_add_u32 m0, s77, 44800
  s_nop 0
  buffer_load_dwordx4 v17, s[20:23], s65 offen offset:256 sc1 lds
  v_mul_f32 v39, 0x37800000, v39
  v_mul_f32 v40, 0x37800000, v40
  v_mul_f32 v41, 0x37800000, v41
  v_lshlrev_b32 v2, 16, v244
  v_and_b32 v3, s58, v244
  v_mul_f32 v2, 0x37800000, v2
  v_mul_f32 v3, 0x37800000, v3
  v_accvgpr_write_b32 a248, v2
  v_accvgpr_write_b32 a249, v3
  s_add_u32 m0, s77, 48640
  s_nop 0
  buffer_load_dwordx4 v17, s[20:23], s65 offen offset:512 sc1 lds
  v_lshlrev_b32 v2, 16, v245
  v_and_b32 v3, s58, v245
  v_mul_f32 v2, 0x37800000, v2
  v_mul_f32 v3, 0x37800000, v3
  v_accvgpr_write_b32 a250, v2
  v_accvgpr_write_b32 a251, v3
  v_lshlrev_b32 v2, 16, v246
  v_and_b32 v3, s58, v246
  v_mul_f32 v2, 0x37800000, v2
  s_add_u32 m0, s77, 52480
  s_nop 0
  buffer_load_dwordx4 v17, s[20:23], s65 offen offset:768 sc1 lds
  v_mul_f32 v3, 0x37800000, v3
  v_accvgpr_write_b32 a252, v2
  v_accvgpr_write_b32 a253, v3
  v_lshlrev_b32 v2, 16, v247
  v_and_b32 v3, s58, v247
  v_mul_f32 v2, 0x37800000, v2
  v_mul_f32 v3, 0x37800000, v3
  v_accvgpr_write_b32 a254, v2
  v_accvgpr_write_b32 a255, v3
  s_add_u32 m0, s77, 56320
  s_nop 0
  buffer_load_dwordx4 v17, s[20:23], s65 offen offset:1024 sc1 lds
  s_add_u32 s49, s76, 14336
  buffer_load_dwordx4 v[156:159], v7, s[20:23], s49 offen offset:1024 sc1
  buffer_load_dwordx4 v[160:163], v7, s[20:23], s49 offen offset:2048 sc1
  buffer_load_dwordx4 v[164:167], v7, s[20:23], s49 offen offset:3072 sc1
  s_add_u32 s49, s76, 18432
  buffer_load_dwordx4 v[168:171], v7, s[20:23], s49 offen offset:0 sc1
  buffer_load_dwordx4 v[172:175], v7, s[20:23], s49 offen offset:1024 sc1
  s_add_u32 s49, s76, 20480
  buffer_load_dwordx4 v[176:179], v7, s[20:23], s49 offen offset:0 sc1
  s_waitcnt vmcnt(16)
  ds_read2st64_b32 v[74:75], v29 offset0:0 offset1:16
  ds_read2st64_b32 v[76:77], v29 offset0:32 offset1:48
  ds_read_b128 v[78:81], v29 offset:16384
  s_waitcnt lgkmcnt(1)
  v_or3_b32 v6, v74, v75, v76
  s_waitcnt lgkmcnt(0)
  v_or3_b32 v6, v6, v77, v78
  v_or3_b32 v6, v6, v79, v80
  v_bitop3_b32 v6, v6, v81, s0 bitop3:0xa8
  v_cmp_ne_u32 vcc, 0, v6
  s_cbranch_vccnz L_slow_32
L_ok_33:
  s_barrier
  ds_read_b128 v[18:21], v94 offset:0
  ds_read_b128 v[54:57], v95 offset:0
  ds_read_b128 v[58:61], v94 offset:2048
  ds_read_b128 v[62:65], v95 offset:2048
  s_waitcnt lgkmcnt(3)
  v_mfma_f32_16x16x32_bf16 v[42:45], a[0:3], v[18:21], v[30:33]
  ds_read_b128 v[22:25], v94 offset:4096
  s_mov_b32 s61, 395264
  s_add_u32 m0, s77, 61440
  v_mfma_f32_16x16x32_bf16 v[46:49], a[4:7], v[18:21], v[34:37]
  buffer_load_dwordx4 v17, s[20:23], s61 offen offset:0 sc1 lds
  s_lshl_b32 s60, s53, 10
  v_mfma_f32_16x16x32_bf16 v[50:53], a[8:11], v[18:21], v[38:41]
  v_add_u32 v12, s60, v7
  s_lshl_b32 s60, s53, 9
  s_add_u32 s60, s60, 4096
  s_waitcnt lgkmcnt(3)
  v_mfma_f32_16x16x32_bf16 v[42:45], a[12:15], v[54:57], v[42:45]
  ds_read_b128 v[18:21], v95 offset:4096
  s_add_u32 m0, s77, 65280
  v_cmp_gt_u32 vcc, 32, v1
  v_mfma_f32_16x16x32_bf16 v[46:49], a[16:19], v[54:57], v[46:49]
  buffer_load_dwordx4 v17, s[20:23], s61 offen offset:256 sc1 lds
  v_mfma_f32_16x16x32_bf16 v[50:53], a[20:23], v[54:57], v[50:53]
  v_add_u32 v13, s60, v7
  v_cndmask_b32 v13, v16, v13, vcc
  s_mul_i32 s78, s53, 20480
  s_waitcnt lgkmcnt(3)
  v_mfma_f32_16x16x32_bf16 v[42:45], a[24:27], v[58:61], v[42:45]
  ds_read_b128 v[54:57], v94 offset:6144
  s_add_u32 m0, s77, 69120
  s_add_u32 s78, s78, 81920
  v_mfma_f32_16x16x32_bf16 v[46:49], a[28:31], v[58:61], v[46:49]
  buffer_load_dwordx4 v17, s[20:23], s61 offen offset:512 sc1 lds
  s_mov_b32 s70, 0xd5d2d3e8
  v_mfma_f32_16x16x32_bf16 v[50:53], a[32:35], v[58:61], v[50:53]
  s_waitcnt lgkmcnt(3)
  v_mov_b32 v26, 0xc8135761
  v_lshlrev_b32 v9, 2, v9
  v_mfma_f32_16x16x32_bf16 v[42:45], a[36:39], v[62:65], v[42:45]
  ds_read_b128 v[58:61], v95 offset:6144
  s_waitcnt vmcnt(14)
  s_add_u32 m0, s77, 72960
  v_and_b32 v27, 1, v14
  v_mfma_f32_16x16x32_bf16 v[46:49], a[40:43], v[62:65], v[46:49]
  ds_read2st64_b32 v[74:75], v29 offset0:80 offset1:96
  buffer_load_dwordx4 v17, s[20:23], s61 offen offset:768 sc1 lds
  v_mul_u32_u24 v27, 6144, v27
  v_mfma_f32_16x16x32_bf16 v[50:53], a[44:47], v[62:65], v[50:53]
  ds_read2st64_b32 v[76:77], v29 offset0:112 offset1:128
  ds_read_b128 v[78:81], v29 offset:36864
  s_waitcnt lgkmcnt(6)
  v_lshl_add_u32 v27, v15, 9, v27
  v_mfma_f32_16x16x32_bf16 v[42:45], a[48:51], v[22:25], v[42:45]
  ds_read_b128 v[62:65], v94 offset:8192
  v_mfma_f32_16x16x32_bf16 v[46:49], a[52:55], v[22:25], v[46:49]
  s_add_u32 m0, s77, 76800
  v_mfma_f32_16x16x32_bf16 v[50:53], a[56:59], v[22:25], v[50:53]
  s_waitcnt lgkmcnt(6)
  v_mfma_f32_16x16x32_bf16 v[42:45], a[60:63], v[18:21], v[42:45]
  ds_read_b128 v[22:25], v95 offset:8192
  v_mfma_f32_16x16x32_bf16 v[46:49], a[64:67], v[18:21], v[46:49]
  buffer_load_dwordx4 v17, s[20:23], s61 offen offset:1024 sc1 lds
  v_mfma_f32_16x16x32_bf16 v[50:53], a[68:71], v[18:21], v[50:53]
  s_waitcnt lgkmcnt(6)
  v_mfma_f32_16x16x32_bf16 v[42:45], a[72:75], v[54:57], v[42:45]
  ds_read_b128 v[18:21], v94 offset:10240
  s_lshl2_add_u32 s48, s52, s53
  s_mul_i32 s48, s48, 2560
  s_add_u32 s48, s48, 3211264
  v_mfma_f32_16x16x32_bf16 v[46:49], a[76:79], v[54:57], v[46:49]
  buffer_store_dwordx4 v[224:227], v7, s[20:23], s48 offen offset:0 sc1
  v_mfma_f32_16x16x32_bf16 v[50:53], a[80:83], v[54:57], v[50:53]
  buffer_store_dwordx4 v[228:231], v7, s[20:23], s48 offen offset:1024 sc1
  s_waitcnt lgkmcnt(6)
  v_mfma_f32_16x16x32_bf16 v[42:45], a[84:87], v[58:61], v[42:45]
  ds_read_b128 v[54:57], v95 offset:10240
  s_mov_b32 exec_hi, 0
  buffer_store_dwordx4 v[232:235], v7, s[20:23], s48 offen offset:2048 sc1
  s_mov_b64 exec, -1
  v_mfma_f32_16x16x32_bf16 v[46:49], a[88:91], v[58:61], v[46:49]
  s_waitcnt lgkmcnt(5)
  v_or3_b32 v6, v74, v75, v76
  s_waitcnt lgkmcnt(4)
  v_or3_b32 v6, v6, v77, v78
  v_mfma_f32_16x16x32_bf16 v[50:53], a[92:95], v[58:61], v[50:53]
  s_waitcnt lgkmcnt(3)
  v_or3_b32 v6, v6, v79, v80
  v_bitop3_b32 v6, v6, v81, s0 bitop3:0xa8
  v_cmp_ne_u32 vcc, 0, v6
  v_mfma_f32_16x16x32_bf16 v[42:45], a[96:99], v[62:65], v[42:45]
  ds_read_b128 v[58:61], v94 offset:12288
  v_mfma_f32_16x16x32_bf16 v[46:49], a[100:103], v[62:65], v[46:49]
  s_cbranch_vccnz L_slow_35
L_ok_36:
  v_mfma_f32_16x16x32_bf16 v[50:53], a[104:107], v[62:65], v[50:53]
  s_add_u32 s49, s76, 20480
  buffer_load_dwordx4 v[180:183], v7, s[20:23], s49 offen offset:1024 sc1
  s_waitcnt lgkmcnt(3)
  v_mfma_f32_16x16x32_bf16 v[42:45], a[108:111], v[22:25], v[42:45]
  ds_read_b128 v[62:65], v95 offset:12288
  v_mfma_f32_16x16x32_bf16 v[46:49], a[112:115], v[22:25], v[46:49]
  s_waitcnt vmcnt(15)
  ds_read2st64_b32 v[74:75], v29 offset0:160 offset1:176
  v_mfma_f32_16x16x32_bf16 v[50:53], a[116:119], v[22:25], v[50:53]
  buffer_load_dwordx4 v[184:187], v7, s[20:23], s49 offen offset:2048 sc1
  s_waitcnt lgkmcnt(4)
  v_mfma_f32_16x16x32_bf16 v[42:45], a[120:123], v[18:21], v[42:45]
  ds_read_b128 v[22:25], v94 offset:14336
  v_mfma_f32_16x16x32_bf16 v[46:49], a[124:127], v[18:21], v[46:49]
  ds_read2st64_b32 v[76:77], v29 offset0:192 offset1:208
  ds_read_b128 v[78:81], v29 offset:57344
  v_mfma_f32_16x16x32_bf16 v[50:53], a[128:131], v[18:21], v[50:53]
  s_waitcnt lgkmcnt(6)
  v_mfma_f32_16x16x32_bf16 v[42:45], a[132:135], v[54:57], v[42:45]
  ds_read_b128 v[18:21], v95 offset:14336
  v_mfma_f32_16x16x32_bf16 v[46:49], a[136:139], v[54:57], v[46:49]
  buffer_load_dwordx4 v[188:191], v7, s[20:23], s49 offen offset:3072 sc1
  v_mfma_f32_16x16x32_bf16 v[50:53], a[140:143], v[54:57], v[50:53]
  s_waitcnt lgkmcnt(6)
  v_mfma_f32_16x16x32_bf16 v[42:45], a[144:147], v[58:61], v[42:45]
  ds_read_b128 v[54:57], v94 offset:16384
  s_add_u32 s49, s76, 24576
  v_mfma_f32_16x16x32_bf16 v[46:49], a[148:151], v[58:61], v[46:49]
  buffer_load_dwordx4 v[192:195], v7, s[20:23], s49 offen offset:0 sc1
  v_mfma_f32_16x16x32_bf16 v[50:53], a[152:155], v[58:61], v[50:53]
  s_waitcnt lgkmcnt(6)
  v_mfma_f32_16x16x32_bf16 v[42:45], a[156:159], v[62:65], v[42:45]
  ds_read_b128 v[58:61], v95 offset:16384
  s_waitcnt lgkmcnt(4)
  v_or3_b32 v6, v74, v75, v76
  v_mfma_f32_16x16x32_bf16 v[46:49], a[160:163], v[62:65], v[46:49]
  s_waitcnt lgkmcnt(3)
  v_or3_b32 v6, v6, v77, v78
  v_or3_b32 v6, v6, v79, v80
  v_mfma_f32_16x16x32_bf16 v[50:53], a[164:167], v[62:65], v[50:53]
  v_bitop3_b32 v6, v6, v81, s0 bitop3:0xa8
  v_cmp_ne_u32 vcc, 0, v6
  v_mfma_f32_16x16x32_bf16 v[42:45], a[168:171], v[22:25], v[42:45]
  ds_read_b128 v[62:65], v94 offset:18432
  v_mfma_f32_16x16x32_bf16 v[46:49], a[172:175], v[22:25], v[46:49]
  buffer_load_dwordx4 v[196:199], v7, s[20:23], s49 offen offset:1024 sc1
  v_mfma_f32_16x16x32_bf16 v[50:53], a[176:179], v[22:25], v[50:53]
  s_waitcnt lgkmcnt(3)
  v_mfma_f32_16x16x32_bf16 v[42:45], a[180:183], v[18:21], v[42:45]
  ds_read_b128 v[22:25], v95 offset:18432
  v_mfma_f32_16x16x32_bf16 v[46:49], a[184:187], v[18:21], v[46:49]
  buffer_load_dwordx4 v[200:203], v7, s[20:23], s49 offen offset:2048 sc1
  v_mfma_f32_16x16x32_bf16 v[50:53], a[188:191], v[18:21], v[50:53]
  s_cbranch_vccnz L_slow_38
L_ok_39:
  s_waitcnt lgkmcnt(3)
  v_mfma_f32_16x16x32_bf16 v[42:45], a[192:195], v[54:57], v[42:45]
  s_barrier
  ds_read_b128 v[18:21], v94 offset:20480
  v_mfma_f32_16x16x32_bf16 v[46:49], a[196:199], v[54:57], v[46:49]
  buffer_load_dwordx4 v[204:207], v7, s[20:23], s49 offen offset:3072 sc1
  v_mfma_f32_16x16x32_bf16 v[50:53], a[200:203], v[54:57], v[50:53]
  s_waitcnt lgkmcnt(3)
  v_mfma_f32_16x16x32_bf16 v[42:45], a[204:207], v[58:61], v[42:45]
  ds_read_b128 v[54:57], v95 offset:20480
  s_add_u32 s49, s76, 28672
  v_mfma_f32_16x16x32_bf16 v[46:49], a[208:211], v[58:61], v[46:49]
  buffer_load_dwordx4 v[208:211], v7, s[20:23], s49 offen offset:0 sc1
  v_mfma_f32_16x16x32_bf16 v[50:53], a[212:215], v[58:61], v[50:53]
  s_waitcnt lgkmcnt(3)
  v_mfma_f32_16x16x32_bf16 v[42:45], a[216:219], v[62:65], v[42:45]
  ds_read_b128 v[58:61], v94 offset:22528
  v_mfma_f32_16x16x32_bf16 v[46:49], a[220:223], v[62:65], v[46:49]
  v_mfma_f32_16x16x32_bf16 v[50:53], a[224:227], v[62:65], v[50:53]
  s_waitcnt lgkmcnt(3)
  v_mfma_f32_16x16x32_bf16 v[42:45], a[228:231], v[22:25], v[42:45]
  ds_read_b128 v[62:65], v95 offset:22528
  v_mfma_f32_16x16x32_bf16 v[46:49], a[232:235], v[22:25], v[46:49]
  buffer_load_dwordx4 v[212:215], v7, s[20:23], s49 offen offset:1024 sc1
  v_mfma_f32_16x16x32_bf16 v[50:53], a[236:239], v[22:25], v[50:53]
  s_waitcnt lgkmcnt(3)
  v_mfma_f32_16x16x32_bf16 v[74:77], a[0:3], v[18:21], v[30:33]
  ds_read_b128 v[22:25], v94 offset:24576
  v_add_u32 v29, 20480, v29
  s_waitcnt vmcnt(12)
  s_add_u32 s49, s76, 30720
  v_mfma_f32_16x16x32_bf16 v[78:81], a[4:7], v[18:21], v[34:37]
  ds_read2st64_b32 v[236:237], v29 offset0:160 offset1:176
  buffer_load_dwordx4 v[216:219], v7, s[20:23], s49 offen offset:0 sc1
  v_mfma_f32_16x16x32_bf16 v[82:85], a[8:11], v[18:21], v[38:41]
  ds_read2st64_b32 v[238:239], v29 offset0:192 offset1:208
  s_waitcnt lgkmcnt(5)
  v_mul_f32 v86, v42, v42
  v_mfma_f32_16x16x32_bf16 v[74:77], a[12:15], v[54:57], v[74:77]
  ds_read_b128 v[18:21], v95 offset:24576
  ds_read_b128 v[240:243], v29 offset:57344
  v_mul_f32 v87, v43, v43
  v_mul_f32 v88, v44, v44
  v_mfma_f32_16x16x32_bf16 v[78:81], a[16:19], v[54:57], v[78:81]
  buffer_load_dwordx4 v[220:223], v7, s[20:23], s49 offen offset:1024 sc1
  v_mul_f32 v89, v45, v45
  v_mfma_f32_16x16x32_bf16 v[82:85], a[20:23], v[54:57], v[82:85]
  s_waitcnt lgkmcnt(6)
  v_fma_f32 v86, v86, s70, v26
L_pad_pg4:
  s_cbranch_execz L_wret_12
  v_fma_f32 v87, v87, s70, v26
  v_fma_f32 v88, v88, s70, v26
  v_fma_f32 v89, v89, s70, v26
  v_mfma_f32_16x16x32_bf16 v[74:77], a[24:27], v[58:61], v[74:77]
  ds_read_b128 v[54:57], v94 offset:26624
  v_mul_f32 v86, v86, v42
  v_mul_f32 v87, v87, v43
  v_mfma_f32_16x16x32_bf16 v[78:81], a[28:31], v[58:61], v[78:81]
  buffer_load_dwordx4 v[224:227], v7, s[20:23], s49 offen offset:2048 sc1
  v_mul_f32 v88, v88, v44
  v_mul_f32 v89, v89, v45
  v_mfma_f32_16x16x32_bf16 v[82:85], a[32:35], v[58:61], v[82:85]
  s_waitcnt lgkmcnt(6)
  v_exp_f32 v86, v86
  v_mfma_f32_16x16x32_bf16 v[74:77], a[36:39], v[62:65], v[74:77]
  ds_read_b128 v[58:61], v95 offset:26624
  v_exp_f32 v87, v87
  v_exp_f32 v88, v88
  v_mfma_f32_16x16x32_bf16 v[78:81], a[40:43], v[62:65], v[78:81]
  buffer_load_dwordx4 v[228:231], v7, s[20:23], s49 offen offset:3072 sc1
  v_mfma_f32_16x16x32_bf16 v[82:85], a[44:47], v[62:65], v[82:85]
  s_waitcnt lgkmcnt(6)
  v_exp_f32 v89, v89
  v_add_f32 v86, 1.0, v86
  v_add_f32 v87, 1.0, v87
  v_add_f32 v88, 1.0, v88
  v_mfma_f32_16x16x32_bf16 v[74:77], a[48:51], v[22:25], v[74:77]
  ds_read_b128 v[62:65], v94 offset:28672
  s_add_u32 s49, s76, 34816
  v_add_f32 v89, 1.0, v89
  v_mfma_f32_16x16x32_bf16 v[78:81], a[52:55], v[22:25], v[78:81]
  buffer_load_dwordx4 v[232:235], v7, s[20:23], s49 offen offset:0 sc1
  v_rcp_f32 v86, v86
  v_mfma_f32_16x16x32_bf16 v[82:85], a[56:59], v[22:25], v[82:85]
  s_waitcnt lgkmcnt(5)
  v_or3_b32 v6, v236, v237, v238
  s_waitcnt lgkmcnt(3)
  v_or3_b32 v6, v6, v239, v240
  v_mfma_f32_16x16x32_bf16 v[74:77], a[60:63], v[18:21], v[74:77]
  ds_read_b128 v[22:25], v95 offset:28672
  s_add_u32 s49, s76, 40960
  s_add_u32 m0, s78, 0
  v_or3_b32 v6, v6, v241, v242
  v_rcp_f32 v87, v87
  v_mfma_f32_16x16x32_bf16 v[78:81], a[64:67], v[18:21], v[78:81]
  buffer_load_dwordx4 v7, s[20:23], s49 offen offset:0 sc1 lds
  v_rcp_f32 v88, v88
  v_mfma_f32_16x16x32_bf16 v[82:85], a[68:71], v[18:21], v[82:85]
  s_waitcnt lgkmcnt(3)
  v_bitop3_b32 v6, v6, v243, s0 bitop3:0xa8
  v_cmp_ne_u32 vcc, 0, v6
  v_rcp_f32 v89, v89
  v_mfma_f32_16x16x32_bf16 v[74:77], a[72:75], v[54:57], v[74:77]
  ds_read_b128 v[18:21], v94 offset:30720
  v_mul_f32 v86, v86, v42
  v_mul_f32 v87, v87, v43
  v_mfma_f32_16x16x32_bf16 v[78:81], a[76:79], v[54:57], v[78:81]
  buffer_load_dwordx4 v7, s[20:23], s49 offen offset:1024 sc1 lds
  v_mul_f32 v88, v88, v44
  v_mul_f32 v89, v89, v45
  v_mfma_f32_16x16x32_bf16 v[82:85], a[80:83], v[54:57], v[82:85]
  s_cbranch_vccnz L_slow_41
L_ok_42:
  v_cvt_pk_bf16_f32 v66, v86, v87
  s_waitcnt lgkmcnt(3)
  v_mfma_f32_16x16x32_bf16 v[74:77], a[84:87], v[58:61], v[74:77]
  ds_read_b128 v[54:57], v95 offset:30720
  v_cvt_pk_bf16_f32 v67, v88, v89
  v_mul_f32 v90, v46, v46
  v_mul_f32 v91, v47, v47
  v_mfma_f32_16x16x32_bf16 v[78:81], a[88:91], v[58:61], v[78:81]
  buffer_load_dwordx4 v7, s[20:23], s49 offen offset:2048 sc1 lds
  v_mov_b32 v3, s54
  s_waitcnt vmcnt(17)
  s_lshl2_add_u32 s61, s52, s53
  s_lshl_b32 s61, s61, 6
  s_add_u32 s61, s61, 65536
  v_mul_f32 v92, v48, v48
  v_mfma_f32_16x16x32_bf16 v[82:85], a[92:95], v[58:61], v[82:85]
  s_mov_b64 exec, 0xffff
  buffer_store_dword v3, v8, s[20:23], s61 offen sc1
  s_mov_b64 exec, -1
  v_mul_f32 v93, v49, v49
  v_fma_f32 v90, v90, s70, v26
  s_waitcnt lgkmcnt(3)
  v_mfma_f32_16x16x32_bf16 v[74:77], a[96:99], v[62:65], v[74:77]
  ds_read_b128 v[58:61], v94 offset:32768
  v_fma_f32 v91, v91, s70, v26
  v_fma_f32 v92, v92, s70, v26
  v_mfma_f32_16x16x32_bf16 v[78:81], a[100:103], v[62:65], v[78:81]
  buffer_load_dwordx4 v7, s[20:23], s49 offen offset:3072 sc1 lds
  v_fma_f32 v93, v93, s70, v26
  v_mul_f32 v90, v90, v46
  v_mfma_f32_16x16x32_bf16 v[82:85], a[104:107], v[62:65], v[82:85]
  s_waitcnt lgkmcnt(3)
  v_mul_f32 v91, v91, v47
  v_mul_f32 v92, v92, v48
  v_mul_f32 v93, v93, v49
  v_mfma_f32_16x16x32_bf16 v[74:77], a[108:111], v[22:25], v[74:77]
  ds_read_b128 v[62:65], v95 offset:32768
  s_add_u32 s49, s76, 45056
  s_add_u32 m0, s78, 4096
  v_exp_f32 v90, v90
  v_mfma_f32_16x16x32_bf16 v[78:81], a[112:115], v[22:25], v[78:81]
  buffer_load_dwordx4 v7, s[20:23], s49 offen offset:0 sc1 lds
  v_mfma_f32_16x16x32_bf16 v[82:85], a[116:119], v[22:25], v[82:85]
  s_waitcnt lgkmcnt(3)
  v_exp_f32 v91, v91
  v_exp_f32 v92, v92
  v_mfma_f32_16x16x32_bf16 v[74:77], a[120:123], v[18:21], v[74:77]
  ds_read_b128 v[22:25], v94 offset:34816
  v_exp_f32 v93, v93
  v_add_f32 v90, 1.0, v90
  v_add_f32 v91, 1.0, v91
  v_mfma_f32_16x16x32_bf16 v[78:81], a[124:127], v[18:21], v[78:81]
  buffer_load_dwordx4 v7, s[20:23], s49 offen offset:1024 sc1 lds
  v_add_f32 v92, 1.0, v92
  v_mfma_f32_16x16x32_bf16 v[82:85], a[128:131], v[18:21], v[82:85]
  s_waitcnt lgkmcnt(3)
  v_add_f32 v93, 1.0, v93
  v_rcp_f32 v90, v90
  v_mfma_f32_16x16x32_bf16 v[74:77], a[132:135], v[54:57], v[74:77]
  ds_read_b128 v[18:21], v95 offset:34816
  v_rcp_f32 v91, v91
  v_mfma_f32_16x16x32_bf16 v[78:81], a[136:139], v[54:57], v[78:81]
  buffer_load_dwordx4 v7, s[20:23], s49 offen offset:2048 sc1 lds
  v_rcp_f32 v92, v92
  v_mfma_f32_16x16x32_bf16 v[82:85], a[140:143], v[54:57], v[82:85]
  s_waitcnt lgkmcnt(3)
  v_rcp_f32 v93, v93
  v_mul_f32 v90, v90, v46
  v_mul_f32 v91, v91, v47
  v_mfma_f32_16x16x32_bf16 v[74:77], a[144:147], v[58:61], v[74:77]
  ds_read_b128 v[54:57], v94 offset:36864
  v_mul_f32 v92, v92, v48
  v_mul_f32 v93, v93, v49
  v_cvt_pk_bf16_f32 v68, v90, v91
  v_mfma_f32_16x16x32_bf16 v[78:81], a[148:151], v[58:61], v[78:81]
  buffer_load_dwordx4 v7, s[20:23], s49 offen offset:3072 sc1 lds
  v_cvt_pk_bf16_f32 v69, v92, v93
  v_mfma_f32_16x16x32_bf16 v[82:85], a[152:155], v[58:61], v[82:85]
  s_waitcnt lgkmcnt(3)
  v_mfma_f32_16x16x32_bf16 v[74:77], a[156:159], v[62:65], v[74:77]
  ds_read_b128 v[58:61], v95 offset:36864
  s_add_u32 s49, s76, 49152
  s_add_u32 m0, s78, 8192
  v_mfma_f32_16x16x32_bf16 v[78:81], a[160:163], v[62:65], v[78:81]
  buffer_load_dwordx4 v7, s[20:23], s49 offen offset:0 sc1 lds
  v_mfma_f32_16x16x32_bf16 v[82:85], a[164:167], v[62:65], v[82:85]
  s_add_u32 s62, s75, 0
  buffer_store_dwordx4 v[66:69], v12, s[20:23], s62 offen sc1
  s_waitcnt lgkmcnt(3)
  v_mul_f32 v86, v50, v50
  v_mfma_f32_16x16x32_bf16 v[74:77], a[168:171], v[22:25], v[74:77]
  ds_read_b128 v[62:65], v94 offset:38912
  v_mul_f32 v87, v51, v51
  v_mul_f32 v88, v52, v52
  v_mul_f32 v89, v53, v53
  v_mfma_f32_16x16x32_bf16 v[78:81], a[172:175], v[22:25], v[78:81]
  buffer_load_dwordx4 v7, s[20:23], s49 offen offset:1024 sc1 lds
  v_fma_f32 v86, v86, s70, v26
  v_mfma_f32_16x16x32_bf16 v[82:85], a[176:179], v[22:25], v[82:85]
  s_waitcnt lgkmcnt(3)
  v_fma_f32 v87, v87, s70, v26
  v_fma_f32 v88, v88, s70, v26
  v_fma_f32 v89, v89, s70, v26
  v_mul_f32 v86, v86, v50
  v_mfma_f32_16x16x32_bf16 v[74:77], a[180:183], v[18:21], v[74:77]
  ds_read_b128 v[22:25], v95 offset:38912
  s_add_u32 s49, s76, 51200
  s_add_u32 m0, s78, 10240
  v_mul_f32 v87, v87, v51
  v_mfma_f32_16x16x32_bf16 v[78:81], a[184:187], v[18:21], v[78:81]
  buffer_load_dwordx4 v7, s[20:23], s49 offen offset:0 sc1 lds
  v_mul_f32 v88, v88, v52
  v_mul_f32 v89, v89, v53
  v_mfma_f32_16x16x32_bf16 v[82:85], a[188:191], v[18:21], v[82:85]
  s_waitcnt lgkmcnt(3)
  v_exp_f32 v86, v86
  v_mfma_f32_16x16x32_bf16 v[74:77], a[192:195], v[54:57], v[74:77]
  v_add_u32 v94, 40960, v94
  ds_read_b128 v[18:21], v94 offset:0
  v_exp_f32 v87, v87
  v_mfma_f32_16x16x32_bf16 v[78:81], a[196:199], v[54:57], v[78:81]
  buffer_load_dwordx4 v7, s[20:23], s49 offen offset:1024 sc1 lds
  v_exp_f32 v88, v88
  v_mfma_f32_16x16x32_bf16 v[82:85], a[200:203], v[54:57], v[82:85]
  s_waitcnt lgkmcnt(3)
  v_exp_f32 v89, v89
  v_add_f32 v86, 1.0, v86
  v_add_f32 v87, 1.0, v87
  v_mfma_f32_16x16x32_bf16 v[74:77], a[204:207], v[58:61], v[74:77]
  v_add_u32 v95, 40960, v95
  ds_read_b128 v[54:57], v95 offset:0
  v_add_f32 v88, 1.0, v88
  v_mfma_f32_16x16x32_bf16 v[78:81], a[208:211], v[58:61], v[78:81]
  buffer_load_dwordx4 v7, s[20:23], s49 offen offset:2048 sc1 lds
  v_add_f32 v89, 1.0, v89
  v_mfma_f32_16x16x32_bf16 v[82:85], a[212:215], v[58:61], v[82:85]
  s_waitcnt lgkmcnt(3)
  v_rcp_f32 v86, v86
  v_rcp_f32 v87, v87
  v_mfma_f32_16x16x32_bf16 v[74:77], a[216:219], v[62:65], v[74:77]
  ds_read_b128 v[58:61], v94 offset:2048
  v_rcp_f32 v88, v88
  v_mfma_f32_16x16x32_bf16 v[78:81], a[220:223], v[62:65], v[78:81]
  v_rcp_f32 v89, v89
  v_mul_f32 v86, v86, v50
  v_mul_f32 v87, v87, v51
  v_mfma_f32_16x16x32_bf16 v[82:85], a[224:227], v[62:65], v[82:85]
  s_waitcnt lgkmcnt(3)
  v_mul_f32 v88, v88, v52
  v_mul_f32 v89, v89, v53
  v_cvt_pk_bf16_f32 v70, v86, v87
  v_cvt_pk_bf16_f32 v71, v88, v89
  v_mfma_f32_16x16x32_bf16 v[74:77], a[228:231], v[22:25], v[74:77]
  ds_read_b128 v[62:65], v95 offset:2048
  v_permlane32_swap_b32 v70, v72
  v_mfma_f32_16x16x32_bf16 v[78:81], a[232:235], v[22:25], v[78:81]
  v_permlane32_swap_b32 v71, v73
  v_mfma_f32_16x16x32_bf16 v[82:85], a[236:239], v[22:25], v[82:85]
  buffer_store_dwordx4 v[70:73], v13, s[20:23], s62 offen sc1
  s_waitcnt lgkmcnt(3)
  v_mfma_f32_16x16x32_bf16 v[42:45], a[0:3], v[18:21], v[30:33]
  ds_read_b128 v[22:25], v94 offset:4096
  v_mfma_f32_16x16x32_bf16 v[46:49], a[4:7], v[18:21], v[34:37]
  buffer_load_dwordx4 v7, s[20:23], s49 offen offset:3072 sc1 lds
  v_mfma_f32_16x16x32_bf16 v[50:53], a[8:11], v[18:21], v[38:41]
  s_waitcnt lgkmcnt(3)
  v_mul_f32 v86, v74, v74
  v_mul_f32 v87, v75, v75
  v_mul_f32 v88, v76, v76
  v_mfma_f32_16x16x32_bf16 v[42:45], a[12:15], v[54:57], v[42:45]
  ds_read_b128 v[18:21], v95 offset:4096
  s_add_u32 s49, s76, 55296
  s_add_u32 m0, s78, 14336
  v_mul_f32 v89, v77, v77
  v_mfma_f32_16x16x32_bf16 v[46:49], a[16:19], v[54:57], v[46:49]
  buffer_load_dwordx4 v7, s[20:23], s49 offen offset:0 sc1 lds
  v_fma_f32 v86, v86, s70, v26
  v_mfma_f32_16x16x32_bf16 v[50:53], a[20:23], v[54:57], v[50:53]
  s_waitcnt lgkmcnt(3)
  v_fma_f32 v87, v87, s70, v26
  v_fma_f32 v88, v88, s70, v26
  v_fma_f32 v89, v89, s70, v26
  v_mfma_f32_16x16x32_bf16 v[42:45], a[24:27], v[58:61], v[42:45]
  ds_read_b128 v[54:57], v94 offset:6144
  v_mul_f32 v86, v86, v74
  v_mul_f32 v87, v87, v75
  v_mfma_f32_16x16x32_bf16 v[46:49], a[28:31], v[58:61], v[46:49]
  v_mul_f32 v88, v88, v76
  v_mul_f32 v89, v89, v77
  v_mfma_f32_16x16x32_bf16 v[50:53], a[32:35], v[58:61], v[50:53]
  s_waitcnt lgkmcnt(3)
  v_exp_f32 v86, v86
  v_exp_f32 v87, v87
  v_mfma_f32_16x16x32_bf16 v[42:45], a[36:39], v[62:65], v[42:45]
  ds_read_b128 v[58:61], v95 offset:6144
  v_exp_f32 v88, v88
  v_mfma_f32_16x16x32_bf16 v[46:49], a[40:43], v[62:65], v[46:49]
  buffer_load_dwordx4 v7, s[20:23], s49 offen offset:1024 sc1 lds
  v_mfma_f32_16x16x32_bf16 v[50:53], a[44:47], v[62:65], v[50:53]
  s_waitcnt lgkmcnt(3)
  v_exp_f32 v89, v89
  v_add_f32 v86, 1.0, v86
  v_add_f32 v87, 1.0, v87
  v_mfma_f32_16x16x32_bf16 v[42:45], a[48:51], v[22:25], v[42:45]
  ds_read_b128 v[62:65], v94 offset:8192
  v_add_f32 v88, 1.0, v88
  v_add_f32 v89, 1.0, v89
  v_mfma_f32_16x16x32_bf16 v[46:49], a[52:55], v[22:25], v[46:49]
  v_rcp_f32 v86, v86
  v_rcp_f32 v87, v87
  v_mfma_f32_16x16x32_bf16 v[50:53], a[56:59], v[22:25], v[50:53]
  s_waitcnt lgkmcnt(3)
  v_rcp_f32 v88, v88
  v_mfma_f32_16x16x32_bf16 v[42:45], a[60:63], v[18:21], v[42:45]
  ds_read_b128 v[22:25], v95 offset:8192
  v_rcp_f32 v89, v89
  v_mul_f32 v86, v86, v74
  v_mfma_f32_16x16x32_bf16 v[46:49], a[64:67], v[18:21], v[46:49]
  buffer_load_dwordx4 v7, s[20:23], s49 offen offset:2048 sc1 lds
  v_mul_f32 v87, v87, v75
  v_mfma_f32_16x16x32_bf16 v[50:53], a[68:71], v[18:21], v[50:53]
  s_waitcnt lgkmcnt(3)
  v_mul_f32 v88, v88, v76
  v_mul_f32 v89, v89, v77
  v_cvt_pk_bf16_f32 v66, v86, v87
  v_mfma_f32_16x16x32_bf16 v[42:45], a[72:75], v[54:57], v[42:45]
  ds_read_b128 v[18:21], v94 offset:10240
  v_cvt_pk_bf16_f32 v67, v88, v89
  v_mul_f32 v90, v78, v78
  v_mfma_f32_16x16x32_bf16 v[46:49], a[76:79], v[54:57], v[46:49]
  buffer_load_dwordx4 v7, s[20:23], s49 offen offset:3072 sc1 lds
  v_mul_f32 v91, v79, v79
  v_mfma_f32_16x16x32_bf16 v[50:53], a[80:83], v[54:57], v[50:53]
  s_waitcnt lgkmcnt(3)
  v_mul_f32 v92, v80, v80
  v_mul_f32 v93, v81, v81
  v_fma_f32 v90, v90, s70, v26
  v_mfma_f32_16x16x32_bf16 v[42:45], a[84:87], v[58:61], v[42:45]
  ds_read_b128 v[54:57], v95 offset:10240
  v_fma_f32 v91, v91, s70, v26
  v_fma_f32 v92, v92, s70, v26
  v_mfma_f32_16x16x32_bf16 v[46:49], a[88:91], v[58:61], v[46:49]
  s_add_u32 s49, s76, 59392
  v_fma_f32 v93, v93, s70, v26
  v_mul_f32 v90, v90, v78
  v_mul_f32 v91, v91, v79
  v_mfma_f32_16x16x32_bf16 v[50:53], a[92:95], v[58:61], v[50:53]
  s_waitcnt lgkmcnt(3)
  v_mul_f32 v92, v92, v80
  v_mul_f32 v93, v93, v81
  v_mfma_f32_16x16x32_bf16 v[42:45], a[96:99], v[62:65], v[42:45]
  ds_read_b128 v[58:61], v94 offset:12288
  s_add_u32 m0, s78, 18432
  v_exp_f32 v90, v90
  v_mfma_f32_16x16x32_bf16 v[46:49], a[100:103], v[62:65], v[46:49]
  buffer_load_dwordx4 v7, s[20:23], s49 offen offset:0 sc1 lds
  v_exp_f32 v91, v91
  v_mfma_f32_16x16x32_bf16 v[50:53], a[104:107], v[62:65], v[50:53]
  s_waitcnt lgkmcnt(3)
  v_exp_f32 v92, v92
  v_mfma_f32_16x16x32_bf16 v[42:45], a[108:111], v[22:25], v[42:45]
  ds_read_b128 v[62:65], v95 offset:12288
  v_exp_f32 v93, v93
  v_add_f32 v90, 1.0, v90
  v_mfma_f32_16x16x32_bf16 v[46:49], a[112:115], v[22:25], v[46:49]
  buffer_load_dwordx4 v7, s[20:23], s49 offen offset:1024 sc1 lds
  v_add_f32 v91, 1.0, v91
  v_mfma_f32_16x16x32_bf16 v[50:53], a[116:119], v[22:25], v[50:53]
  s_waitcnt lgkmcnt(3)
  v_add_f32 v92, 1.0, v92
  v_add_f32 v93, 1.0, v93
  v_mfma_f32_16x16x32_bf16 v[42:45], a[120:123], v[18:21], v[42:45]
  ds_read_b128 v[22:25], v94 offset:14336
  v_rcp_f32 v90, v90
  v_mfma_f32_16x16x32_bf16 v[46:49], a[124:127], v[18:21], v[46:49]
  s_add_u32 s49, s76, 34816
  v_rcp_f32 v91, v91
  v_rcp_f32 v92, v92
  v_mfma_f32_16x16x32_bf16 v[50:53], a[128:131], v[18:21], v[50:53]
  s_waitcnt lgkmcnt(3)
  v_rcp_f32 v93, v93
  v_mul_f32 v90, v90, v78
  v_mfma_f32_16x16x32_bf16 v[42:45], a[132:135], v[54:57], v[42:45]
  ds_read_b128 v[18:21], v95 offset:14336
  v_mul_f32 v91, v91, v79
  v_mul_f32 v92, v92, v80
  v_mfma_f32_16x16x32_bf16 v[46:49], a[136:139], v[54:57], v[46:49]
  buffer_load_dwordx4 v[236:239], v7, s[20:23], s49 offen offset:1024 sc1
  v_mul_f32 v93, v93, v81
  v_mfma_f32_16x16x32_bf16 v[50:53], a[140:143], v[54:57], v[50:53]
  s_waitcnt lgkmcnt(3)
  v_cvt_pk_bf16_f32 v68, v90, v91
  v_cvt_pk_bf16_f32 v69, v92, v93
  v_mfma_f32_16x16x32_bf16 v[42:45], a[144:147], v[58:61], v[42:45]
  ds_read_b128 v[54:57], v94 offset:16384
  v_mfma_f32_16x16x32_bf16 v[46:49], a[148:151], v[58:61], v[46:49]
  buffer_load_dwordx4 v[240:243], v7, s[20:23], s49 offen offset:2048 sc1
  v_mfma_f32_16x16x32_bf16 v[50:53], a[152:155], v[58:61], v[50:53]
  s_add_u32 s62, s75, 49152
  buffer_store_dwordx4 v[66:69], v12, s[20:23], s62 offen sc1
  s_waitcnt lgkmcnt(3)
  v_mfma_f32_16x16x32_bf16 v[42:45], a[156:159], v[62:65], v[42:45]
  ds_read_b128 v[58:61], v95 offset:16384
  v_mul_f32 v86, v82, v82
  v_mul_f32 v87, v83, v83
  v_mfma_f32_16x16x32_bf16 v[46:49], a[160:163], v[62:65], v[46:49]
  v_mul_f32 v88, v84, v84
  v_mul_f32 v89, v85, v85
  v_fma_f32 v86, v86, s70, v26
  v_mfma_f32_16x16x32_bf16 v[50:53], a[164:167], v[62:65], v[50:53]
  s_waitcnt lgkmcnt(3)
  v_fma_f32 v87, v87, s70, v26
  v_fma_f32 v88, v88, s70, v26
  v_fma_f32 v89, v89, s70, v26
  v_mfma_f32_16x16x32_bf16 v[42:45], a[168:171], v[22:25], v[42:45]
  ds_read_b128 v[62:65], v94 offset:18432
  v_mul_f32 v86, v86, v82
  v_mul_f32 v87, v87, v83
  v_mfma_f32_16x16x32_bf16 v[46:49], a[172:175], v[22:25], v[46:49]
  buffer_load_dwordx4 v[244:247], v7, s[20:23], s49 offen offset:3072 sc1
  v_mul_f32 v88, v88, v84
  v_mfma_f32_16x16x32_bf16 v[50:53], a[176:179], v[22:25], v[50:53]
  s_waitcnt lgkmcnt(3)
  v_mul_f32 v89, v89, v85
  v_exp_f32 v86, v86
  v_mfma_f32_16x16x32_bf16 v[42:45], a[180:183], v[18:21], v[42:45]
  ds_read_b128 v[22:25], v95 offset:18432
  s_add_u32 s49, s76, 38912
  v_mfma_f32_16x16x32_bf16 v[46:49], a[184:187], v[18:21], v[46:49]
  buffer_load_dwordx4 v[248:251], v7, s[20:23], s49 offen offset:0 sc1
  v_exp_f32 v87, v87
  v_mfma_f32_16x16x32_bf16 v[50:53], a[188:191], v[18:21], v[50:53]
  s_waitcnt lgkmcnt(3)
  v_exp_f32 v88, v88
  v_mfma_f32_16x16x32_bf16 v[42:45], a[192:195], v[54:57], v[42:45]
  s_barrier
  ds_read_b128 v[18:21], v94 offset:20480
  v_exp_f32 v89, v89
  v_add_f32 v86, 1.0, v86
  v_mfma_f32_16x16x32_bf16 v[46:49], a[196:199], v[54:57], v[46:49]
  v_add_f32 v87, 1.0, v87
  v_add_f32 v88, 1.0, v88
  v_add_f32 v89, 1.0, v89
  v_mfma_f32_16x16x32_bf16 v[50:53], a[200:203], v[54:57], v[50:53]
  s_waitcnt lgkmcnt(3)
  v_rcp_f32 v86, v86
  v_mfma_f32_16x16x32_bf16 v[42:45], a[204:207], v[58:61], v[42:45]
  ds_read_b128 v[54:57], v95 offset:20480
  v_rcp_f32 v87, v87
  v_mfma_f32_16x16x32_bf16 v[46:49], a[208:211], v[58:61], v[46:49]
  buffer_load_dwordx4 v[252:255], v7, s[20:23], s49 offen offset:1024 sc1
  v_rcp_f32 v88, v88
  v_mfma_f32_16x16x32_bf16 v[50:53], a[212:215], v[58:61], v[50:53]
  s_waitcnt lgkmcnt(3)
  v_rcp_f32 v89, v89
  v_mul_f32 v86, v86, v82
  v_mfma_f32_16x16x32_bf16 v[42:45], a[216:219], v[62:65], v[42:45]
  ds_read_b128 v[58:61], v94 offset:22528
  v_mul_f32 v87, v87, v83
  v_mul_f32 v88, v88, v84
  v_mfma_f32_16x16x32_bf16 v[46:49], a[220:223], v[62:65], v[46:49]
  v_mul_f32 v89, v89, v85
  v_cvt_pk_bf16_f32 v70, v86, v87
  v_cvt_pk_bf16_f32 v71, v88, v89
  v_mfma_f32_16x16x32_bf16 v[50:53], a[224:227], v[62:65], v[50:53]
  s_waitcnt lgkmcnt(3)
  v_permlane32_swap_b32 v70, v72
  v_mfma_f32_16x16x32_bf16 v[42:45], a[228:231], v[22:25], v[42:45]
  ds_read_b128 v[62:65], v95 offset:22528
  v_permlane32_swap_b32 v71, v73
  v_mfma_f32_16x16x32_bf16 v[46:49], a[232:235], v[22:25], v[46:49]
  v_mfma_f32_16x16x32_bf16 v[50:53], a[236:239], v[22:25], v[50:53]
  buffer_store_dwordx4 v[70:73], v13, s[20:23], s62 offen sc1
  s_waitcnt lgkmcnt(3)
  v_mfma_f32_16x16x32_bf16 v[74:77], a[0:3], v[18:21], v[30:33]
  ds_read_b128 v[22:25], v94 offset:24576
  v_mfma_f32_16x16x32_bf16 v[78:81], a[4:7], v[18:21], v[34:37]
  s_waitcnt vmcnt(14)
  s_add_u32 s48, s3, 0
  buffer_load_dwordx4 a[0:3], v7, s[20:23], s48 offen offset:0 sc1
  v_mfma_f32_16x16x32_bf16 v[82:85], a[8:11], v[18:21], v[38:41]
  s_waitcnt lgkmcnt(3)
  v_mul_f32 v86, v42, v42
  v_mul_f32 v87, v43, v43
  v_mul_f32 v88, v44, v44
  v_mfma_f32_16x16x32_bf16 v[74:77], a[12:15], v[54:57], v[74:77]
  ds_read_b128 v[18:21], v95 offset:24576
  v_mul_f32 v89, v45, v45
  v_fma_f32 v86, v86, s70, v26
  v_mfma_f32_16x16x32_bf16 v[78:81], a[16:19], v[54:57], v[78:81]
  v_fma_f32 v87, v87, s70, v26
  v_fma_f32 v88, v88, s70, v26
  v_fma_f32 v89, v89, s70, v26
  v_mfma_f32_16x16x32_bf16 v[82:85], a[20:23], v[54:57], v[82:85]
  s_waitcnt lgkmcnt(3)
  v_mul_f32 v86, v86, v42
  v_mul_f32 v87, v87, v43
  v_mul_f32 v88, v88, v44
  v_mfma_f32_16x16x32_bf16 v[74:77], a[24:27], v[58:61], v[74:77]
  ds_read_b128 v[54:57], v94 offset:26624
  v_mul_f32 v89, v89, v45
  v_mfma_f32_16x16x32_bf16 v[78:81], a[28:31], v[58:61], v[78:81]
  buffer_load_dwordx4 a[4:7], v7, s[20:23], s48 offen offset:1024 sc1
  v_exp_f32 v86, v86
  v_mfma_f32_16x16x32_bf16 v[82:85], a[32:35], v[58:61], v[82:85]
  s_waitcnt lgkmcnt(3)
  v_exp_f32 v87, v87
  v_mfma_f32_16x16x32_bf16 v[74:77], a[36:39], v[62:65], v[74:77]
  ds_read_b128 v[58:61], v95 offset:26624
  s_lshl_b32 s61, s56, 11
  s_add_u32 s61, s61, 65536
  v_exp_f32 v88, v88
  v_mfma_f32_16x16x32_bf16 v[78:81], a[40:43], v[62:65], v[78:81]
  buffer_load_dword v2, v9, s[20:23], s61 offen sc1
  v_mfma_f32_16x16x32_bf16 v[82:85], a[44:47], v[62:65], v[82:85]
  buffer_load_dwordx4 a[8:11], v7, s[20:23], s48 offen offset:2048 sc1
  s_waitcnt lgkmcnt(3)
  v_exp_f32 v89, v89
  v_mfma_f32_16x16x32_bf16 v[74:77], a[48:51], v[22:25], v[74:77]
  ds_read_b128 v[62:65], v94 offset:28672
  v_add_f32 v86, 1.0, v86
  v_add_f32 v87, 1.0, v87
  v_mfma_f32_16x16x32_bf16 v[78:81], a[52:55], v[22:25], v[78:81]
  buffer_load_dwordx4 a[12:15], v7, s[20:23], s48 offen offset:3072 sc1
  v_add_f32 v88, 1.0, v88
  v_add_f32 v89, 1.0, v89
  v_mfma_f32_16x16x32_bf16 v[82:85], a[56:59], v[22:25], v[82:85]
  s_waitcnt lgkmcnt(3)
  v_rcp_f32 v86, v86
  v_mfma_f32_16x16x32_bf16 v[74:77], a[60:63], v[18:21], v[74:77]
  ds_read_b128 v[22:25], v95 offset:28672
  v_rcp_f32 v87, v87
  v_mfma_f32_16x16x32_bf16 v[78:81], a[64:67], v[18:21], v[78:81]
  s_add_u32 s48, s5, 0
  v_rcp_f32 v88, v88
  v_rcp_f32 v89, v89
  v_mfma_f32_16x16x32_bf16 v[82:85], a[68:71], v[18:21], v[82:85]
  s_waitcnt lgkmcnt(3)
  v_mul_f32 v86, v86, v42
  v_mul_f32 v87, v87, v43
  v_mul_f32 v88, v88, v44
  v_mfma_f32_16x16x32_bf16 v[74:77], a[72:75], v[54:57], v[74:77]
  ds_read_b128 v[18:21], v94 offset:30720
  v_mul_f32 v89, v89, v45
  v_cvt_pk_bf16_f32 v66, v86, v87
  v_mfma_f32_16x16x32_bf16 v[78:81], a[76:79], v[54:57], v[78:81]
  buffer_load_dwordx4 a[16:19], v7, s[20:23], s48 offen offset:0 sc1
  v_cvt_pk_bf16_f32 v67, v88, v89
  v_mfma_f32_16x16x32_bf16 v[82:85], a[80:83], v[54:57], v[82:85]
  s_waitcnt lgkmcnt(3)
  v_mul_f32 v90, v46, v46
  v_mul_f32 v91, v47, v47
  v_mul_f32 v92, v48, v48
  v_mfma_f32_16x16x32_bf16 v[74:77], a[84:87], v[58:61], v[74:77]
  ds_read_b128 v[54:57], v95 offset:30720
  v_mul_f32 v93, v49, v49
  v_fma_f32 v90, v90, s70, v26
  v_mfma_f32_16x16x32_bf16 v[78:81], a[88:91], v[58:61], v[78:81]
  buffer_load_dwordx4 a[20:23], v7, s[20:23], s48 offen offset:1024 sc1
  v_fma_f32 v91, v91, s70, v26
  v_mfma_f32_16x16x32_bf16 v[82:85], a[92:95], v[58:61], v[82:85]
  s_waitcnt lgkmcnt(3)
  v_fma_f32 v92, v92, s70, v26
  v_fma_f32 v93, v93, s70, v26
  v_mul_f32 v90, v90, v46
  v_mfma_f32_16x16x32_bf16 v[74:77], a[96:99], v[62:65], v[74:77]
  ds_read_b128 v[58:61], v94 offset:32768
  v_mul_f32 v91, v91, v47
  v_mul_f32 v92, v92, v48
  v_mfma_f32_16x16x32_bf16 v[78:81], a[100:103], v[62:65], v[78:81]
  buffer_load_dwordx4 a[24:27], v7, s[20:23], s48 offen offset:2048 sc1
  v_mul_f32 v93, v93, v49
  v_mfma_f32_16x16x32_bf16 v[82:85], a[104:107], v[62:65], v[82:85]
  s_waitcnt lgkmcnt(3)
  v_exp_f32 v90, v90
  v_exp_f32 v91, v91
  v_mfma_f32_16x16x32_bf16 v[74:77], a[108:111], v[22:25], v[74:77]
  ds_read_b128 v[62:65], v95 offset:32768
  v_exp_f32 v92, v92
  v_mfma_f32_16x16x32_bf16 v[78:81], a[112:115], v[22:25], v[78:81]
  v_exp_f32 v93, v93
  v_add_f32 v90, 1.0, v90
  v_mfma_f32_16x16x32_bf16 v[82:85], a[116:119], v[22:25], v[82:85]
  s_waitcnt lgkmcnt(3)
  v_add_f32 v91, 1.0, v91
  v_add_f32 v92, 1.0, v92
  v_add_f32 v93, 1.0, v93
  v_mfma_f32_16x16x32_bf16 v[74:77], a[120:123], v[18:21], v[74:77]
  ds_read_b128 v[22:25], v94 offset:34816
  v_rcp_f32 v90, v90
  v_mfma_f32_16x16x32_bf16 v[78:81], a[124:127], v[18:21], v[78:81]
  buffer_load_dwordx4 a[28:31], v7, s[20:23], s48 offen offset:3072 sc1
  v_mfma_f32_16x16x32_bf16 v[82:85], a[128:131], v[18:21], v[82:85]
  s_waitcnt lgkmcnt(3)
  v_rcp_f32 v91, v91
  v_rcp_f32 v92, v92
  v_mfma_f32_16x16x32_bf16 v[74:77], a[132:135], v[54:57], v[74:77]
  ds_read_b128 v[18:21], v95 offset:34816
  s_add_u32 s48, s7, 0
  v_mfma_f32_16x16x32_bf16 v[78:81], a[136:139], v[54:57], v[78:81]
  buffer_load_dwordx4 a[32:35], v7, s[20:23], s48 offen offset:0 sc1
  v_rcp_f32 v93, v93
  v_mfma_f32_16x16x32_bf16 v[82:85], a[140:143], v[54:57], v[82:85]
  s_waitcnt lgkmcnt(3)
  v_mul_f32 v90, v90, v46
  v_mul_f32 v91, v91, v47
  v_mul_f32 v92, v92, v48
  v_mfma_f32_16x16x32_bf16 v[74:77], a[144:147], v[58:61], v[74:77]
  ds_read_b128 v[54:57], v94 offset:36864
  v_mul_f32 v93, v93, v49
  v_cvt_pk_bf16_f32 v68, v90, v91
  v_cvt_pk_bf16_f32 v69, v92, v93
  v_mfma_f32_16x16x32_bf16 v[78:81], a[148:151], v[58:61], v[78:81]
  buffer_load_dwordx4 a[36:39], v7, s[20:23], s48 offen offset:1024 sc1
  v_mfma_f32_16x16x32_bf16 v[82:85], a[152:155], v[58:61], v[82:85]
  s_waitcnt lgkmcnt(3)
  v_mfma_f32_16x16x32_bf16 v[74:77], a[156:159], v[62:65], v[74:77]
  ds_read_b128 v[58:61], v95 offset:36864
  v_mfma_f32_16x16x32_bf16 v[78:81], a[160:163], v[62:65], v[78:81]
  s_add_u32 s62, s75, 98304
  buffer_store_dwordx4 v[66:69], v12, s[20:23], s62 offen sc1
  v_mfma_f32_16x16x32_bf16 v[82:85], a[164:167], v[62:65], v[82:85]
  s_waitcnt lgkmcnt(3)
  v_mul_f32 v86, v50, v50
  v_mul_f32 v87, v51, v51
  v_mul_f32 v88, v52, v52
  v_mfma_f32_16x16x32_bf16 v[74:77], a[168:171], v[22:25], v[74:77]
  ds_read_b128 v[62:65], v94 offset:38912
  v_mul_f32 v89, v53, v53
  v_fma_f32 v86, v86, s70, v26
  v_mfma_f32_16x16x32_bf16 v[78:81], a[172:175], v[22:25], v[78:81]
  buffer_load_dwordx4 a[40:43], v7, s[20:23], s48 offen offset:2048 sc1
  v_fma_f32 v87, v87, s70, v26
  v_mfma_f32_16x16x32_bf16 v[82:85], a[176:179], v[22:25], v[82:85]
  s_waitcnt lgkmcnt(3)
  v_fma_f32 v88, v88, s70, v26
  v_fma_f32 v89, v89, s70, v26
  v_mul_f32 v86, v86, v50
  v_mfma_f32_16x16x32_bf16 v[74:77], a[180:183], v[18:21], v[74:77]
  ds_read_b128 v[22:25], v95 offset:38912
  v_mul_f32 v87, v87, v51
  v_mul_f32 v88, v88, v52
  v_mfma_f32_16x16x32_bf16 v[78:81], a[184:187], v[18:21], v[78:81]
  buffer_load_dwordx4 a[44:47], v7, s[20:23], s48 offen offset:3072 sc1
  v_mul_f32 v89, v89, v53
  v_mfma_f32_16x16x32_bf16 v[82:85], a[188:191], v[18:21], v[82:85]
  s_waitcnt lgkmcnt(3)
  v_exp_f32 v86, v86
  v_mfma_f32_16x16x32_bf16 v[74:77], a[192:195], v[54:57], v[74:77]
  v_exp_f32 v87, v87
  v_exp_f32 v88, v88
  v_mfma_f32_16x16x32_bf16 v[78:81], a[196:199], v[54:57], v[78:81]
  v_exp_f32 v89, v89
  v_add_f32 v86, 1.0, v86
  v_add_f32 v87, 1.0, v87
  v_mfma_f32_16x16x32_bf16 v[82:85], a[200:203], v[54:57], v[82:85]
  s_waitcnt lgkmcnt(2)
  v_add_f32 v88, 1.0, v88
  v_add_f32 v89, 1.0, v89
  v_mfma_f32_16x16x32_bf16 v[74:77], a[204:207], v[58:61], v[74:77]
  v_rcp_f32 v86, v86
  v_rcp_f32 v87, v87
  v_mfma_f32_16x16x32_bf16 v[78:81], a[208:211], v[58:61], v[78:81]
  s_waitcnt vmcnt(11)
  v_cmp_ne_u32 vcc, s54, v2
  v_rcp_f32 v88, v88
  v_mfma_f32_16x16x32_bf16 v[82:85], a[212:215], v[58:61], v[82:85]
  s_waitcnt lgkmcnt(1)
  v_rcp_f32 v89, v89
  v_mul_f32 v86, v86, v50
  v_mfma_f32_16x16x32_bf16 v[74:77], a[216:219], v[62:65], v[74:77]
  s_cbranch_vccnz L_slow_44
L_ok_45:
  v_mul_f32 v87, v87, v51
  v_mfma_f32_16x16x32_bf16 v[78:81], a[220:223], v[62:65], v[78:81]
  v_mul_f32 v88, v88, v52
  v_mul_f32 v89, v89, v53
  v_cvt_pk_bf16_f32 v70, v86, v87
  v_mfma_f32_16x16x32_bf16 v[82:85], a[224:227], v[62:65], v[82:85]
  s_waitcnt lgkmcnt(0)
  v_cvt_pk_bf16_f32 v71, v88, v89
  v_permlane32_swap_b32 v70, v72
  v_mfma_f32_16x16x32_bf16 v[74:77], a[228:231], v[22:25], v[74:77]
  v_permlane32_swap_b32 v71, v73
  v_mfma_f32_16x16x32_bf16 v[78:81], a[232:235], v[22:25], v[78:81]
  v_mfma_f32_16x16x32_bf16 v[82:85], a[236:239], v[22:25], v[82:85]
  buffer_store_dwordx4 v[70:73], v13, s[20:23], s62 offen sc1
  s_nop 3
  v_mul_f32 v86, v74, v74
  v_mul_f32 v87, v75, v75
  v_mul_f32 v88, v76, v76
  v_mul_f32 v89, v77, v77
  v_fma_f32 v86, v86, s70, v26
  v_fma_f32 v87, v87, s70, v26
  v_fma_f32 v88, v88, s70, v26
  v_fma_f32 v89, v89, s70, v26
  v_mul_f32 v86, v86, v74
  v_mul_f32 v87, v87, v75
  v_mul_f32 v88, v88, v76
  v_mul_f32 v89, v89, v77
  v_exp_f32 v86, v86
  v_exp_f32 v87, v87
  v_exp_f32 v88, v88
  s_waitcnt vmcnt(10)
L_pad_pg5:
  s_cbranch_execz L_wret_25
  v_accvgpr_read_b32 v6, a15
  v_accvgpr_read_b32 v3, a11
  v_accvgpr_read_b32 v2, a7
  v_max3_u32 v6, v6, v2, v3
  v_accvgpr_read_b32 v3, a3
  v_max_u32 v6, v6, v3
  v_cmp_eq_u32 vcc, -1, v6
  s_cbranch_vccnz L_slow_47
L_ok_48:
  v_mfma_f32_16x16x32_bf16 v[28:31], v[96:99], a[0:3], 0
  v_add_u32 v95, s78, v7
  ds_read_b128 a[144:147], v95 offset:0
  v_mfma_f32_16x16x32_bf16 v[28:31], v[116:119], a[4:7], v[28:31]
  ds_read_b128 a[148:151], v95 offset:1024
  s_add_u32 s48, s3, 49152
  v_exp_f32 v89, v89
  v_mfma_f32_16x16x32_bf16 v[28:31], v[136:139], a[8:11], v[28:31]
  buffer_load_dwordx4 a[48:51], v7, s[20:23], s48 offen offset:0 sc1
  v_add_f32 v86, 1.0, v86
  v_add_f32 v87, 1.0, v87
  v_mfma_f32_16x16x32_bf16 v[28:31], v[156:159], a[12:15], v[28:31]
  ds_read_b128 a[152:155], v95 offset:2048
  v_add_f32 v88, 1.0, v88
  v_add_f32 v89, 1.0, v89
  v_mfma_f32_16x16x32_bf16 v[32:35], v[100:103], a[0:3], 0
  ds_read_b128 a[156:159], v95 offset:3072
  v_rcp_f32 v86, v86
  v_mfma_f32_16x16x32_bf16 v[32:35], v[120:123], a[4:7], v[32:35]
  buffer_load_dwordx4 a[52:55], v7, s[20:23], s48 offen offset:1024 sc1
  v_rcp_f32 v87, v87
  v_mfma_f32_16x16x32_bf16 v[32:35], v[140:143], a[8:11], v[32:35]
  ds_read_b128 a[160:163], v95 offset:4096
  v_rcp_f32 v88, v88
  v_mfma_f32_16x16x32_bf16 v[32:35], v[160:163], a[12:15], v[32:35]
  ds_read_b128 a[164:167], v95 offset:5120
  v_rcp_f32 v89, v89
  v_mul_f32 v86, v86, v74
  v_mfma_f32_16x16x32_bf16 v[36:39], v[104:107], a[0:3], 0
  v_mul_f32 v87, v87, v75
  v_mul_f32 v88, v88, v76
  v_mul_f32 v89, v89, v77
  v_cvt_pk_bf16_f32 v66, v86, v87
  v_mfma_f32_16x16x32_bf16 v[36:39], v[124:127], a[4:7], v[36:39]
  ds_read_b128 a[168:171], v95 offset:6144
  v_cvt_pk_bf16_f32 v67, v88, v89
  v_mul_f32 v90, v78, v78
  v_mfma_f32_16x16x32_bf16 v[36:39], v[144:147], a[8:11], v[36:39]
  ds_read_b128 a[172:175], v95 offset:7168
  v_mul_f32 v91, v79, v79
  v_mul_f32 v92, v80, v80
  v_mul_f32 v93, v81, v81
  v_mfma_f32_16x16x32_bf16 v[36:39], v[164:167], a[12:15], v[36:39]
  buffer_load_dwordx4 a[56:59], v7, s[20:23], s48 offen offset:2048 sc1
  v_fma_f32 v90, v90, s70, v26
  v_mfma_f32_16x16x32_bf16 v[40:43], v[108:111], a[0:3], 0
  ds_read_b128 a[176:179], v95 offset:8192
  v_fma_f32 v91, v91, s70, v26
  v_fma_f32 v92, v92, s70, v26
  v_fma_f32 v93, v93, s70, v26
  v_mfma_f32_16x16x32_bf16 v[40:43], v[128:131], a[4:7], v[40:43]
  ds_read_b128 a[180:183], v95 offset:9216
  s_waitcnt vmcnt(9)
  v_accvgpr_read_b32 v6, a31
  v_mul_f32 v90, v90, v78
  v_mfma_f32_16x16x32_bf16 v[40:43], v[148:151], a[8:11], v[40:43]
  buffer_load_dwordx4 a[60:63], v7, s[20:23], s48 offen offset:3072 sc1
  v_accvgpr_read_b32 v3, a27
  v_mul_f32 v91, v91, v79
  v_mul_f32 v92, v92, v80
  v_mfma_f32_16x16x32_bf16 v[40:43], v[168:171], a[12:15], v[40:43]
  ds_read_b128 a[184:187], v95 offset:10240
  v_accvgpr_read_b32 v2, a23
  v_max3_u32 v6, v6, v2, v3
  v_mul_f32 v93, v93, v81
  v_mfma_f32_16x16x32_bf16 v[44:47], v[112:115], a[0:3], 0
  ds_read_b128 a[188:191], v95 offset:11264
  s_add_u32 s48, s5, 49152
  v_mfma_f32_16x16x32_bf16 v[44:47], v[132:135], a[4:7], v[44:47]
  buffer_load_dwordx4 a[64:67], v7, s[20:23], s48 offen offset:0 sc1
  v_accvgpr_read_b32 v3, a19
  v_exp_f32 v90, v90
  v_mfma_f32_16x16x32_bf16 v[44:47], v[152:155], a[8:11], v[44:47]
  ds_read_b128 a[192:195], v95 offset:12288
  v_max_u32 v6, v6, v3
  v_cmp_eq_u32 vcc, -1, v6
  v_exp_f32 v91, v91
  v_mfma_f32_16x16x32_bf16 v[44:47], v[172:175], a[12:15], v[44:47]
  s_cbranch_vccnz L_slow_50
L_ok_51:
  v_exp_f32 v92, v92
  v_mfma_f32_16x16x32_bf16 v[28:31], v[176:179], a[16:19], v[28:31]
  ds_read_b128 a[196:199], v95 offset:13312
  v_exp_f32 v93, v93
  v_mfma_f32_16x16x32_bf16 v[28:31], v[196:199], a[20:23], v[28:31]
  ds_read_b128 a[200:203], v95 offset:14336
  v_add_f32 v90, 1.0, v90
  v_add_f32 v91, 1.0, v91
  v_add_f32 v92, 1.0, v92
  v_mfma_f32_16x16x32_bf16 v[28:31], v[216:219], a[24:27], v[28:31]
  ds_read_b128 a[204:207], v95 offset:15360
  v_add_f32 v93, 1.0, v93
  v_mfma_f32_16x16x32_bf16 v[28:31], v[236:239], a[28:31], v[28:31]
  buffer_load_dwordx4 a[68:71], v7, s[20:23], s48 offen offset:1024 sc1
  v_rcp_f32 v90, v90
  v_mfma_f32_16x16x32_bf16 v[32:35], v[180:183], a[16:19], v[32:35]
  ds_read_b128 a[208:211], v95 offset:16384
  v_rcp_f32 v91, v91
  v_mfma_f32_16x16x32_bf16 v[32:35], v[200:203], a[20:23], v[32:35]
  ds_read_b128 a[212:215], v95 offset:17408
  v_rcp_f32 v92, v92
  v_rcp_f32 v93, v93
  v_mfma_f32_16x16x32_bf16 v[32:35], v[220:223], a[24:27], v[32:35]
  buffer_load_dwordx4 a[72:75], v7, s[20:23], s48 offen offset:2048 sc1
  v_mul_f32 v90, v90, v78
  v_mfma_f32_16x16x32_bf16 v[32:35], v[240:243], a[28:31], v[32:35]
  ds_read_b128 a[216:219], v95 offset:18432
  v_mul_f32 v91, v91, v79
  v_mul_f32 v92, v92, v80
  v_mul_f32 v93, v93, v81
  v_mfma_f32_16x16x32_bf16 v[36:39], v[184:187], a[16:19], v[36:39]
  ds_read_b128 a[220:223], v95 offset:19456
  v_cvt_pk_bf16_f32 v68, v90, v91
  v_cvt_pk_bf16_f32 v69, v92, v93
  v_mfma_f32_16x16x32_bf16 v[36:39], v[204:207], a[20:23], v[36:39]
  buffer_load_dwordx4 a[76:79], v7, s[20:23], s48 offen offset:3072 sc1
  v_mfma_f32_16x16x32_bf16 v[36:39], v[224:227], a[24:27], v[36:39]
  v_mfma_f32_16x16x32_bf16 v[36:39], v[244:247], a[28:31], v[36:39]
  s_add_u32 s62, s75, 147456
  buffer_store_dwordx4 v[66:69], v12, s[20:23], s62 offen sc1
  v_mfma_f32_16x16x32_bf16 v[40:43], v[188:191], a[16:19], v[40:43]
  s_add_u32 s48, s7, 49152
  v_mul_f32 v86, v82, v82
  v_mul_f32 v87, v83, v83
  v_mul_f32 v88, v84, v84
  v_mul_f32 v89, v85, v85
  v_mfma_f32_16x16x32_bf16 v[40:43], v[208:211], a[20:23], v[40:43]
  buffer_load_dwordx4 a[80:83], v7, s[20:23], s48 offen offset:0 sc1
  v_fma_f32 v86, v86, s70, v26
  v_mfma_f32_16x16x32_bf16 v[40:43], v[228:231], a[24:27], v[40:43]
  s_waitcnt vmcnt(11)
  v_accvgpr_read_b32 v6, a47
  v_accvgpr_read_b32 v3, a43
  v_fma_f32 v87, v87, s70, v26
  v_fma_f32 v88, v88, s70, v26
  v_mfma_f32_16x16x32_bf16 v[40:43], v[248:251], a[28:31], v[40:43]
  v_accvgpr_read_b32 v2, a39
  v_max3_u32 v6, v6, v2, v3
  v_fma_f32 v89, v89, s70, v26
  v_mfma_f32_16x16x32_bf16 v[44:47], v[192:195], a[16:19], v[44:47]
  v_accvgpr_read_b32 v3, a35
  v_max_u32 v6, v6, v3
  v_mul_f32 v86, v86, v82
  v_mul_f32 v87, v87, v83
  v_mfma_f32_16x16x32_bf16 v[44:47], v[212:215], a[20:23], v[44:47]
  buffer_load_dwordx4 a[84:87], v7, s[20:23], s48 offen offset:1024 sc1
  v_mul_f32 v88, v88, v84
  v_mfma_f32_16x16x32_bf16 v[44:47], v[232:235], a[24:27], v[44:47]
  v_cmp_eq_u32 vcc, -1, v6
  v_mul_f32 v89, v89, v85
  v_exp_f32 v86, v86
  v_mfma_f32_16x16x32_bf16 v[44:47], v[252:255], a[28:31], v[44:47]
  s_cbranch_vccnz L_slow_53
L_ok_54:
  s_waitcnt lgkmcnt(15)
  v_mfma_f32_16x16x32_bf16 v[28:31], a[144:147], a[32:35], v[28:31]
  s_waitcnt lgkmcnt(14)
  v_exp_f32 v87, v87
  v_exp_f32 v88, v88
  v_mfma_f32_16x16x32_bf16 v[28:31], a[164:167], a[36:39], v[28:31]
  buffer_load_dwordx4 a[88:91], v7, s[20:23], s48 offen offset:2048 sc1
  s_waitcnt lgkmcnt(9)
  v_exp_f32 v89, v89
  v_mfma_f32_16x16x32_bf16 v[28:31], a[184:187], a[40:43], v[28:31]
  s_waitcnt lgkmcnt(4)
  v_add_f32 v86, 1.0, v86
  v_add_f32 v87, 1.0, v87
  v_add_f32 v88, 1.0, v88
  v_add_f32 v89, 1.0, v89
  v_mfma_f32_16x16x32_bf16 v[28:31], a[204:207], a[44:47], v[28:31]
  v_rcp_f32 v86, v86
  v_mfma_f32_16x16x32_bf16 v[32:35], a[148:151], a[32:35], v[32:35]
  v_rcp_f32 v87, v87
  v_rcp_f32 v88, v88
  v_mfma_f32_16x16x32_bf16 v[32:35], a[168:171], a[36:39], v[32:35]
  buffer_load_dwordx4 a[92:95], v7, s[20:23], s48 offen offset:3072 sc1
  v_rcp_f32 v89, v89
  v_mfma_f32_16x16x32_bf16 v[32:35], a[188:191], a[40:43], v[32:35]
  s_waitcnt lgkmcnt(3)
  v_mul_f32 v86, v86, v82
  v_mul_f32 v87, v87, v83
  v_mul_f32 v88, v88, v84
  v_mfma_f32_16x16x32_bf16 v[32:35], a[208:211], a[44:47], v[32:35]
  v_mul_f32 v89, v89, v85
  v_cvt_pk_bf16_f32 v70, v86, v87
  v_cvt_pk_bf16_f32 v71, v88, v89
  v_mfma_f32_16x16x32_bf16 v[36:39], a[152:155], a[32:35], v[36:39]
  v_permlane32_swap_b32 v70, v72
  v_permlane32_swap_b32 v71, v73
  v_mfma_f32_16x16x32_bf16 v[36:39], a[172:175], a[36:39], v[36:39]
  v_mfma_f32_16x16x32_bf16 v[36:39], a[192:195], a[40:43], v[36:39]
  buffer_store_dwordx4 v[70:73], v13, s[20:23], s62 offen sc1
  s_waitcnt lgkmcnt(2)
  v_mfma_f32_16x16x32_bf16 v[36:39], a[212:215], a[44:47], v[36:39]
  v_bfe_u32 v4, v10, 1, 2
  v_xor_b32 v4, v4, v11
  s_mul_i32 s60, s53, 13312
  v_lshl_add_u32 v94, v4, 4, s60
  v_mfma_f32_16x16x32_bf16 v[40:43], a[156:159], a[32:35], v[40:43]
  v_lshl_add_u32 v94, v10, 6, v94
  s_lshl_b32 s60, s53, 2
  v_add_u32 v22, s60, v11
  v_mfma_f32_16x16x32_bf16 v[40:43], a[176:179], a[36:39], v[40:43]
  s_waitcnt vmcnt(10)
  v_accvgpr_read_b32 v6, a63
  v_accvgpr_read_b32 v3, a59
  s_lshl_b32 s61, s55, 7
  s_mul_i32 s60, s56, 81920
  v_mfma_f32_16x16x32_bf16 v[40:43], a[196:199], a[40:43], v[40:43]
  s_waitcnt lgkmcnt(1)
  v_accvgpr_read_b32 v2, a55
  v_max3_u32 v6, v6, v2, v3
  v_lshl_add_u32 v20, v10, 3, s61
  v_mfma_f32_16x16x32_bf16 v[40:43], a[216:219], a[44:47], v[40:43]
  v_accvgpr_read_b32 v3, a51
  v_max_u32 v6, v6, v3
  v_mul_u32_u24 v5, 1280, v22
  v_add3_u32 v18, v5, v20, s60
  v_mfma_f32_16x16x32_bf16 v[44:47], a[160:163], a[32:35], v[44:47]
  v_cmp_eq_u32 vcc, -1, v6
  s_lshl_b32 s61, s55, 5
  s_add_u32 s61, s61, 1024
  v_mfma_f32_16x16x32_bf16 v[44:47], a[180:183], a[36:39], v[44:47]
  s_lshl2_add_u32 s64, s56, s53
  s_mul_i32 s60, s64, 20480
  v_lshl_add_u32 v21, v15, 3, s61
  v_mul_u32_u24 v5, 1280, v14
  v_add3_u32 v19, v5, v21, s60
  v_mfma_f32_16x16x32_bf16 v[44:47], a[200:203], a[40:43], v[44:47]
  s_cbranch_vccnz L_slow_56
L_ok_57:
  s_waitcnt lgkmcnt(0)
  v_mfma_f32_16x16x32_bf16 v[44:47], a[220:223], a[44:47], v[44:47]
  s_mov_b32 s59, 3211264
  buffer_load_dwordx2 v[48:49], v18, s[20:23], s59 offen sc1
  v_mfma_f32_16x16x32_bf16 v[74:77], v[96:99], a[48:51], 0
  s_barrier
  v_bfe_u32 v5, v22, 1, 2
  v_mfma_f32_16x16x32_bf16 v[74:77], v[116:119], a[52:55], v[74:77]
  s_add_u32 s48, s3, 98304
  buffer_load_dwordx4 a[96:99], v7, s[20:23], s48 offen offset:0 sc1
  v_mfma_f32_16x16x32_bf16 v[74:77], v[136:139], a[56:59], v[74:77]
  v_xor_b32 v5, v5, v15
  v_lshlrev_b32 v5, 4, v5
  v_mfma_f32_16x16x32_bf16 v[74:77], v[156:159], a[60:63], v[74:77]
  v_lshl_add_u32 v95, v22, 6, v5
  v_lshrrev_b32 v5, 2, v10
  v_mul_u32_u24 v5, 1152, v5
  v_mfma_f32_16x16x32_bf16 v[78:81], v[100:103], a[48:51], 0
  v_add_u32 v95, v5, v95
  s_mul_i32 s64, s56, 10240
  v_mfma_f32_16x16x32_bf16 v[78:81], v[120:123], a[52:55], v[78:81]
  ds_write_b128 v94, v[28:31] offset:0
  v_mfma_f32_16x16x32_bf16 v[78:81], v[140:143], a[56:59], v[78:81]
  buffer_load_dwordx4 a[100:103], v7, s[20:23], s48 offen offset:1024 sc1
  v_and_b32 v5, 7, v22
  v_mfma_f32_16x16x32_bf16 v[78:81], v[160:163], a[60:63], v[78:81]
  ds_write_b128 v94, v[32:35] offset:1152
  v_mfma_f32_16x16x32_bf16 v[82:85], v[104:107], a[48:51], 0
  v_lshrrev_b32 v4, 3, v22
  v_lshl_add_u32 v5, v5, 8, v4
  v_mfma_f32_16x16x32_bf16 v[82:85], v[124:127], a[52:55], v[82:85]
  ds_write_b128 v94, v[36:39] offset:2304
  v_mfma_f32_16x16x32_bf16 v[82:85], v[144:147], a[56:59], v[82:85]
  buffer_load_dwordx4 a[104:107], v7, s[20:23], s48 offen offset:2048 sc1
  v_mul_u32_u24 v5, 1280, v5
  v_mfma_f32_16x16x32_bf16 v[82:85], v[164:167], a[60:63], v[82:85]
  ds_write_b128 v94, v[40:43] offset:3456
  v_mfma_f32_16x16x32_bf16 v[86:89], v[108:111], a[48:51], 0
  v_add3_u32 v20, v5, v20, s64
  v_accvgpr_read_b32 v8, a240
  v_mfma_f32_16x16x32_bf16 v[86:89], v[128:131], a[52:55], v[86:89]
  ds_write_b128 v94, v[44:47] offset:9216
  v_accvgpr_read_b32 v16, a248
  v_mfma_f32_16x16x32_bf16 v[86:89], v[148:151], a[56:59], v[86:89]
  buffer_load_dwordx4 a[108:111], v7, s[20:23], s48 offen offset:3072 sc1
  s_waitcnt vmcnt(11)
  v_accvgpr_read_b32 v6, a79
  v_mfma_f32_16x16x32_bf16 v[86:89], v[168:171], a[60:63], v[86:89]
  s_mov_b32 s59, 3231744
  buffer_load_dwordx2 v[50:51], v18, s[20:23], s59 offen sc1
  v_mfma_f32_16x16x32_bf16 v[90:93], v[112:115], a[48:51], 0
  s_add_u32 s48, s5, 98304
  v_accvgpr_read_b32 v3, a75
  v_accvgpr_read_b32 v2, a71
  v_max3_u32 v6, v6, v2, v3
  v_accvgpr_read_b32 v9, a241
  v_mfma_f32_16x16x32_bf16 v[90:93], v[132:135], a[52:55], v[90:93]
  buffer_load_dwordx4 a[112:115], v7, s[20:23], s48 offen offset:0 sc1
  v_mfma_f32_16x16x32_bf16 v[90:93], v[152:155], a[56:59], v[90:93]
  v_accvgpr_read_b32 v3, a67
  v_max_u32 v6, v6, v3
  v_cmp_eq_u32 vcc, -1, v6
  v_mfma_f32_16x16x32_bf16 v[90:93], v[172:175], a[60:63], v[90:93]
  s_cbranch_vccnz L_slow_59
L_ok_60:
  v_mfma_f32_16x16x32_bf16 v[74:77], v[176:179], a[64:67], v[74:77]
  v_accvgpr_read_b32 v23, a249
  v_accvgpr_read_b32 v12, a242
  v_accvgpr_read_b32 v26, a250
  v_mfma_f32_16x16x32_bf16 v[74:77], v[196:199], a[68:71], v[74:77]
  buffer_load_dwordx4 a[116:119], v7, s[20:23], s48 offen offset:1024 sc1
  v_mfma_f32_16x16x32_bf16 v[74:77], v[216:219], a[72:75], v[74:77]
  v_accvgpr_read_b32 v13, a243
  v_accvgpr_read_b32 v68, a251
  v_mfma_f32_16x16x32_bf16 v[74:77], v[236:239], a[76:79], v[74:77]
  v_accvgpr_read_b32 v24, a244
  v_accvgpr_read_b32 v69, a252
  v_accvgpr_read_b32 v25, a245
  v_mfma_f32_16x16x32_bf16 v[78:81], v[180:183], a[64:67], v[78:81]
  v_accvgpr_read_b32 v70, a253
  v_accvgpr_read_b32 v66, a246
  v_mfma_f32_16x16x32_bf16 v[78:81], v[200:203], a[68:71], v[78:81]
  buffer_load_dwordx4 a[120:123], v7, s[20:23], s48 offen offset:2048 sc1
  v_mfma_f32_16x16x32_bf16 v[78:81], v[220:223], a[72:75], v[78:81]
  v_accvgpr_read_b32 v71, a254
  v_accvgpr_read_b32 v67, a247
  v_accvgpr_read_b32 v72, a255
  v_mfma_f32_16x16x32_bf16 v[78:81], v[240:243], a[76:79], v[78:81]
  s_waitcnt lgkmcnt(0)
  s_barrier
  v_mfma_f32_16x16x32_bf16 v[82:85], v[184:187], a[64:67], v[82:85]
  ds_read_b128 v[28:31], v95 offset:0
  s_waitcnt vmcnt(8)
  v_lshlrev_b32 v58, 16, v48
  v_mfma_f32_16x16x32_bf16 v[82:85], v[204:207], a[68:71], v[82:85]
  ds_read_b128 v[32:35], v95 offset:13312
  ds_read_b128 v[36:39], v95 offset:26624
  ds_read_b128 v[40:43], v95 offset:39936
  v_mfma_f32_16x16x32_bf16 v[82:85], v[224:227], a[72:75], v[82:85]
  buffer_load_dwordx4 a[124:127], v7, s[20:23], s48 offen offset:3072 sc1
  v_mfma_f32_16x16x32_bf16 v[82:85], v[244:247], a[76:79], v[82:85]
  v_and_b32 v59, s58, v48
  v_lshlrev_b32 v60, 16, v49
  v_mfma_f32_16x16x32_bf16 v[86:89], v[188:191], a[64:67], v[86:89]
  s_add_u32 s48, s7, 98304
  v_and_b32 v61, s58, v49
  v_fmac_f32 v58, v8, v16
  v_mfma_f32_16x16x32_bf16 v[86:89], v[208:211], a[68:71], v[86:89]
  buffer_load_dwordx4 a[128:131], v7, s[20:23], s48 offen offset:0 sc1
  v_fmac_f32 v59, v9, v23
  v_mfma_f32_16x16x32_bf16 v[86:89], v[228:231], a[72:75], v[86:89]
  v_accvgpr_read_b32 v6, a95
  v_accvgpr_read_b32 v3, a91
  v_mfma_f32_16x16x32_bf16 v[86:89], v[248:251], a[76:79], v[86:89]
  v_accvgpr_read_b32 v2, a87
  v_max3_u32 v6, v6, v2, v3
  v_mfma_f32_16x16x32_bf16 v[90:93], v[192:195], a[64:67], v[90:93]
  v_accvgpr_read_b32 v3, a83
  v_max_u32 v6, v6, v3
  v_mfma_f32_16x16x32_bf16 v[90:93], v[212:215], a[68:71], v[90:93]
  buffer_load_dwordx4 a[132:135], v7, s[20:23], s48 offen offset:1024 sc1
  v_mfma_f32_16x16x32_bf16 v[90:93], v[232:235], a[72:75], v[90:93]
  v_cmp_eq_u32 vcc, -1, v6
  v_fmac_f32 v60, v12, v26
  v_mfma_f32_16x16x32_bf16 v[90:93], v[252:255], a[76:79], v[90:93]
  s_cbranch_vccnz L_slow_62
L_ok_63:
  v_fmac_f32 v61, v13, v68
  v_mfma_f32_16x16x32_bf16 v[74:77], a[144:147], a[80:83], v[74:77]
  s_waitcnt lgkmcnt(0)
  v_add_f32 v28, v28, v32
  v_add_f32 v29, v29, v33
  v_mfma_f32_16x16x32_bf16 v[74:77], a[164:167], a[84:87], v[74:77]
  buffer_load_dwordx4 a[136:139], v7, s[20:23], s48 offen offset:2048 sc1
  v_mfma_f32_16x16x32_bf16 v[74:77], a[184:187], a[88:91], v[74:77]
  v_add_f32 v30, v30, v34
  v_add_f32 v31, v31, v35
  v_mfma_f32_16x16x32_bf16 v[74:77], a[204:207], a[92:95], v[74:77]
  v_add_f32 v36, v36, v40
  v_add_f32 v37, v37, v41
  v_add_f32 v38, v38, v42
  v_mfma_f32_16x16x32_bf16 v[78:81], a[148:151], a[80:83], v[78:81]
  v_add_f32 v39, v39, v43
  v_add_f32 v28, v28, v36
  v_mfma_f32_16x16x32_bf16 v[78:81], a[168:171], a[84:87], v[78:81]
  buffer_load_dwordx4 a[140:143], v7, s[20:23], s48 offen offset:3072 sc1
  v_mfma_f32_16x16x32_bf16 v[78:81], a[188:191], a[88:91], v[78:81]
  v_add_f32 v29, v29, v37
  v_add_f32 v30, v30, v38
  v_mfma_f32_16x16x32_bf16 v[78:81], a[208:211], a[92:95], v[78:81]
  v_add_f32 v31, v31, v39
  v_fmac_f32 v58, v28, v8
  v_fmac_f32 v59, v29, v9
  v_mfma_f32_16x16x32_bf16 v[82:85], a[152:155], a[80:83], v[82:85]
  v_fmac_f32 v60, v30, v12
  v_fmac_f32 v61, v31, v13
  v_mfma_f32_16x16x32_bf16 v[82:85], a[172:175], a[84:87], v[82:85]
  v_cvt_pk_bf16_f32 v44, v58, v59
  v_cvt_pk_bf16_f32 v45, v60, v61
  v_mfma_f32_16x16x32_bf16 v[82:85], a[192:195], a[88:91], v[82:85]
  v_mfma_f32_16x16x32_bf16 v[82:85], a[212:215], a[92:95], v[82:85]
  v_mfma_f32_16x16x32_bf16 v[86:89], a[156:159], a[80:83], v[86:89]
  v_mfma_f32_16x16x32_bf16 v[86:89], a[176:179], a[84:87], v[86:89]
  s_waitcnt vmcnt(9)
  v_accvgpr_read_b32 v6, a111
  v_accvgpr_read_b32 v3, a107
  v_mfma_f32_16x16x32_bf16 v[86:89], a[196:199], a[88:91], v[86:89]
  v_accvgpr_read_b32 v2, a103
  v_max3_u32 v6, v6, v2, v3
  v_mfma_f32_16x16x32_bf16 v[86:89], a[216:219], a[92:95], v[86:89]
  v_accvgpr_read_b32 v3, a99
  v_max_u32 v6, v6, v3
  v_mfma_f32_16x16x32_bf16 v[90:93], a[160:163], a[80:83], v[90:93]
  v_cmp_eq_u32 vcc, -1, v6
  v_mfma_f32_16x16x32_bf16 v[90:93], a[180:183], a[84:87], v[90:93]
  s_mov_b32 s63, 0
  buffer_store_dwordx2 v[44:45], v20, s[44:47], s63 offen sc1
  v_mfma_f32_16x16x32_bf16 v[90:93], a[200:203], a[88:91], v[90:93]
  s_cbranch_vccnz L_slow_65
L_ok_66:
  v_mfma_f32_16x16x32_bf16 v[90:93], a[220:223], a[92:95], v[90:93]
  v_mfma_f32_16x16x32_bf16 v[28:31], v[96:99], a[96:99], 0
  v_bfe_u32 v5, v14, 1, 2
  v_xor_b32 v5, v5, v15
  v_mfma_f32_16x16x32_bf16 v[28:31], v[116:119], a[100:103], v[28:31]
  s_add_u32 s48, s3, 147456
  buffer_load_dwordx4 a[0:3], v7, s[20:23], s48 offen offset:0 sc1
  v_mfma_f32_16x16x32_bf16 v[28:31], v[136:139], a[104:107], v[28:31]
  v_lshlrev_b32 v5, 4, v5
  v_lshl_add_u32 v17, v14, 6, v5
  v_mfma_f32_16x16x32_bf16 v[28:31], v[156:159], a[108:111], v[28:31]
  s_lshl_b32 s60, s53, 10
  v_add_u32 v17, s60, v17
  s_lshl2_add_u32 s64, s56, s53
  v_mfma_f32_16x16x32_bf16 v[32:35], v[100:103], a[96:99], 0
  s_mul_i32 s64, s64, 2560
  v_and_b32 v5, 7, v14
  v_lshrrev_b32 v4, 3, v14
  v_mfma_f32_16x16x32_bf16 v[32:35], v[120:123], a[100:103], v[32:35]
  ds_write_b128 v94, v[74:77] offset:4608
  v_mfma_f32_16x16x32_bf16 v[32:35], v[140:143], a[104:107], v[32:35]
  buffer_load_dwordx4 a[4:7], v7, s[20:23], s48 offen offset:1024 sc1
  v_mfma_f32_16x16x32_bf16 v[32:35], v[160:163], a[108:111], v[32:35]
  ds_write_b128 v94, v[78:81] offset:5760
  v_mfma_f32_16x16x32_bf16 v[36:39], v[104:107], a[96:99], 0
  v_lshl_add_u32 v5, v5, 8, v4
  v_mul_u32_u24 v5, 1280, v5
  v_mfma_f32_16x16x32_bf16 v[36:39], v[124:127], a[100:103], v[36:39]
  ds_write_b128 v94, v[82:85] offset:6912
  v_mfma_f32_16x16x32_bf16 v[36:39], v[144:147], a[104:107], v[36:39]
  buffer_load_dwordx4 a[8:11], v7, s[20:23], s48 offen offset:2048 sc1
  v_mfma_f32_16x16x32_bf16 v[36:39], v[164:167], a[108:111], v[36:39]
  ds_write_b128 v94, v[86:89] offset:8064
  v_mfma_f32_16x16x32_bf16 v[40:43], v[108:111], a[96:99], 0
  v_add3_u32 v21, v5, v21, s64
  v_mfma_f32_16x16x32_bf16 v[40:43], v[128:131], a[100:103], v[40:43]
  ds_write_b128 v94, v[90:93] offset:10240
  v_mfma_f32_16x16x32_bf16 v[40:43], v[148:151], a[104:107], v[40:43]
  buffer_load_dwordx4 a[12:15], v7, s[20:23], s48 offen offset:3072 sc1
  s_waitcnt vmcnt(9)
  v_accvgpr_read_b32 v6, a127
  v_mfma_f32_16x16x32_bf16 v[40:43], v[168:171], a[108:111], v[40:43]
  s_mov_b32 s59, 3252224
  buffer_load_dwordx2 v[52:53], v18, s[20:23], s59 offen sc1
  v_mfma_f32_16x16x32_bf16 v[44:47], v[112:115], a[96:99], 0
  s_add_u32 s48, s5, 147456
  v_accvgpr_read_b32 v3, a123
  v_accvgpr_read_b32 v2, a119
  v_max3_u32 v6, v6, v2, v3
  v_mfma_f32_16x16x32_bf16 v[44:47], v[132:135], a[100:103], v[44:47]
  buffer_load_dwordx4 a[16:19], v7, s[20:23], s48 offen offset:0 sc1
  v_mfma_f32_16x16x32_bf16 v[44:47], v[152:155], a[104:107], v[44:47]
  s_mov_b32 s59, 3211264
  v_accvgpr_read_b32 v3, a115
  v_max_u32 v6, v6, v3
  v_cmp_eq_u32 vcc, -1, v6
  v_mfma_f32_16x16x32_bf16 v[44:47], v[172:175], a[108:111], v[44:47]
  s_cbranch_vccnz L_slow_68
L_ok_69:
  v_mfma_f32_16x16x32_bf16 v[28:31], v[176:179], a[112:115], v[28:31]
  buffer_load_dwordx2 v[56:57], v19, s[20:23], s59 offen sc1
  v_mfma_f32_16x16x32_bf16 v[28:31], v[196:199], a[116:119], v[28:31]
  buffer_load_dwordx4 a[20:23], v7, s[20:23], s48 offen offset:1024 sc1
  v_mfma_f32_16x16x32_bf16 v[28:31], v[216:219], a[120:123], v[28:31]
  v_mfma_f32_16x16x32_bf16 v[28:31], v[236:239], a[124:127], v[28:31]
  v_mfma_f32_16x16x32_bf16 v[32:35], v[180:183], a[112:115], v[32:35]
  s_mov_b32 s59, 3272704
  v_mfma_f32_16x16x32_bf16 v[32:35], v[200:203], a[116:119], v[32:35]
  buffer_load_dwordx4 a[24:27], v7, s[20:23], s48 offen offset:2048 sc1
  v_mfma_f32_16x16x32_bf16 v[32:35], v[220:223], a[120:123], v[32:35]
  buffer_load_dwordx2 v[54:55], v18, s[20:23], s59 offen sc1
  v_mfma_f32_16x16x32_bf16 v[32:35], v[240:243], a[124:127], v[32:35]
  s_waitcnt lgkmcnt(0)
  s_barrier
  v_mfma_f32_16x16x32_bf16 v[36:39], v[184:187], a[112:115], v[36:39]
  ds_read_b128 v[74:77], v95 offset:4608
  v_lshlrev_b32 v58, 16, v50
  v_mfma_f32_16x16x32_bf16 v[36:39], v[204:207], a[116:119], v[36:39]
  ds_read_b128 v[78:81], v95 offset:17920
  ds_read_b128 v[82:85], v95 offset:31232
  ds_read_b128 v[86:89], v95 offset:44544
  v_mfma_f32_16x16x32_bf16 v[36:39], v[224:227], a[120:123], v[36:39]
  buffer_load_dwordx4 a[28:31], v7, s[20:23], s48 offen offset:3072 sc1
  v_mfma_f32_16x16x32_bf16 v[36:39], v[244:247], a[124:127], v[36:39]
  v_and_b32 v59, s58, v50
  v_lshlrev_b32 v60, 16, v51
  v_mfma_f32_16x16x32_bf16 v[40:43], v[188:191], a[112:115], v[40:43]
  s_add_u32 s48, s7, 147456
  v_and_b32 v61, s58, v51
  v_fmac_f32 v58, v8, v16
  v_mfma_f32_16x16x32_bf16 v[40:43], v[208:211], a[116:119], v[40:43]
  buffer_load_dwordx4 a[32:35], v7, s[20:23], s48 offen offset:0 sc1
  v_fmac_f32 v59, v9, v23
  v_mfma_f32_16x16x32_bf16 v[40:43], v[228:231], a[120:123], v[40:43]
  s_waitcnt vmcnt(13)
  v_accvgpr_read_b32 v6, a143
  v_accvgpr_read_b32 v3, a139
  v_mfma_f32_16x16x32_bf16 v[40:43], v[248:251], a[124:127], v[40:43]
  v_accvgpr_read_b32 v2, a135
  v_max3_u32 v6, v6, v2, v3
  v_mfma_f32_16x16x32_bf16 v[44:47], v[192:195], a[112:115], v[44:47]
  v_accvgpr_read_b32 v3, a131
  v_max_u32 v6, v6, v3
  v_mfma_f32_16x16x32_bf16 v[44:47], v[212:215], a[116:119], v[44:47]
  buffer_load_dwordx4 a[36:39], v7, s[20:23], s48 offen offset:1024 sc1
  v_mfma_f32_16x16x32_bf16 v[44:47], v[232:235], a[120:123], v[44:47]
  v_cmp_eq_u32 vcc, -1, v6
  v_fmac_f32 v60, v12, v26
  v_mfma_f32_16x16x32_bf16 v[44:47], v[252:255], a[124:127], v[44:47]
  s_cbranch_vccnz L_slow_71
L_ok_72:
  v_fmac_f32 v61, v13, v68
  v_mfma_f32_16x16x32_bf16 v[28:31], a[144:147], a[128:131], v[28:31]
  s_waitcnt lgkmcnt(0)
  v_add_f32 v74, v74, v78
  v_add_f32 v75, v75, v79
  v_mfma_f32_16x16x32_bf16 v[28:31], a[164:167], a[132:135], v[28:31]
  buffer_load_dwordx4 a[40:43], v7, s[20:23], s48 offen offset:2048 sc1
  v_mfma_f32_16x16x32_bf16 v[28:31], a[184:187], a[136:139], v[28:31]
  v_add_f32 v76, v76, v80
  v_add_f32 v77, v77, v81
  v_mfma_f32_16x16x32_bf16 v[28:31], a[204:207], a[140:143], v[28:31]
  v_add_f32 v82, v82, v86
  v_add_f32 v83, v83, v87
  v_add_f32 v84, v84, v88
  v_mfma_f32_16x16x32_bf16 v[32:35], a[148:151], a[128:131], v[32:35]
  v_add_f32 v85, v85, v89
  v_add_f32 v74, v74, v82
  v_mfma_f32_16x16x32_bf16 v[32:35], a[168:171], a[132:135], v[32:35]
  buffer_load_dwordx4 a[44:47], v7, s[20:23], s48 offen offset:3072 sc1
  v_mfma_f32_16x16x32_bf16 v[32:35], a[188:191], a[136:139], v[32:35]
  v_add_f32 v75, v75, v83
  v_add_f32 v76, v76, v84
  v_mfma_f32_16x16x32_bf16 v[32:35], a[208:211], a[140:143], v[32:35]
  v_add_f32 v77, v77, v85
  v_fmac_f32 v58, v74, v8
  v_fmac_f32 v59, v75, v9
  v_mfma_f32_16x16x32_bf16 v[36:39], a[152:155], a[128:131], v[36:39]
  v_fmac_f32 v60, v76, v12
  v_fmac_f32 v61, v77, v13
  v_mfma_f32_16x16x32_bf16 v[36:39], a[172:175], a[132:135], v[36:39]
  v_cvt_pk_bf16_f32 v90, v58, v59
  v_cvt_pk_bf16_f32 v91, v60, v61
  v_mfma_f32_16x16x32_bf16 v[36:39], a[192:195], a[136:139], v[36:39]
  v_mfma_f32_16x16x32_bf16 v[36:39], a[212:215], a[140:143], v[36:39]
  v_mfma_f32_16x16x32_bf16 v[40:43], a[156:159], a[128:131], v[40:43]
  v_mfma_f32_16x16x32_bf16 v[40:43], a[176:179], a[132:135], v[40:43]
  s_waitcnt vmcnt(11)
  v_accvgpr_read_b32 v6, a15
  v_accvgpr_read_b32 v3, a11
  v_mfma_f32_16x16x32_bf16 v[40:43], a[196:199], a[136:139], v[40:43]
  v_accvgpr_read_b32 v2, a7
  v_max3_u32 v6, v6, v2, v3
  v_mfma_f32_16x16x32_bf16 v[40:43], a[216:219], a[140:143], v[40:43]
  v_accvgpr_read_b32 v3, a3
  v_max_u32 v6, v6, v3
  v_mfma_f32_16x16x32_bf16 v[44:47], a[160:163], a[128:131], v[44:47]
  v_cmp_eq_u32 vcc, -1, v6
  v_mfma_f32_16x16x32_bf16 v[44:47], a[180:183], a[132:135], v[44:47]
  s_mov_b32 s63, 2560
  buffer_store_dwordx2 v[90:91], v20, s[44:47], s63 offen sc1
  v_mfma_f32_16x16x32_bf16 v[44:47], a[200:203], a[136:139], v[44:47]
  s_cbranch_vccnz L_slow_74
L_ok_75:
  v_mfma_f32_16x16x32_bf16 v[44:47], a[220:223], a[140:143], v[44:47]
  v_mfma_f32_16x16x32_bf16 v[74:77], v[96:99], a[0:3], 0
  v_mfma_f32_16x16x32_bf16 v[74:77], v[116:119], a[4:7], v[74:77]
  v_mfma_f32_16x16x32_bf16 v[74:77], v[136:139], a[8:11], v[74:77]
  v_mfma_f32_16x16x32_bf16 v[74:77], v[156:159], a[12:15], v[74:77]
  v_mfma_f32_16x16x32_bf16 v[78:81], v[100:103], a[0:3], 0
  v_mfma_f32_16x16x32_bf16 v[78:81], v[120:123], a[4:7], v[78:81]
  ds_write_b128 v94, v[28:31] offset:0
  v_mfma_f32_16x16x32_bf16 v[78:81], v[140:143], a[8:11], v[78:81]
  v_mfma_f32_16x16x32_bf16 v[78:81], v[160:163], a[12:15], v[78:81]
  ds_write_b128 v94, v[32:35] offset:1152
  v_mfma_f32_16x16x32_bf16 v[82:85], v[104:107], a[0:3], 0
  v_mfma_f32_16x16x32_bf16 v[82:85], v[124:127], a[4:7], v[82:85]
  ds_write_b128 v94, v[36:39] offset:2304
  v_mfma_f32_16x16x32_bf16 v[82:85], v[144:147], a[8:11], v[82:85]
  v_mfma_f32_16x16x32_bf16 v[82:85], v[164:167], a[12:15], v[82:85]
  ds_write_b128 v94, v[40:43] offset:3456
  v_mfma_f32_16x16x32_bf16 v[86:89], v[108:111], a[0:3], 0
  v_mfma_f32_16x16x32_bf16 v[86:89], v[128:131], a[4:7], v[86:89]
  ds_write_b128 v94, v[44:47] offset:11264
  v_mfma_f32_16x16x32_bf16 v[86:89], v[148:151], a[8:11], v[86:89]
  s_waitcnt vmcnt(5)
  v_accvgpr_read_b32 v6, a31
  v_accvgpr_read_b32 v3, a27
  v_mfma_f32_16x16x32_bf16 v[86:89], v[168:171], a[12:15], v[86:89]
  v_accvgpr_read_b32 v2, a23
  v_max3_u32 v6, v6, v2, v3
  v_mfma_f32_16x16x32_bf16 v[90:93], v[112:115], a[0:3], 0
  v_accvgpr_read_b32 v3, a19
  v_max_u32 v6, v6, v3
  v_mfma_f32_16x16x32_bf16 v[90:93], v[132:135], a[4:7], v[90:93]
  v_cmp_eq_u32 vcc, -1, v6
  v_mfma_f32_16x16x32_bf16 v[90:93], v[152:155], a[8:11], v[90:93]
L_pad_pg6:
  s_cbranch_execz L_wret_25
  v_mfma_f32_16x16x32_bf16 v[90:93], v[172:175], a[12:15], v[90:93]
  s_cbranch_vccnz L_slow_77
L_ok_78:
  v_mfma_f32_16x16x32_bf16 v[74:77], v[176:179], a[16:19], v[74:77]
  v_mfma_f32_16x16x32_bf16 v[74:77], v[196:199], a[20:23], v[74:77]
  v_mfma_f32_16x16x32_bf16 v[74:77], v[216:219], a[24:27], v[74:77]
  v_mfma_f32_16x16x32_bf16 v[74:77], v[236:239], a[28:31], v[74:77]
  v_mfma_f32_16x16x32_bf16 v[78:81], v[180:183], a[16:19], v[78:81]
  v_mfma_f32_16x16x32_bf16 v[78:81], v[200:203], a[20:23], v[78:81]
  v_mfma_f32_16x16x32_bf16 v[78:81], v[220:223], a[24:27], v[78:81]
  v_mfma_f32_16x16x32_bf16 v[78:81], v[240:243], a[28:31], v[78:81]
  s_waitcnt lgkmcnt(0)
  s_barrier
  v_mfma_f32_16x16x32_bf16 v[82:85], v[184:187], a[16:19], v[82:85]
  ds_read_b128 v[28:31], v95 offset:0
  v_lshlrev_b32 v58, 16, v52
  v_mfma_f32_16x16x32_bf16 v[82:85], v[204:207], a[20:23], v[82:85]
  ds_read_b128 v[32:35], v95 offset:13312
  ds_read_b128 v[36:39], v95 offset:26624
  ds_read_b128 v[40:43], v95 offset:39936
  v_mfma_f32_16x16x32_bf16 v[82:85], v[224:227], a[24:27], v[82:85]
  v_and_b32 v59, s58, v52
  v_lshlrev_b32 v60, 16, v53
  v_and_b32 v61, s58, v53
  v_mfma_f32_16x16x32_bf16 v[82:85], v[244:247], a[28:31], v[82:85]
  v_fmac_f32 v58, v8, v16
  v_fmac_f32 v59, v9, v23
  v_mfma_f32_16x16x32_bf16 v[86:89], v[188:191], a[16:19], v[86:89]
  v_fmac_f32 v60, v12, v26
  v_fmac_f32 v61, v13, v68
  v_mfma_f32_16x16x32_bf16 v[86:89], v[208:211], a[20:23], v[86:89]
  s_waitcnt vmcnt(1)
  v_accvgpr_read_b32 v6, a47
  v_accvgpr_read_b32 v3, a43
  v_lshlrev_b32 v62, 16, v56
  v_mfma_f32_16x16x32_bf16 v[86:89], v[228:231], a[24:27], v[86:89]
  v_accvgpr_read_b32 v2, a39
  v_max3_u32 v6, v6, v2, v3
  v_mfma_f32_16x16x32_bf16 v[86:89], v[248:251], a[28:31], v[86:89]
  v_accvgpr_read_b32 v3, a35
  v_max_u32 v6, v6, v3
  v_mfma_f32_16x16x32_bf16 v[90:93], v[192:195], a[16:19], v[90:93]
  v_cmp_eq_u32 vcc, -1, v6
  v_and_b32 v63, s58, v56
  v_lshlrev_b32 v64, 16, v57
  v_mfma_f32_16x16x32_bf16 v[90:93], v[212:215], a[20:23], v[90:93]
  v_and_b32 v65, s58, v57
  v_fmac_f32 v62, v24, v69
  v_mfma_f32_16x16x32_bf16 v[90:93], v[232:235], a[24:27], v[90:93]
  s_cbranch_vccnz L_slow_80
L_ok_81:
  v_mfma_f32_16x16x32_bf16 v[90:93], v[252:255], a[28:31], v[90:93]
  v_fmac_f32 v63, v25, v70
  v_fmac_f32 v64, v66, v71
  v_fmac_f32 v65, v67, v72
  v_mfma_f32_16x16x32_bf16 v[74:77], a[144:147], a[32:35], v[74:77]
  s_waitcnt lgkmcnt(0)
  v_add_f32 v28, v28, v32
  v_add_f32 v29, v29, v33
  v_mfma_f32_16x16x32_bf16 v[74:77], a[164:167], a[36:39], v[74:77]
  v_add_f32 v30, v30, v34
  v_add_f32 v31, v31, v35
  v_mfma_f32_16x16x32_bf16 v[74:77], a[184:187], a[40:43], v[74:77]
  v_add_f32 v36, v36, v40
  v_add_f32 v37, v37, v41
  v_mfma_f32_16x16x32_bf16 v[74:77], a[204:207], a[44:47], v[74:77]
  v_add_f32 v38, v38, v42
  v_add_f32 v39, v39, v43
  v_add_f32 v28, v28, v36
  v_mfma_f32_16x16x32_bf16 v[78:81], a[148:151], a[32:35], v[78:81]
  v_add_f32 v29, v29, v37
  v_add_f32 v30, v30, v38
  v_mfma_f32_16x16x32_bf16 v[78:81], a[168:171], a[36:39], v[78:81]
  v_add_f32 v31, v31, v39
  v_fmac_f32 v58, v28, v8
  v_mfma_f32_16x16x32_bf16 v[78:81], a[188:191], a[40:43], v[78:81]
  v_fmac_f32 v59, v29, v9
  v_fmac_f32 v60, v30, v12
  v_fmac_f32 v61, v31, v13
  v_mfma_f32_16x16x32_bf16 v[78:81], a[208:211], a[44:47], v[78:81]
  v_cvt_pk_bf16_f32 v44, v58, v59
  v_cvt_pk_bf16_f32 v45, v60, v61
  v_mfma_f32_16x16x32_bf16 v[82:85], a[152:155], a[32:35], v[82:85]
  ds_write_b128 v94, v[74:77] offset:4608
  v_mfma_f32_16x16x32_bf16 v[82:85], a[172:175], a[36:39], v[82:85]
  v_mfma_f32_16x16x32_bf16 v[82:85], a[192:195], a[40:43], v[82:85]
  v_mfma_f32_16x16x32_bf16 v[82:85], a[212:215], a[44:47], v[82:85]
  v_mfma_f32_16x16x32_bf16 v[86:89], a[156:159], a[32:35], v[86:89]
  ds_write_b128 v94, v[78:81] offset:5760
  v_mfma_f32_16x16x32_bf16 v[86:89], a[176:179], a[36:39], v[86:89]
  s_mov_b32 s63, 5120
  buffer_store_dwordx2 v[44:45], v20, s[44:47], s63 offen sc1
  v_mfma_f32_16x16x32_bf16 v[86:89], a[196:199], a[40:43], v[86:89]
  v_lshlrev_b32 v58, 16, v54
  v_and_b32 v59, s58, v54
  v_mfma_f32_16x16x32_bf16 v[86:89], a[216:219], a[44:47], v[86:89]
  v_lshlrev_b32 v60, 16, v55
  v_and_b32 v61, s58, v55
  v_mfma_f32_16x16x32_bf16 v[90:93], a[160:163], a[32:35], v[90:93]
  ds_write_b128 v94, v[82:85] offset:6912
  v_fmac_f32 v58, v8, v16
  v_mfma_f32_16x16x32_bf16 v[90:93], a[180:183], a[36:39], v[90:93]
  v_fmac_f32 v59, v9, v23
  v_fmac_f32 v60, v12, v26
  v_mfma_f32_16x16x32_bf16 v[90:93], a[200:203], a[40:43], v[90:93]
  v_fmac_f32 v61, v13, v68
  v_mfma_f32_16x16x32_bf16 v[90:93], a[220:223], a[44:47], v[90:93]
  ds_write_b128 v94, v[86:89] offset:8064
  s_nop 6
  ds_write_b128 v94, v[90:93] offset:12288
  s_waitcnt lgkmcnt(0)
  s_barrier
  ds_read_b128 v[74:77], v95 offset:4608
  ds_read_b128 v[78:81], v95 offset:17920
  ds_read_b128 v[82:85], v95 offset:31232
  ds_read_b128 v[86:89], v95 offset:44544
  ds_read_b128 v[28:31], v17 offset:9216
  ds_read_b128 v[32:35], v17 offset:22528
  ds_read_b128 v[36:39], v17 offset:35840
  ds_read_b128 v[40:43], v17 offset:49152
  s_waitcnt lgkmcnt(6)
  v_pk_add_f32 v[74:75], v[74:75], v[78:79]
  v_pk_add_f32 v[76:77], v[76:77], v[80:81]
  s_waitcnt lgkmcnt(4)
  v_pk_add_f32 v[82:83], v[82:83], v[86:87]
  v_pk_add_f32 v[84:85], v[84:85], v[88:89]
  v_pk_add_f32 v[74:75], v[74:75], v[82:83]
  v_pk_add_f32 v[76:77], v[76:77], v[84:85]
  v_pk_fma_f32 v[58:59], v[74:75], v[8:9], v[58:59]
  v_pk_fma_f32 v[60:61], v[76:77], v[12:13], v[60:61]
  v_cvt_pk_bf16_f32 v90, v58, v59
  v_cvt_pk_bf16_f32 v91, v60, v61
  s_mov_b32 s63, 7680
  buffer_store_dwordx2 v[90:91], v20, s[44:47], s63 offen
  s_waitcnt lgkmcnt(2)
  v_pk_add_f32 v[28:29], v[28:29], v[32:33]
  v_pk_add_f32 v[30:31], v[30:31], v[34:35]
  s_waitcnt lgkmcnt(0)
  v_pk_add_f32 v[36:37], v[36:37], v[40:41]
  v_pk_add_f32 v[38:39], v[38:39], v[42:43]
  v_pk_add_f32 v[28:29], v[28:29], v[36:37]
  v_pk_add_f32 v[30:31], v[30:31], v[38:39]
  v_pk_fma_f32 v[62:63], v[28:29], v[24:25], v[62:63]
  v_pk_fma_f32 v[64:65], v[30:31], v[66:67], v[64:65]
  v_cvt_pk_bf16_f32 v44, v62, v63
  v_cvt_pk_bf16_f32 v45, v64, v65
  s_mov_b32 s63, 0
  buffer_store_dwordx2 v[44:45], v21, s[44:47], s63 offen
L_end:
  s_endpgm
L_far_2:
  s_lshr_b32 s48, s74, 1
  s_lshl_b32 s48, s48, 5
  s_add_u32 s48, s48, s73
  s_mul_i32 s48, s48, 40
  s_and_b32 s49, s74, 1
  s_lshl2_add_u32 s49, s49, s53
  s_add_u32 s48, s48, s49
  s_mul_i32 s48, s48, 384
  v_lshrrev_b32 v121, 3, v1
  v_min_u32 v121, 4, v121
  v_mul_u32_u24 v121, 3072, v121
  s_waitcnt vmcnt(0)
  v_and_b32 v118, 7, v1
  v_min_u32 v118, 2, v118
  v_lshl_add_u32 v118, v118, 7, v121
  buffer_load_dword v118, v118, s[28:31], s48 offen
  s_mul_i32 s61, s3, 205
  s_lshr_b32 s61, s61, 10
  s_mul_i32 s62, s61, 5
  s_sub_u32 s60, s3, s62
  s_lshl2_add_u32 s60, s60, s53
  s_lshr_b32 s62, s60, 1
  s_mul_i32 s62, s62, 238
  s_and_b32 s63, s60, 1
  s_add_u32 s62, s62, s63
  s_add_u32 s62, s62, s60
  s_mul_i32 s63, s60, 480
  s_sub_u32 s63, s63, 7676
  s_cmp_lt_u32 s60, 16
  s_cselect_b32 s62, s62, s63
  s_cselect_b32 s63, 1, 240
  s_mul_i32 s64, s61, 15
  s_add_u32 s62, s62, s64
  s_add_u32 s63, s63, s62
  s_lshl_b32 s4, s62, 10
  s_lshl_b32 s5, s63, 10
  s_lshr_b32 s62, s61, 1
  s_mul_i32 s62, s62, 245760
  s_lshl_b32 s60, s60, 6
  s_add_u32 s60, s60, s62
  s_and_b32 s72, s61, 1
  v_mul_u32_u24 v101, 1280, v14
  v_lshl_add_u32 v101, v15, 4, v101
  v_add_u32 v101, s60, v101
  v_lshrrev_b32 v102, 5, v1
  s_mul_i32 s62, s72, 51200
  v_mul_u32_u24 v102, s62, v102
  v_add_u32 v102, v102, v101
  s_lshl_b32 s62, s3, 6
  s_mul_i32 s63, s53, 1228800
  s_add_u32 s62, s62, s63
  s_add_u32 s59, s62, 2560
  v_mul_u32_u24 v103, 7680, v14
  v_lshl_add_u32 v103, v15, 4, v103
  v_lshlrev_b32 v140, 16, v104
  v_and_b32 v141, s58, v104
  v_lshlrev_b32 v142, 16, v105
  v_and_b32 v143, s58, v105
  v_mul_f32 v144, 0xbfb8aa3b, v140
  v_mul_f32 v145, 0xbfb8aa3b, v141
  v_mul_f32 v146, 0xbfb8aa3b, v142
  v_mul_f32 v147, 0xbfb8aa3b, v143
  v_exp_f32 v144, v144
  v_exp_f32 v145, v145
  v_exp_f32 v146, v146
  v_exp_f32 v147, v147
  v_add_f32 v144, 1.0, v144
  v_add_f32 v145, 1.0, v145
  v_add_f32 v146, 1.0, v146
  v_add_f32 v147, 1.0, v147
  v_rcp_f32 v144, v144
  v_rcp_f32 v145, v145
  v_rcp_f32 v146, v146
  v_rcp_f32 v147, v147
  v_mul_f32 v140, v140, v144
  v_mul_f32 v141, v141, v145
  v_mul_f32 v142, v142, v146
  v_mul_f32 v143, v143, v147
  v_cvt_pk_bf16_f32 v140, v140, v141
  v_cvt_pk_bf16_f32 v141, v142, v143
  s_mul_i32 s60, s53, 320
  v_add_u32 v144, s60, v9
  s_mov_b32 exec_hi, 0xff
  ds_write_b64 v144, v[140:141] offset:17920
  s_mov_b64 exec, -1
  s_branch L_back_3
L_far_9:
L_pad_ii:
  s_cbranch_execz L_wret_5
  ds_read_b128 v[210:213], v7 offset:2560
  ds_read_b128 v[214:217], v7 offset:3840
  ds_read2st64_b32 v[218:219], v8 offset0:14 offset1:19
  ds_read_b128 v[200:203], v7 offset:0
  ds_read_b128 v[204:207], v7 offset:1280
  ds_read2st64_b32 v[208:209], v8 offset0:4 offset1:9
  s_lshl1_add_u32 m0, s78, 90112
  s_mul_i32 s49, s72, 184320
  s_add_u32 s49, s49, 0
  buffer_load_dwordx4 v101, s[32:35], s49 offen lds
  s_lshl1_add_u32 m0, s78, 91136
  s_mul_i32 s49, s72, 184320
  s_add_u32 s49, s49, 20480
  buffer_load_dwordx4 v101, s[32:35], s49 offen lds
  s_waitcnt lgkmcnt(2)
  v_pk_fma_f32 v[104:105], v[104:105], v[210:211], v[200:201]
  v_pk_fma_f32 v[106:107], v[106:107], v[212:213], v[202:203]
  s_waitcnt lgkmcnt(1)
  v_pk_fma_f32 v[108:109], v[108:109], v[214:215], v[204:205]
  v_pk_fma_f32 v[110:111], v[110:111], v[216:217], v[206:207]
  s_waitcnt lgkmcnt(0)
  v_pk_fma_f32 v[112:113], v[112:113], v[218:219], v[208:209]
  v_pk_fma_f32 v[190:191], v[190:191], v[210:211], v[200:201]
  v_pk_fma_f32 v[192:193], v[192:193], v[212:213], v[202:203]
  v_pk_fma_f32 v[194:195], v[194:195], v[214:215], v[204:205]
  v_pk_fma_f32 v[196:197], v[196:197], v[216:217], v[206:207]
  v_pk_fma_f32 v[198:199], v[198:199], v[218:219], v[208:209]
  v_cvt_pk_bf16_f32 v140, v104, v105
  v_cvt_pk_bf16_f32 v141, v106, v107
  s_lshl1_add_u32 m0, s78, 92160
  s_mul_i32 s49, s72, -20480
  s_add_u32 s49, s49, 61440
  buffer_load_dwordx4 v102, s[32:35], s49 offen lds
  v_cvt_pk_bf16_f32 v142, v112, v112
  v_cvt_pk_bf16_f32 v144, v108, v109
  v_cvt_pk_bf16_f32 v145, v110, v111
  v_mfma_f32_16x16x32_bf16 v[200:203], v[140:143], a[96:99], 0
  v_cvt_pk_bf16_f32 v146, v113, v113
  v_cvt_pk_bf16_f32 v148, v190, v191
  v_mfma_f32_16x16x32_bf16 v[204:207], v[140:143], a[100:103], 0
  v_cvt_pk_bf16_f32 v149, v192, v193
  s_lshl1_add_u32 m0, s78, 93184
  s_mul_i32 s49, s72, -30720
  s_add_u32 s49, s49, 81920
  buffer_load_dwordx4 v102, s[32:35], s49 offen lds
  v_cvt_pk_bf16_f32 v150, v198, v198
  v_mfma_f32_16x16x32_bf16 v[208:211], v[144:147], a[96:99], 0
  v_cvt_pk_bf16_f32 v152, v194, v195
  v_cvt_pk_bf16_f32 v153, v196, v197
  v_mfma_f32_16x16x32_bf16 v[212:215], v[144:147], a[100:103], 0
  v_cvt_pk_bf16_f32 v154, v199, v199
  v_mfma_f32_16x16x32_bf16 v[232:235], v[148:151], a[96:99], 0
  s_mul_i32 s49, s53, 10240
  s_add_u32 m0, s49, 32768
  s_add_u32 s49, s59, 0
  buffer_load_dwordx4 v103, s[12:15], s49 offen lds
  v_mfma_f32_16x16x32_bf16 v[236:239], v[148:151], a[100:103], 0
  v_mfma_f32_16x16x32_bf16 v[240:243], v[152:155], a[96:99], 0
  v_mfma_f32_16x16x32_bf16 v[244:247], v[152:155], a[100:103], 0
  s_mul_i32 s49, s53, 10240
  s_add_u32 m0, s49, 33792
  s_add_u32 s49, s59, 122880
  buffer_load_dwordx4 v103, s[12:15], s49 offen lds
  v_pk_mul_f32 v[104:105], v[204:205], v[168:169]
  v_pk_mul_f32 v[108:109], v[200:201], v[168:169]
  v_pk_mul_f32 v[106:107], v[206:207], v[170:171]
  v_pk_mul_f32 v[110:111], v[202:203], v[170:171]
  v_pk_fma_f32 v[104:105], v[200:201], v[164:165], v[104:105]
  v_pk_fma_f32 v[108:109], v[204:205], v[164:165], v[108:109] neg_lo:[0,0,1] neg_hi:[0,0,1]
  v_pk_fma_f32 v[106:107], v[202:203], v[166:167], v[106:107]
  v_pk_fma_f32 v[110:111], v[206:207], v[166:167], v[110:111] neg_lo:[0,0,1] neg_hi:[0,0,1]
  v_pk_mul_f32 v[248:249], v[212:213], v[178:179]
  v_pk_mul_f32 v[252:253], v[208:209], v[178:179]
  v_pk_mul_f32 v[250:251], v[214:215], v[180:181]
  v_pk_mul_f32 v[254:255], v[210:211], v[180:181]
  v_pk_fma_f32 v[248:249], v[208:209], v[172:173], v[248:249]
  v_pk_fma_f32 v[252:253], v[212:213], v[172:173], v[252:253] neg_lo:[0,0,1] neg_hi:[0,0,1]
  v_pk_fma_f32 v[250:251], v[210:211], v[174:175], v[250:251]
  v_pk_fma_f32 v[254:255], v[214:215], v[174:175], v[254:255] neg_lo:[0,0,1] neg_hi:[0,0,1]
  v_pk_mul_f32 v[190:191], v[236:237], v[168:169]
  v_pk_mul_f32 v[194:195], v[232:233], v[168:169]
  v_pk_mul_f32 v[192:193], v[238:239], v[170:171]
  v_pk_mul_f32 v[196:197], v[234:235], v[170:171]
  v_pk_fma_f32 v[190:191], v[232:233], v[164:165], v[190:191]
  v_pk_fma_f32 v[194:195], v[236:237], v[164:165], v[194:195] neg_lo:[0,0,1] neg_hi:[0,0,1]
  v_pk_fma_f32 v[192:193], v[234:235], v[166:167], v[192:193]
  v_pk_fma_f32 v[196:197], v[238:239], v[166:167], v[196:197] neg_lo:[0,0,1] neg_hi:[0,0,1]
  v_pk_mul_f32 v[66:67], v[244:245], v[178:179]
  v_pk_mul_f32 v[70:71], v[240:241], v[178:179]
  v_pk_mul_f32 v[68:69], v[246:247], v[180:181]
  v_pk_mul_f32 v[72:73], v[242:243], v[180:181]
  v_pk_fma_f32 v[66:67], v[240:241], v[172:173], v[66:67]
  v_pk_fma_f32 v[70:71], v[244:245], v[172:173], v[70:71] neg_lo:[0,0,1] neg_hi:[0,0,1]
  v_pk_fma_f32 v[68:69], v[242:243], v[174:175], v[68:69]
  v_pk_fma_f32 v[72:73], v[246:247], v[174:175], v[72:73] neg_lo:[0,0,1] neg_hi:[0,0,1]
  v_cvt_pk_bf16_f32 v140, v104, v108
  v_cvt_pk_bf16_f32 v141, v105, v109
  v_cvt_pk_bf16_f32 v142, v106, v110
  v_cvt_pk_bf16_f32 v143, v107, v111
  v_cvt_pk_bf16_f32 v144, v248, v252
  v_cvt_pk_bf16_f32 v145, v249, v253
  v_mfma_f32_16x16x32_bf16 v[104:107], a[104:107], v[140:143], 0
  s_mul_i32 s49, s53, 10240
  s_add_u32 m0, s49, 34816
  s_add_u32 s49, s59, 245760
  buffer_load_dwordx4 v103, s[12:15], s49 offen lds
  v_cvt_pk_bf16_f32 v146, v250, v254
  v_cvt_pk_bf16_f32 v147, v251, v255
  v_mfma_f32_16x16x32_bf16 v[108:111], a[112:115], v[140:143], 0
  v_cvt_pk_bf16_f32 v136, -v248, -v252
  v_cvt_pk_bf16_f32 v137, -v249, -v253
  v_mfma_f32_16x16x32_bf16 v[200:203], a[108:111], v[144:147], v[104:107]
  v_cvt_pk_bf16_f32 v138, -v250, -v254
  v_cvt_pk_bf16_f32 v139, -v251, -v255
  v_mfma_f32_16x16x32_bf16 v[204:207], a[116:119], v[144:147], v[108:111]
  v_cvt_pk_bf16_f32 v148, v190, v194
  v_cvt_pk_bf16_f32 v149, v191, v195
  v_mfma_f32_16x16x32_bf16 v[208:211], a[108:111], v[136:139], v[104:107]
  v_cvt_pk_bf16_f32 v150, v192, v196
  v_cvt_pk_bf16_f32 v151, v193, v197
  v_mfma_f32_16x16x32_bf16 v[212:215], a[116:119], v[136:139], v[108:111]
  v_cvt_pk_bf16_f32 v152, v66, v70
  v_cvt_pk_bf16_f32 v153, v67, v71
  v_mfma_f32_16x16x32_bf16 v[190:193], a[104:107], v[148:151], 0
  v_cvt_pk_bf16_f32 v154, v68, v72
  v_cvt_pk_bf16_f32 v155, v69, v73
  v_mfma_f32_16x16x32_bf16 v[194:197], a[112:115], v[148:151], 0
  v_cvt_pk_bf16_f32 v112, -v66, -v70
  v_cvt_pk_bf16_f32 v113, -v67, -v71
  v_mfma_f32_16x16x32_bf16 v[232:235], a[108:111], v[152:155], v[190:193]
  v_cvt_pk_bf16_f32 v114, -v68, -v72
  v_cvt_pk_bf16_f32 v115, -v69, -v73
  v_mfma_f32_16x16x32_bf16 v[236:239], a[116:119], v[152:155], v[194:197]
  v_cvt_pk_bf16_f32 v248, v200, v201
  v_cvt_pk_bf16_f32 v249, v202, v203
  v_mfma_f32_16x16x32_bf16 v[240:243], a[108:111], v[112:115], v[190:193]
  v_cvt_pk_bf16_f32 v250, v204, v205
  v_cvt_pk_bf16_f32 v251, v206, v207
  v_mfma_f32_16x16x32_bf16 v[244:247], a[116:119], v[112:115], v[194:197]
  v_cvt_pk_bf16_f32 v252, v208, -v209
  v_cvt_pk_bf16_f32 v253, v210, -v211
  v_cvt_pk_bf16_f32 v254, v212, -v213
  v_cvt_pk_bf16_f32 v255, v214, -v215
  ds_write2_b32 v220, v248, v249 offset0:0 offset1:5
  ds_write2_b32 v220, v250, v251 offset0:40 offset1:45
  ds_write2_b32 v221, v252, v253 offset0:45 offset1:40
  ds_write2_b32 v221, v254, v255 offset0:5 offset1:0
  v_cvt_pk_bf16_f32 v66, v232, v233
  v_cvt_pk_bf16_f32 v67, v234, v235
  v_cvt_pk_bf16_f32 v68, v236, v237
  v_cvt_pk_bf16_f32 v69, v238, v239
  v_cvt_pk_bf16_f32 v70, v240, -v241
  v_cvt_pk_bf16_f32 v71, v242, -v243
  v_cvt_pk_bf16_f32 v72, v244, -v245
  v_cvt_pk_bf16_f32 v73, v246, -v247
  ds_write2_b32 v228, v66, v67 offset0:0 offset1:5
  ds_write2_b32 v228, v68, v69 offset0:40 offset1:45
  ds_write2_b32 v229, v70, v71 offset0:45 offset1:40
  ds_write2_b32 v229, v72, v73 offset0:5 offset1:0
  s_waitcnt lgkmcnt(0)
  s_barrier
  s_cmp_eq_u32 s53, 3
  s_cbranch_scc1 L_skip_16
  ds_read2st64_b32 v[136:137], v156 offset0:80 offset1:86
  ds_read2st64_b32 v[138:139], v156 offset0:92 offset1:98
  ds_read2st64_b32 v[122:123], v157 offset0:80 offset1:86
  ds_read2st64_b32 v[124:125], v157 offset0:92 offset1:98
  ds_read2st64_b32 v[164:165], v158 offset0:80 offset1:86
  ds_read2st64_b32 v[166:167], v158 offset0:92 offset1:98
  ds_read2st64_b32 v[168:169], v159 offset0:80 offset1:86
  ds_read2st64_b32 v[170:171], v159 offset0:92 offset1:98
  s_add_u32 s61, s77, 2816
  s_waitcnt lgkmcnt(6)
  v_mfma_f32_32x32x16_bf16 v[232:247], v[128:131], v[136:139], 0
  s_waitcnt lgkmcnt(4)
  v_mfma_f32_32x32x16_bf16 v[190:205], v[128:131], v[122:125], 0
  s_waitcnt lgkmcnt(2)
  s_nop 8
  v_cvt_pk_bf16_f32 v140, v232, v233
  v_bfi_b32 v140, s0, v160, v140
  v_cvt_pk_bf16_f32 v144, v234, v235
  v_mfma_f32_32x32x16_bf16 v[206:221], v[128:131], v[164:167], 0
  v_bfi_b32 v144, s0, v160, v144
  v_cvt_pk_bf16_f32 v148, v236, v237
  v_cvt_pk_bf16_f32 v141, v190, v191
  v_bfi_b32 v141, s0, v161, v141
  v_cvt_pk_bf16_f32 v145, v192, v193
  s_waitcnt lgkmcnt(0)
  v_mfma_f32_32x32x16_bf16 v[66:81], v[128:131], v[168:171], 0
  v_bfi_b32 v145, s0, v161, v145
  v_cvt_pk_bf16_f32 v149, v194, v195
  v_bfi_b32 v148, s0, v160, v148
  s_nop 1
  v_cvt_pk_bf16_f32 v142, v206, v207
  v_bfi_b32 v142, s0, v162, v142
  v_cvt_pk_bf16_f32 v146, v208, v209
  v_bfi_b32 v146, s0, v162, v146
  v_cvt_pk_bf16_f32 v150, v210, v211
  v_cvt_pk_bf16_f32 v152, v238, v239
  v_bfi_b32 v149, s0, v161, v149
  v_cvt_pk_bf16_f32 v143, v66, v67
  v_bfi_b32 v143, s0, v163, v143
  v_cvt_pk_bf16_f32 v147, v68, v69
  v_bfi_b32 v147, s0, v163, v147
  v_cvt_pk_bf16_f32 v151, v70, v71
  buffer_store_dwordx4 v[140:143], v100, s[20:23], s77 offen offset:0 sc1
  buffer_store_dwordx4 v[144:147], v100, s[20:23], s77 offen offset:1408 sc1
  v_cvt_pk_bf16_f32 v153, v196, v197
  v_bfi_b32 v150, s0, v162, v150
  v_cvt_pk_bf16_f32 v154, v212, v213
  v_bfi_b32 v151, s0, v163, v151
  v_cvt_pk_bf16_f32 v155, v72, v73
  v_bfi_b32 v152, s0, v160, v152
  v_bfi_b32 v153, s0, v161, v153
  v_bfi_b32 v154, s0, v162, v154
  v_bfi_b32 v155, s0, v163, v155
  buffer_store_dwordx4 v[148:151], v100, s[20:23], s61 offen offset:0 sc1
  buffer_store_dwordx4 v[152:155], v100, s[20:23], s61 offen offset:1408 sc1
  s_nop 1
L_skip_16:
  s_lshl1_add_u32 m0, s78, 94208
  s_mul_i32 s49, s72, 40960
  s_add_u32 s49, s49, 122880
  buffer_load_dwordx4 v102, s[32:35], s49 offen lds
  s_mul_i32 s49, s53, 10240
  s_add_u32 m0, s49, 35840
  s_add_u32 s49, s59, 368640
  buffer_load_dwordx4 v103, s[12:15], s49 offen lds
  s_mul_i32 s49, s53, 10240
  s_add_u32 m0, s49, 36864
  s_add_u32 s49, s59, 491520
  buffer_load_dwordx4 v103, s[12:15], s49 offen lds
  s_mul_i32 s49, s53, 10240
  s_add_u32 m0, s49, 37888
  s_add_u32 s49, s59, 614400
  buffer_load_dwordx4 v103, s[12:15], s49 offen lds
  s_mul_i32 s49, s53, 10240
  s_add_u32 m0, s49, 38912
  s_add_u32 s49, s59, 737280
  buffer_load_dwordx4 v103, s[12:15], s49 offen lds
  s_mul_i32 s49, s53, 10240
  s_add_u32 m0, s49, 39936
  s_add_u32 s49, s59, 860160
  buffer_load_dwordx4 v103, s[12:15], s49 offen lds
  s_mul_i32 s49, s53, 10240
  s_add_u32 m0, s49, 40960
  s_add_u32 s49, s59, 983040
  buffer_load_dwordx4 v103, s[12:15], s49 offen lds
  s_mul_i32 s49, s53, 10240
  s_add_u32 m0, s49, 41984
  s_add_u32 s49, s59, 1105920
  buffer_load_dwordx4 v103, s[12:15], s49 offen lds
  s_lshl1_add_u32 m0, s78, 95232
  s_mul_i32 s49, s72, 30720
  s_add_u32 s49, s49, 143360
  buffer_load_dwordx4 v102, s[32:35], s49 offen lds
  s_mul_i32 s63, s53, 10240
  s_add_u32 s63, s63, 32768
  v_add_u32 v136, s63, v99
  s_mul_i32 s60, s53, 320
  s_add_u32 s60, s60, 17920
  v_lshl_add_u32 v138, v11, 3, s60
  s_lshl_b32 s60, s53, 7
  v_lshl_add_u32 v139, v11, 4, s60
  s_mul_i32 s61, s3, 205
  s_lshr_b32 s61, s61, 12
  s_cmp_eq_u32 s61, 2
  s_cselect_b32 s50, 1.0, 0
  s_mul_i32 s62, s61, 20
  s_sub_u32 s62, s3, s62
  s_lshl4_add_u32 s63, s61, s62
  s_lshl2_add_u32 s64, s61, s62
  s_add_u32 s64, s64, 48
  s_cmp_lt_u32 s62, 16
  s_cselect_b32 s63, s63, s64
  s_add_u32 s64, s74, 80
  s_cmp_ge_u32 s73, 22
  s_cselect_b32 s61, s63, s64
  s_lshl_b32 s61, s61, 7
  s_add_u32 s75, s61, 36864
  s_lshl1_add_u32 s60, s78, 90112
  v_add_u32 v140, s60, v99
  s_waitcnt vmcnt(0)
  ds_read_b64_tr_b16 v[104:105], v140 offset:0
  ds_read_b64_tr_b16 v[106:107], v140 offset:1024
  ds_read_b64_tr_b16 v[108:109], v140 offset:32
  ds_read_b64_tr_b16 v[110:111], v140 offset:1056
  ds_read_b64_tr_b16 v[112:113], v140 offset:2048
  ds_read_b64_tr_b16 v[114:115], v140 offset:3072
  ds_read_b64_tr_b16 v[116:117], v140 offset:2080
  ds_read_b64_tr_b16 v[118:119], v140 offset:3104
  ds_read_b64_tr_b16 v[120:121], v140 offset:4096
  ds_read_b64_tr_b16 v[122:123], v140 offset:5120
  ds_read_b64_tr_b16 v[124:125], v140 offset:4128
  ds_read_b64_tr_b16 v[126:127], v140 offset:5152
  s_add_u32 s62, s4, 12124160
  s_waitcnt lgkmcnt(10)
  buffer_store_dwordx4 v[104:107], v7, s[20:23], s62 offen sc1
  s_add_u32 s62, s5, 12124160
  s_waitcnt lgkmcnt(8)
  buffer_store_dwordx4 v[108:111], v7, s[20:23], s62 offen sc1
  s_add_u32 s62, s4, 12129280
  s_waitcnt lgkmcnt(6)
  buffer_store_dwordx4 v[112:115], v7, s[20:23], s62 offen sc1
  s_add_u32 s62, s5, 12129280
  s_waitcnt lgkmcnt(4)
  buffer_store_dwordx4 v[116:119], v7, s[20:23], s62 offen sc1
  s_add_u32 s62, s4, 12134400
  s_waitcnt lgkmcnt(2)
  buffer_store_dwordx4 v[120:123], v7, s[20:23], s62 offen sc1
  s_add_u32 s62, s5, 12134400
  s_waitcnt lgkmcnt(0)
  buffer_store_dwordx4 v[124:127], v7, s[20:23], s62 offen sc1
  s_nop 1
  s_add_u32 m0, s78, 139264
  s_add_u32 s48, s71, 49152
  buffer_load_dwordx4 v22, s[28:31], s48 offen offset:0 lds
  buffer_load_dwordx4 v23, s[28:31], s48 offen offset:1024 lds
  buffer_load_dwordx4 v24, s[28:31], s48 offen offset:2048 lds
  s_add_u32 m0, s78, 151552
  s_add_u32 s48, s71, 73728
  buffer_load_dwordx4 v22, s[28:31], s48 offen offset:0 lds
  buffer_load_dwordx4 v23, s[28:31], s48 offen offset:1024 lds
  buffer_load_dwordx4 v24, s[28:31], s48 offen offset:2048 lds
  ds_read2_b64 v[232:235], v138 offset0:0 offset1:4
  ds_read2_b64 v[236:239], v138 offset0:8 offset1:12
  ds_read2_b64 v[240:243], v138 offset0:16 offset1:20
  ds_read2_b64 v[244:247], v138 offset0:24 offset1:28
  ds_read2_b64 v[248:251], v138 offset0:32 offset1:36
  ds_read_b64_tr_b16 v[140:141], v136 offset:0
  ds_read_b64_tr_b16 v[142:143], v136 offset:1024
  ds_read_b64_tr_b16 v[144:145], v136 offset:32
  ds_read_b64_tr_b16 v[146:147], v136 offset:1056
  ds_read_b64_tr_b16 v[148:149], v136 offset:2048
  ds_read_b64_tr_b16 v[150:151], v136 offset:3072
  ds_read_b64_tr_b16 v[152:153], v136 offset:2080
  ds_read_b64_tr_b16 v[154:155], v136 offset:3104
  ds_read_b64_tr_b16 v[104:105], v136 offset:4096
  ds_read_b64_tr_b16 v[106:107], v136 offset:5120
  ds_read_b64_tr_b16 v[108:109], v136 offset:4128
  ds_read_b64_tr_b16 v[110:111], v136 offset:5152
  ds_read_b64_tr_b16 v[112:113], v136 offset:6144
  ds_read_b64_tr_b16 v[114:115], v136 offset:7168
  ds_read_b64_tr_b16 v[116:117], v136 offset:6176
  ds_read_b64_tr_b16 v[118:119], v136 offset:7200
  ds_read_b64_tr_b16 v[120:121], v136 offset:8192
  ds_read_b64_tr_b16 v[122:123], v136 offset:9216
  ds_read_b64_tr_b16 v[124:125], v136 offset:8224
  ds_read_b64_tr_b16 v[126:127], v136 offset:9248
  s_waitcnt lgkmcnt(15)
  v_mfma_f32_16x16x32_bf16 v[164:167], v[140:143], v[232:235], 0
  v_mfma_f32_16x16x32_bf16 v[168:171], v[144:147], v[232:235], 0
  s_waitcnt lgkmcnt(14)
  v_mfma_f32_16x16x32_bf16 v[164:167], v[148:151], v[236:239], v[164:167]
  s_waitcnt lgkmcnt(12)
  v_mfma_f32_16x16x32_bf16 v[168:171], v[152:155], v[236:239], v[168:171]
  s_waitcnt lgkmcnt(10)
  v_mfma_f32_16x16x32_bf16 v[164:167], v[104:107], v[240:243], v[164:167]
  s_waitcnt lgkmcnt(8)
  v_mfma_f32_16x16x32_bf16 v[168:171], v[108:111], v[240:243], v[168:171]
  s_waitcnt lgkmcnt(6)
  v_mfma_f32_16x16x32_bf16 v[164:167], v[112:115], v[244:247], v[164:167]
  s_waitcnt lgkmcnt(4)
  v_mfma_f32_16x16x32_bf16 v[168:171], v[116:119], v[244:247], v[168:171]
  s_waitcnt lgkmcnt(2)
  v_mfma_f32_16x16x32_bf16 v[164:167], v[120:123], v[248:251], v[164:167]
  s_waitcnt lgkmcnt(0)
  v_mfma_f32_16x16x32_bf16 v[168:171], v[124:127], v[248:251], v[168:171]
  s_nop 5
  ds_write_b128 v139, v[164:167] offset:19200
  s_nop 0
  ds_write_b128 v139, v[168:171] offset:19264
  s_waitcnt lgkmcnt(0)
  s_barrier
  s_add_u32 m0, s78, 65536
  s_add_u32 s48, s71, 98304
  buffer_load_dwordx4 v22, s[28:31], s48 offen offset:0 lds
  buffer_load_dwordx4 v23, s[28:31], s48 offen offset:1024 lds
  buffer_load_dwordx4 v24, s[28:31], s48 offen offset:2048 lds
  s_add_u32 m0, s78, 77824
  s_add_u32 s48, s71, 122880
  buffer_load_dwordx4 v22, s[28:31], s48 offen offset:0 lds
  buffer_load_dwordx4 v23, s[28:31], s48 offen offset:1024 lds
  buffer_load_dwordx4 v24, s[28:31], s48 offen offset:2048 lds
  v_and_b32 v224, 4, v1
  v_bfe_u32 v225, v1, 3, 1
  v_lshl_add_u32 v224, v225, 1, v224
  v_bfe_u32 v225, v1, 1, 1
  v_add_u32 v224, v224, v225
  v_and_b32 v225, 1, v1
  v_lshlrev_b32 v225, 9, v225
  v_lshl_add_u32 v227, v224, 8, s52
  v_lshlrev_b32 v226, 2, v13
  v_mul_u32_u24 v226, v226, v227
  v_sub_u32 v226, v226, v225
  v_and_b32 v228, 2047, v226
  v_cvt_f32_u32 v228, v228
  v_mul_f32 v228, 0x3a000000, v228
  v_sin_f32 v229, v228
  v_cos_f32 v228, v228
  v_add_u32 v226, v226, v227
  v_mul_f32 v229, 0x5f800000, v229
  v_mul_f32 v228, 0x5f800000, v228
  v_cvt_pk_bf16_f32 v132, v228, -v229
  v_and_b32 v228, 2047, v226
  v_cvt_f32_u32 v228, v228
  v_mul_f32 v228, 0x3a000000, v228
  v_sin_f32 v229, v228
  v_cos_f32 v228, v228
  v_add_u32 v226, v226, v227
  v_mul_f32 v229, 0x5f800000, v229
  v_mul_f32 v228, 0x5f800000, v228
  v_cvt_pk_bf16_f32 v133, v228, -v229
  v_and_b32 v228, 2047, v226
  v_cvt_f32_u32 v228, v228
  v_mul_f32 v228, 0x3a000000, v228
  v_sin_f32 v229, v228
  v_cos_f32 v228, v228
  v_add_u32 v226, v226, v227
  v_mul_f32 v229, 0x5f800000, v229
  v_mul_f32 v228, 0x5f800000, v228
  v_cvt_pk_bf16_f32 v134, v228, -v229
  v_and_b32 v228, 2047, v226
  v_cvt_f32_u32 v228, v228
  v_mul_f32 v228, 0x3a000000, v228
  v_sin_f32 v229, v228
  v_cos_f32 v228, v228
  v_add_u32 v226, v226, v227
  v_mul_f32 v229, 0x5f800000, v229
  v_mul_f32 v228, 0x5f800000, v228
  v_cvt_pk_bf16_f32 v135, v228, -v229
  s_waitcnt vmcnt(12)
  s_barrier
  s_cmp_lg_u32 s53, 0
  s_cbranch_scc1 L_skip_17
  ds_read_b128 v[232:235], v7 offset:19200
  ds_read_b128 v[236:239], v7 offset:19328
  ds_read_b128 v[240:243], v7 offset:19456
  ds_read_b128 v[244:247], v7 offset:19584
  s_mov_b64 exec, 0xff
  s_waitcnt lgkmcnt(2)
  v_pk_add_f32 v[232:233], v[232:233], v[236:237]
  s_waitcnt lgkmcnt(0)
  v_pk_add_f32 v[240:241], v[240:241], v[244:245]
  v_pk_add_f32 v[232:233], v[232:233], v[240:241]
  v_cvt_pk_bf16_f32 v232, v232, v233
  v_and_b32 v233, s58, v232
  v_lshlrev_b32 v232, 16, v232
  v_add_f32 v233, s50, v233
  v_add_f32 v232, s50, v232
  v_cvt_pk_bf16_f32 v232, v232, v233
  v_mov_b32 v233, s54
  v_pk_add_f32 v[234:235], v[234:235], v[238:239]
  v_pk_add_f32 v[242:243], v[242:243], v[246:247]
  v_pk_add_f32 v[234:235], v[234:235], v[242:243]
  v_cvt_pk_bf16_f32 v234, v234, v235
  v_and_b32 v235, s58, v234
  v_lshlrev_b32 v234, 16, v234
  v_add_f32 v235, s50, v235
  v_add_f32 v234, s50, v234
  v_cvt_pk_bf16_f32 v234, v234, v235
  v_mov_b32 v235, s54
  buffer_store_dwordx4 v[232:235], v7, s[20:23], s75 offen sc1
  s_mov_b64 exec, -1
  s_nop 1
L_skip_17:
  s_lshl2_add_u32 s49, s52, s53
  s_mul_i32 s49, s49, 6144
  s_add_u32 s49, s49, 5832704
  buffer_store_dwordx4 v[18:21], v7, s[20:23], s49 offen offset:0 sc1
  s_add_u32 m0, s78, 90112
  s_add_u32 s48, s71, 147456
  buffer_load_dwordx4 v22, s[28:31], s48 offen offset:0 lds
  buffer_load_dwordx4 v23, s[28:31], s48 offen offset:1024 lds
  buffer_load_dwordx4 v24, s[28:31], s48 offen offset:2048 lds
  s_add_u32 m0, s78, 102400
  s_add_u32 s48, s71, 172032
  buffer_load_dwordx4 v22, s[28:31], s48 offen offset:0 lds
  buffer_load_dwordx4 v23, s[28:31], s48 offen offset:1024 lds
  buffer_load_dwordx4 v24, s[28:31], s48 offen offset:2048 lds
  s_waitcnt vmcnt(13)
  v_add_u32 v6, 114688, v25
  ds_read_b64_tr_b16 a[0:1], v6 offset:0
  ds_read_b64_tr_b16 a[2:3], v6 offset:1536
  ds_read_b64_tr_b16 a[4:5], v6 offset:32
  ds_read_b64_tr_b16 a[6:7], v6 offset:1568
  ds_read_b64_tr_b16 a[8:9], v6 offset:64
  ds_read_b64_tr_b16 a[10:11], v6 offset:1600
  ds_read_b64_tr_b16 a[12:13], v6 offset:12288
  ds_read_b64_tr_b16 a[14:15], v6 offset:13824
  ds_read_b64_tr_b16 a[16:17], v6 offset:12320
  ds_read_b64_tr_b16 a[18:19], v6 offset:13856
  ds_read_b64_tr_b16 a[20:21], v6 offset:12352
  ds_read_b64_tr_b16 a[22:23], v6 offset:13888
  ds_read_b64_tr_b16 a[24:25], v6 offset:24576
  ds_read_b64_tr_b16 a[26:27], v6 offset:26112
  ds_read_b64_tr_b16 a[28:29], v6 offset:24608
  ds_read_b64_tr_b16 a[30:31], v6 offset:26144
  ds_read_b64_tr_b16 a[32:33], v6 offset:24640
  ds_read_b64_tr_b16 a[34:35], v6 offset:26176
  ds_read_b64_tr_b16 a[36:37], v6 offset:36864
  ds_read_b64_tr_b16 a[38:39], v6 offset:38400
  ds_read_b64_tr_b16 a[40:41], v6 offset:36896
  ds_read_b64_tr_b16 a[42:43], v6 offset:38432
  ds_read_b64_tr_b16 a[44:45], v6 offset:36928
  ds_read_b64_tr_b16 a[46:47], v6 offset:38464
  s_waitcnt lgkmcnt(0)
  s_add_u32 m0, s78, 114688
  s_add_u32 s48, s71, 196608
  buffer_load_dwordx4 v22, s[28:31], s48 offen offset:0 lds
  buffer_load_dwordx4 v23, s[28:31], s48 offen offset:1024 lds
  buffer_load_dwordx4 v24, s[28:31], s48 offen offset:2048 lds
  s_waitcnt vmcnt(0)
  v_add_u32 v6, 65536, v25
  ds_read_b64_tr_b16 a[48:49], v6 offset:0
  ds_read_b64_tr_b16 a[50:51], v6 offset:1536
  ds_read_b64_tr_b16 a[52:53], v6 offset:32
  ds_read_b64_tr_b16 a[54:55], v6 offset:1568
  ds_read_b64_tr_b16 a[56:57], v6 offset:64
  ds_read_b64_tr_b16 a[58:59], v6 offset:1600
  ds_read_b64_tr_b16 a[60:61], v6 offset:12288
  ds_read_b64_tr_b16 a[62:63], v6 offset:13824
  ds_read_b64_tr_b16 a[64:65], v6 offset:12320
  ds_read_b64_tr_b16 a[66:67], v6 offset:13856
  ds_read_b64_tr_b16 a[68:69], v6 offset:12352
  ds_read_b64_tr_b16 a[70:71], v6 offset:13888
  ds_read_b64_tr_b16 a[72:73], v6 offset:24576
  ds_read_b64_tr_b16 a[74:75], v6 offset:26112
  ds_read_b64_tr_b16 a[76:77], v6 offset:24608
  ds_read_b64_tr_b16 a[78:79], v6 offset:26144
  ds_read_b64_tr_b16 a[80:81], v6 offset:24640
  ds_read_b64_tr_b16 a[82:83], v6 offset:26176
  ds_read_b64_tr_b16 a[84:85], v6 offset:36864
  ds_read_b64_tr_b16 a[86:87], v6 offset:38400
  ds_read_b64_tr_b16 a[88:89], v6 offset:36896
  ds_read_b64_tr_b16 a[90:91], v6 offset:38432
  ds_read_b64_tr_b16 a[92:93], v6 offset:36928
  ds_read_b64_tr_b16 a[94:95], v6 offset:38464
  v_add_u32 v6, 114688, v25
  ds_read_b64_tr_b16 a[96:97], v6 offset:0
  ds_read_b64_tr_b16 a[98:99], v6 offset:1536
  ds_read_b64_tr_b16 a[100:101], v6 offset:32
  ds_read_b64_tr_b16 a[102:103], v6 offset:1568
  ds_read_b64_tr_b16 a[104:105], v6 offset:64
  ds_read_b64_tr_b16 a[106:107], v6 offset:1600
  s_waitcnt lgkmcnt(0)
  s_branch L_back_10
L_far_18:
L_pad_m2a:
  s_cbranch_execz L_pad_pg4
  s_mov_b32 s65, 36864
  buffer_load_dwordx4 v[136:139], v7, s[20:23], s65 offen offset:0 sc1
  buffer_load_dwordx4 v[140:143], v7, s[20:23], s65 offen offset:1024 sc1
  buffer_load_dwordx4 v[144:147], v7, s[20:23], s65 offen offset:2048 sc1
  buffer_load_dwordx4 v[148:151], v7, s[20:23], s65 offen offset:3072 sc1
  s_mov_b32 s65, 40960
  buffer_load_dwordx4 v[102:105], v7, s[20:23], s65 offen offset:0 sc1
  buffer_load_dwordx4 v[106:109], v7, s[20:23], s65 offen offset:1024 sc1
  buffer_load_dwordx4 v[110:113], v7, s[20:23], s65 offen offset:2048 sc1
  s_waitcnt vmcnt(10)
  buffer_load_dwordx4 v[114:117], v7, s[20:23], s65 offen offset:3072 sc1
  s_mov_b32 s65, 45056
  buffer_load_dwordx4 v[232:235], v7, s[20:23], s65 offen offset:0 sc1
  buffer_load_dwordx4 v[236:239], v7, s[20:23], s65 offen offset:1024 sc1
  buffer_load_dwordx4 v[240:243], v7, s[20:23], s65 offen offset:2048 sc1
  v_lshlrev_b32 v176, 5, v12
  v_lshl_add_u32 v176, v13, 2, v176
  v_add_u32 v177, 16, v176
  v_add_u32 v178, 8, v176
  v_add_u32 v179, 24, v176
  v_mul_u32_u24 v180, 2560, v13
  v_lshl_add_u32 v180, v12, 3, v180
  v_add_u32 v181, 4, v180
  s_branch L_back_19
L_far_20:
  s_waitcnt vmcnt(12)
  v_xor_b32 v6, s54, v139
  v_bitop3_b32 v6, v143, s54, v6 bitop3:0xbe
  v_bitop3_b32 v6, v147, s54, v6 bitop3:0xbe
  v_bitop3_b32 v6, v151, s54, v6 bitop3:0xbe
  v_bitop3_b32 v6, v105, s54, v6 bitop3:0xbe
  v_bitop3_b32 v6, v109, s54, v6 bitop3:0xbe
  v_bitop3_b32 v6, v113, s54, v6 bitop3:0xbe
  v_bitop3_b32 v6, v117, s54, v6 bitop3:0xbe
  v_bitop3_b32 v6, v235, s54, v6 bitop3:0xbe
  v_bitop3_b32 v6, v239, s54, v6 bitop3:0xbe
  v_bitop3_b32 v6, v243, s54, v6 bitop3:0xbe
  v_cmp_ne_u32 vcc, 0, v6
  s_cbranch_vccnz L_slow_22
L_ok_23:
  v_and_b32 v137, s58, v136
  v_lshlrev_b32 v136, 16, v136
  v_and_b32 v139, s58, v138
  v_lshlrev_b32 v138, 16, v138
  ds_write2st64_b32 v176, v136, v137 offset0:20 offset1:25
  ds_write2st64_b32 v177, v138, v139 offset0:20 offset1:25
  v_and_b32 v141, s58, v140
  v_lshlrev_b32 v140, 16, v140
  v_and_b32 v143, s58, v142
  v_lshlrev_b32 v142, 16, v142
  ds_write2st64_b32 v178, v140, v141 offset0:20 offset1:25
  ds_write2st64_b32 v179, v142, v143 offset0:20 offset1:25
  v_and_b32 v145, s58, v144
  v_lshlrev_b32 v144, 16, v144
  v_and_b32 v147, s58, v146
  v_lshlrev_b32 v146, 16, v146
  ds_write2st64_b32 v176, v144, v145 offset0:30 offset1:35
  ds_write2st64_b32 v177, v146, v147 offset0:30 offset1:35
  v_and_b32 v149, s58, v148
  v_lshlrev_b32 v148, 16, v148
  v_and_b32 v151, s58, v150
  v_lshlrev_b32 v150, 16, v150
  ds_write2st64_b32 v178, v148, v149 offset0:30 offset1:35
  ds_write2st64_b32 v179, v150, v151 offset0:30 offset1:35
  v_and_b32 v103, s58, v102
  v_lshlrev_b32 v102, 16, v102
  v_and_b32 v105, s58, v104
  v_lshlrev_b32 v104, 16, v104
  ds_write2st64_b32 v176, v102, v103 offset0:40 offset1:45
  ds_write2st64_b32 v177, v104, v105 offset0:40 offset1:45
  v_and_b32 v107, s58, v106
  v_lshlrev_b32 v106, 16, v106
  v_and_b32 v109, s58, v108
  v_lshlrev_b32 v108, 16, v108
  ds_write2st64_b32 v178, v106, v107 offset0:40 offset1:45
  ds_write2st64_b32 v179, v108, v109 offset0:40 offset1:45
  v_and_b32 v111, s58, v110
  v_lshlrev_b32 v110, 16, v110
  v_and_b32 v113, s58, v112
  v_lshlrev_b32 v112, 16, v112
  ds_write2st64_b32 v176, v110, v111 offset0:50 offset1:55
  ds_write2st64_b32 v177, v112, v113 offset0:50 offset1:55
  v_and_b32 v115, s58, v114
  v_lshlrev_b32 v114, 16, v114
  v_and_b32 v117, s58, v116
  v_lshlrev_b32 v116, 16, v116
  ds_write2st64_b32 v178, v114, v115 offset0:50 offset1:55
  ds_write2st64_b32 v179, v116, v117 offset0:50 offset1:55
  v_and_b32 v233, s58, v232
  v_lshlrev_b32 v232, 16, v232
  v_and_b32 v235, s58, v234
  v_lshlrev_b32 v234, 16, v234
  ds_write2st64_b32 v180, v232, v233 offset0:24 offset1:29
  ds_write2st64_b32 v181, v234, v235 offset0:24 offset1:29
  v_and_b32 v237, s58, v236
  v_lshlrev_b32 v236, 16, v236
  v_and_b32 v239, s58, v238
  v_lshlrev_b32 v238, 16, v238
  ds_write2st64_b32 v180, v236, v237 offset0:44 offset1:49
  ds_write2st64_b32 v181, v238, v239 offset0:44 offset1:49
  s_branch L_back_21
L_far_30:
  v_mov_b32 v2, s1
  s_mov_b64 exec, 1
  buffer_store_dword v2, v8, s[20:23], 0 offen offset:0 sc1
  s_mov_b64 exec, -1
  s_branch L_back_31
L_slow_6:
L_pad_s0r0:
  s_cbranch_execz L_wret_5
  s_add_u32 s57, s57, 1
  s_cmp_gt_u32 s57, 1000000
  s_cbranch_scc1 L_out_8
  s_wqm_b64 exec, vcc
  s_mov_b32 s65, 4096
  buffer_load_dwordx4 v[216:219], v123, s[20:23], s65 offen sc1
  buffer_load_dwordx4 v[200:203], v122, s[20:23], s65 offen offset:0 sc1
  buffer_load_dwordx4 v[204:207], v122, s[20:23], s65 offen offset:128 sc1
  buffer_load_dwordx4 v[208:211], v122, s[20:23], s65 offen offset:256 sc1
  buffer_load_dwordx4 v[212:215], v122, s[20:23], s65 offen offset:384 sc1
  s_waitcnt vmcnt(0)
  v_xor_b32 v200, v136, v200
  v_xor_b32 v201, v137, v201
  v_xor_b32 v202, v138, v202
  v_xor_b32 v203, v139, v203
  v_xor_b32 v204, v136, v204
  v_xor_b32 v205, v137, v205
  v_xor_b32 v206, v138, v206
  v_xor_b32 v207, v139, v207
  v_xor_b32 v208, v136, v208
  v_xor_b32 v209, v137, v209
  v_xor_b32 v210, v138, v210
  v_xor_b32 v211, v139, v211
  v_xor_b32 v212, v136, v212
  v_xor_b32 v213, v137, v213
  v_xor_b32 v214, v138, v214
  v_xor_b32 v215, v139, v215
  v_xor_b32 v216, v136, v216
  v_xor_b32 v217, v137, v217
  v_xor_b32 v218, v138, v218
  v_xor_b32 v219, v139, v219
  v_or3_b32 v6, v200, v201, v202
  v_or3_b32 v6, v6, v203, v204
  v_or3_b32 v6, v6, v205, v206
  v_or3_b32 v6, v6, v207, v208
  v_or3_b32 v6, v6, v209, v210
  v_or3_b32 v6, v6, v211, v212
  v_or3_b32 v6, v6, v213, v214
  v_or3_b32 v6, v6, v215, v216
  v_or3_b32 v6, v6, v217, v218
  v_bitop3_b32 v6, v6, v219, 3 bitop3:0xa8
  v_cmp_ne_u32 vcc, 0, v6
  s_cbranch_vccnz L_slow_6
L_out_8:
  s_mov_b64 exec, -1
  s_nop 4
  s_branch L_ok_7
L_slow_13:
L_pad_s1r:
  s_cbranch_execz L_wret_12
  s_add_u32 s57, s57, 1
  s_cmp_gt_u32 s57, 1000000
  s_cbranch_scc1 L_out_15
  s_wqm_b64 exec, vcc
  s_add_u32 s65, s75, 327680
  buffer_load_dwordx4 v[136:139], v224, s[20:23], s65 offen sc1
  s_add_u32 s65, s75, 507904
  buffer_load_dwordx4 v[140:143], v224, s[20:23], s65 offen sc1
  s_add_u32 s65, s75, 688128
  buffer_load_dwordx4 v[144:147], v224, s[20:23], s65 offen sc1
  s_add_u32 s65, s75, 868352
  buffer_load_dwordx4 v[148:151], v224, s[20:23], s65 offen sc1
  s_waitcnt vmcnt(0)
  v_xor_b32 v102, v160, v136
  v_xor_b32 v106, v161, v137
  v_xor_b32 v110, v162, v138
  v_xor_b32 v114, v163, v139
  v_xor_b32 v103, v160, v140
  v_xor_b32 v107, v161, v141
  v_xor_b32 v111, v162, v142
  v_xor_b32 v115, v163, v143
  v_xor_b32 v104, v160, v144
  v_xor_b32 v108, v161, v145
  v_xor_b32 v112, v162, v146
  v_xor_b32 v116, v163, v147
  v_xor_b32 v105, v160, v148
  v_xor_b32 v109, v161, v149
  v_xor_b32 v113, v162, v150
  v_xor_b32 v117, v163, v151
  v_or3_b32 v6, v102, v106, v110
  v_or3_b32 v6, v6, v114, v103
  v_or3_b32 v6, v6, v107, v111
  v_or3_b32 v6, v6, v115, v104
  v_or3_b32 v6, v6, v108, v112
  v_or3_b32 v6, v6, v116, v105
  v_or3_b32 v6, v6, v109, v113
  v_bitop3_b32 v6, v6, v117, s0 bitop3:0xa8
  v_cmp_ne_u32 vcc, 0, v6
  s_cbranch_vccnz L_slow_13
L_out_15:
  s_mov_b64 exec, -1
  s_nop 4
  s_branch L_ok_14
L_slow_22:
  s_add_u32 s57, s57, 1
  s_cmp_gt_u32 s57, 1000000
  s_cbranch_scc1 L_out_24
  s_mov_b64 exec, vcc
  s_mov_b32 s65, 36864
  buffer_load_dwordx4 v[136:139], v7, s[20:23], s65 offen offset:0 sc1
  buffer_load_dwordx4 v[140:143], v7, s[20:23], s65 offen offset:1024 sc1
  buffer_load_dwordx4 v[144:147], v7, s[20:23], s65 offen offset:2048 sc1
  buffer_load_dwordx4 v[148:151], v7, s[20:23], s65 offen offset:3072 sc1
  s_mov_b32 s65, 40960
  buffer_load_dwordx4 v[102:105], v7, s[20:23], s65 offen offset:0 sc1
  buffer_load_dwordx4 v[106:109], v7, s[20:23], s65 offen offset:1024 sc1
  buffer_load_dwordx4 v[110:113], v7, s[20:23], s65 offen offset:2048 sc1
  buffer_load_dwordx4 v[114:117], v7, s[20:23], s65 offen offset:3072 sc1
  s_mov_b32 s65, 45056
  buffer_load_dwordx4 v[232:235], v7, s[20:23], s65 offen offset:0 sc1
  buffer_load_dwordx4 v[236:239], v7, s[20:23], s65 offen offset:1024 sc1
  buffer_load_dwordx4 v[240:243], v7, s[20:23], s65 offen offset:2048 sc1
  s_waitcnt vmcnt(0)
  v_xor_b32 v6, s54, v139
  v_bitop3_b32 v6, v143, s54, v6 bitop3:0xbe
  v_bitop3_b32 v6, v147, s54, v6 bitop3:0xbe
  v_bitop3_b32 v6, v151, s54, v6 bitop3:0xbe
  v_bitop3_b32 v6, v105, s54, v6 bitop3:0xbe
  v_bitop3_b32 v6, v109, s54, v6 bitop3:0xbe
  v_bitop3_b32 v6, v113, s54, v6 bitop3:0xbe
  v_bitop3_b32 v6, v117, s54, v6 bitop3:0xbe
  v_bitop3_b32 v6, v235, s54, v6 bitop3:0xbe
  v_bitop3_b32 v6, v239, s54, v6 bitop3:0xbe
  v_bitop3_b32 v6, v243, s54, v6 bitop3:0xbe
  v_cmp_ne_u32 vcc, 0, v6
  s_cbranch_vccnz L_slow_22
L_out_24:
  s_mov_b64 exec, -1
  s_nop 4
  s_branch L_ok_23
L_slow_27:
L_pad_s2r:
  s_cbranch_execz L_wret_12
  s_add_u32 s57, s57, 1
  s_cmp_gt_u32 s57, 1000000
  s_cbranch_scc1 L_out_29
  s_wqm_b64 exec, vcc
  s_add_u32 s65, s77, 2816
  buffer_load_dwordx4 v[192:195], v100, s[20:23], s77 offen offset:0 sc1
  buffer_load_dwordx4 v[196:199], v100, s[20:23], s77 offen offset:1408 sc1
  buffer_load_dwordx4 v[200:203], v100, s[20:23], s65 offen offset:0 sc1
  buffer_load_dwordx4 v[204:207], v100, s[20:23], s65 offen offset:1408 sc1
  s_waitcnt vmcnt(0)
  v_xor_b32 v66, v160, v192
  v_xor_b32 v70, v161, v193
  v_xor_b32 v74, v162, v194
  v_xor_b32 v78, v163, v195
  v_xor_b32 v67, v160, v196
  v_xor_b32 v71, v161, v197
  v_xor_b32 v75, v162, v198
  v_xor_b32 v79, v163, v199
  v_xor_b32 v68, v160, v200
  v_xor_b32 v72, v161, v201
  v_xor_b32 v76, v162, v202
  v_xor_b32 v80, v163, v203
  v_xor_b32 v69, v160, v204
  v_xor_b32 v73, v161, v205
  v_xor_b32 v77, v162, v206
  v_xor_b32 v81, v163, v207
  v_or3_b32 v6, v66, v70, v74
  v_or3_b32 v6, v6, v78, v67
  v_or3_b32 v6, v6, v71, v75
  v_or3_b32 v6, v6, v79, v68
  v_or3_b32 v6, v6, v72, v76
  v_or3_b32 v6, v6, v80, v69
  v_or3_b32 v6, v6, v73, v77
  v_bitop3_b32 v6, v6, v81, s0 bitop3:0xa8
  v_cmp_ne_u32 vcc, 0, v6
  s_cbranch_vccnz L_slow_27
L_out_29:
  s_mov_b64 exec, -1
  s_nop 4
  s_branch L_ok_28
L_slow_32:
L_pad_s3r0:
  s_cbranch_execz L_wret_25
  s_add_u32 s57, s57, 1
  s_cmp_gt_u32 s57, 1000000
  s_cbranch_scc1 L_out_34
  s_mov_b64 exec, vcc
  s_mov_b32 s59, m0
  s_mov_b32 s65, 327680
  s_add_u32 m0, s77, 0
  s_nop 0
  buffer_load_dwordx4 v17, s[20:23], s65 offen offset:0 sc1 lds
  s_add_u32 m0, s77, 3840
  s_nop 0
  buffer_load_dwordx4 v17, s[20:23], s65 offen offset:256 sc1 lds
  s_add_u32 m0, s77, 7680
  s_nop 0
  buffer_load_dwordx4 v17, s[20:23], s65 offen offset:512 sc1 lds
  s_add_u32 m0, s77, 11520
  s_nop 0
  buffer_load_dwordx4 v17, s[20:23], s65 offen offset:768 sc1 lds
  s_add_u32 m0, s77, 15360
  s_nop 0
  buffer_load_dwordx4 v17, s[20:23], s65 offen offset:1024 sc1 lds
  s_mov_b32 m0, s59
  s_waitcnt vmcnt(0)
  ds_read2st64_b32 v[74:75], v29 offset0:0 offset1:16
  ds_read2st64_b32 v[76:77], v29 offset0:32 offset1:48
  ds_read_b128 v[78:81], v29 offset:16384
  s_waitcnt vmcnt(0)
  s_waitcnt lgkmcnt(1)
  v_or3_b32 v6, v74, v75, v76
  s_waitcnt lgkmcnt(0)
  v_or3_b32 v6, v6, v77, v78
  v_or3_b32 v6, v6, v79, v80
  v_bitop3_b32 v6, v6, v81, s0 bitop3:0xa8
  v_cmp_ne_u32 vcc, 0, v6
  s_cbranch_vccnz L_slow_32
L_out_34:
  s_mov_b64 exec, -1
  s_nop 4
  s_branch L_ok_33
L_slow_35:
L_pad_s3r1:
  s_cbranch_execz L_wret_25
  s_add_u32 s57, s57, 1
  s_cmp_gt_u32 s57, 1000000
  s_cbranch_scc1 L_out_37
  s_mov_b64 exec, vcc
  s_mov_b32 s59, m0
  s_mov_b32 s65, 350208
  s_add_u32 m0, s77, 20480
  s_nop 0
  buffer_load_dwordx4 v17, s[20:23], s65 offen offset:0 sc1 lds
  s_add_u32 m0, s77, 24320
  s_nop 0
  buffer_load_dwordx4 v17, s[20:23], s65 offen offset:256 sc1 lds
  s_add_u32 m0, s77, 28160
  s_nop 0
  buffer_load_dwordx4 v17, s[20:23], s65 offen offset:512 sc1 lds
  s_add_u32 m0, s77, 32000
  s_nop 0
  buffer_load_dwordx4 v17, s[20:23], s65 offen offset:768 sc1 lds
  s_add_u32 m0, s77, 35840
  s_nop 0
  buffer_load_dwordx4 v17, s[20:23], s65 offen offset:1024 sc1 lds
  s_mov_b32 m0, s59
  s_waitcnt vmcnt(0)
  ds_read2st64_b32 v[74:75], v29 offset0:80 offset1:96
  ds_read2st64_b32 v[76:77], v29 offset0:112 offset1:128
  ds_read_b128 v[78:81], v29 offset:36864
  s_waitcnt vmcnt(0)
  s_waitcnt lgkmcnt(1)
  v_or3_b32 v6, v74, v75, v76
  s_waitcnt lgkmcnt(0)
  v_or3_b32 v6, v6, v77, v78
  v_or3_b32 v6, v6, v79, v80
  v_bitop3_b32 v6, v6, v81, s0 bitop3:0xa8
  v_cmp_ne_u32 vcc, 0, v6
  s_cbranch_vccnz L_slow_35
L_out_37:
  s_mov_b64 exec, -1
  s_nop 4
  s_branch L_ok_36
L_slow_38:
  s_add_u32 s57, s57, 1
  s_cmp_gt_u32 s57, 1000000
  s_cbranch_scc1 L_out_40
  s_mov_b64 exec, vcc
  s_mov_b32 s59, m0
  s_mov_b32 s65, 372736
  s_add_u32 m0, s77, 40960
  s_nop 0
  buffer_load_dwordx4 v17, s[20:23], s65 offen offset:0 sc1 lds
  s_add_u32 m0, s77, 44800
  s_nop 0
  buffer_load_dwordx4 v17, s[20:23], s65 offen offset:256 sc1 lds
  s_add_u32 m0, s77, 48640
  s_nop 0
  buffer_load_dwordx4 v17, s[20:23], s65 offen offset:512 sc1 lds
  s_add_u32 m0, s77, 52480
  s_nop 0
  buffer_load_dwordx4 v17, s[20:23], s65 offen offset:768 sc1 lds
  s_add_u32 m0, s77, 56320
  s_nop 0
  buffer_load_dwordx4 v17, s[20:23], s65 offen offset:1024 sc1 lds
  s_mov_b32 m0, s59
  s_waitcnt vmcnt(0)
  ds_read2st64_b32 v[74:75], v29 offset0:160 offset1:176
  ds_read2st64_b32 v[76:77], v29 offset0:192 offset1:208
  ds_read_b128 v[78:81], v29 offset:57344
  s_waitcnt vmcnt(0)
  s_waitcnt lgkmcnt(1)
  v_or3_b32 v6, v74, v75, v76
  s_waitcnt lgkmcnt(0)
  v_or3_b32 v6, v6, v77, v78
  v_or3_b32 v6, v6, v79, v80
  v_bitop3_b32 v6, v6, v81, s0 bitop3:0xa8
  v_cmp_ne_u32 vcc, 0, v6
  s_cbranch_vccnz L_slow_38
L_out_40:
  s_mov_b64 exec, -1
  s_nop 4
  s_branch L_ok_39
L_slow_41:
  s_add_u32 s57, s57, 1
  s_cmp_gt_u32 s57, 1000000
  s_cbranch_scc1 L_out_43
  s_mov_b64 exec, vcc
  s_mov_b32 s59, m0
  s_mov_b32 s65, 395264
  s_add_u32 m0, s77, 61440
  s_nop 0
  buffer_load_dwordx4 v17, s[20:23], s65 offen offset:0 sc1 lds
  s_add_u32 m0, s77, 65280
  s_nop 0
  buffer_load_dwordx4 v17, s[20:23], s65 offen offset:256 sc1 lds
  s_add_u32 m0, s77, 69120
  s_nop 0
  buffer_load_dwordx4 v17, s[20:23], s65 offen offset:512 sc1 lds
  s_add_u32 m0, s77, 72960
  s_nop 0
  buffer_load_dwordx4 v17, s[20:23], s65 offen offset:768 sc1 lds
  s_add_u32 m0, s77, 76800
  s_nop 0
  buffer_load_dwordx4 v17, s[20:23], s65 offen offset:1024 sc1 lds
  s_mov_b32 m0, s59
  s_waitcnt vmcnt(0)
  ds_read2st64_b32 v[236:237], v29 offset0:160 offset1:176
  ds_read2st64_b32 v[238:239], v29 offset0:192 offset1:208
  ds_read_b128 v[240:243], v29 offset:57344
  s_waitcnt vmcnt(0)
  s_waitcnt lgkmcnt(1)
  v_or3_b32 v6, v236, v237, v238
  s_waitcnt lgkmcnt(0)
  v_or3_b32 v6, v6, v239, v240
  v_or3_b32 v6, v6, v241, v242
  v_bitop3_b32 v6, v6, v243, s0 bitop3:0xa8
  v_cmp_ne_u32 vcc, 0, v6
  s_cbranch_vccnz L_slow_41
L_out_43:
  s_mov_b64 exec, -1
  s_nop 4
  s_branch L_ok_42
L_slow_44:
  s_add_u32 s57, s57, 1
  s_cmp_gt_u32 s57, 1000000
  s_cbranch_scc1 L_out_46
  s_mov_b64 exec, vcc
  s_lshl_b32 s61, s56, 11
  s_add_u32 s61, s61, 65536
  buffer_load_dword v2, v9, s[20:23], s61 offen sc1
  s_waitcnt vmcnt(0)
  v_cmp_ne_u32 vcc, s54, v2
  s_cbranch_vccnz L_slow_44
L_out_46:
  s_mov_b64 exec, -1
  s_nop 4
  s_branch L_ok_45
L_slow_47:
  s_add_u32 s57, s57, 1
  s_cmp_gt_u32 s57, 1000000
  s_cbranch_scc1 L_out_49
  s_mov_b64 exec, vcc
  s_mov_b64 exec, -1
  s_add_u32 s65, s3, 0
  buffer_load_dwordx4 a[0:3], v7, s[20:23], s65 offen offset:0 sc1
  buffer_load_dwordx4 a[4:7], v7, s[20:23], s65 offen offset:1024 sc1
  buffer_load_dwordx4 a[8:11], v7, s[20:23], s65 offen offset:2048 sc1
  buffer_load_dwordx4 a[12:15], v7, s[20:23], s65 offen offset:3072 sc1
  s_add_u32 s65, s5, 0
  buffer_load_dwordx4 a[16:19], v7, s[20:23], s65 offen offset:0 sc1
  buffer_load_dwordx4 a[20:23], v7, s[20:23], s65 offen offset:1024 sc1
  buffer_load_dwordx4 a[24:27], v7, s[20:23], s65 offen offset:2048 sc1
  buffer_load_dwordx4 a[28:31], v7, s[20:23], s65 offen offset:3072 sc1
  s_add_u32 s65, s7, 0
  buffer_load_dwordx4 a[32:35], v7, s[20:23], s65 offen offset:0 sc1
  buffer_load_dwordx4 a[36:39], v7, s[20:23], s65 offen offset:1024 sc1
  buffer_load_dwordx4 a[40:43], v7, s[20:23], s65 offen offset:2048 sc1
  buffer_load_dwordx4 a[44:47], v7, s[20:23], s65 offen offset:3072 sc1
  s_waitcnt vmcnt(0)
  v_accvgpr_read_b32 v6, a15
  v_accvgpr_read_b32 v3, a11
  v_accvgpr_read_b32 v2, a7
  v_max3_u32 v6, v6, v2, v3
  v_accvgpr_read_b32 v3, a3
  v_max_u32 v6, v6, v3
  v_cmp_eq_u32 vcc, -1, v6
  s_cbranch_vccnz L_slow_47
L_out_49:
  s_mov_b64 exec, -1
  s_nop 4
  s_branch L_ok_48
L_slow_50:
  s_add_u32 s57, s57, 1
  s_cmp_gt_u32 s57, 1000000
  s_cbranch_scc1 L_out_52
  s_mov_b64 exec, vcc
  s_mov_b64 exec, -1
  s_add_u32 s65, s5, 0
  buffer_load_dwordx4 a[16:19], v7, s[20:23], s65 offen offset:0 sc1
  buffer_load_dwordx4 a[20:23], v7, s[20:23], s65 offen offset:1024 sc1
  buffer_load_dwordx4 a[24:27], v7, s[20:23], s65 offen offset:2048 sc1
  buffer_load_dwordx4 a[28:31], v7, s[20:23], s65 offen offset:3072 sc1
  s_add_u32 s65, s7, 0
  buffer_load_dwordx4 a[32:35], v7, s[20:23], s65 offen offset:0 sc1
  buffer_load_dwordx4 a[36:39], v7, s[20:23], s65 offen offset:1024 sc1
  buffer_load_dwordx4 a[40:43], v7, s[20:23], s65 offen offset:2048 sc1
  buffer_load_dwordx4 a[44:47], v7, s[20:23], s65 offen offset:3072 sc1
  s_waitcnt vmcnt(0)
  v_accvgpr_read_b32 v6, a31
  v_accvgpr_read_b32 v3, a27
  v_accvgpr_read_b32 v2, a23
  v_max3_u32 v6, v6, v2, v3
  v_accvgpr_read_b32 v3, a19
  v_max_u32 v6, v6, v3
  v_cmp_eq_u32 vcc, -1, v6
  s_cbranch_vccnz L_slow_50
L_out_52:
  s_mov_b64 exec, -1
  s_nop 4
  s_branch L_ok_51
L_slow_53:
  s_add_u32 s57, s57, 1
  s_cmp_gt_u32 s57, 1000000
  s_cbranch_scc1 L_out_55
  s_mov_b64 exec, vcc
  s_mov_b64 exec, -1
  s_add_u32 s65, s7, 0
  buffer_load_dwordx4 a[32:35], v7, s[20:23], s65 offen offset:0 sc1
  buffer_load_dwordx4 a[36:39], v7, s[20:23], s65 offen offset:1024 sc1
  buffer_load_dwordx4 a[40:43], v7, s[20:23], s65 offen offset:2048 sc1
  buffer_load_dwordx4 a[44:47], v7, s[20:23], s65 offen offset:3072 sc1
  s_waitcnt vmcnt(0)
  v_accvgpr_read_b32 v6, a47
  v_accvgpr_read_b32 v3, a43
  v_accvgpr_read_b32 v2, a39
  v_max3_u32 v6, v6, v2, v3
  v_accvgpr_read_b32 v3, a35
  v_max_u32 v6, v6, v3
  v_cmp_eq_u32 vcc, -1, v6
  s_cbranch_vccnz L_slow_53
L_out_55:
  s_mov_b64 exec, -1
  s_nop 4
  s_branch L_ok_54
L_slow_56:
  s_add_u32 s57, s57, 1
  s_cmp_gt_u32 s57, 1000000
  s_cbranch_scc1 L_out_58
  s_mov_b64 exec, vcc
  s_mov_b64 exec, -1
  s_add_u32 s65, s3, 49152
  buffer_load_dwordx4 a[48:51], v7, s[20:23], s65 offen offset:0 sc1
  buffer_load_dwordx4 a[52:55], v7, s[20:23], s65 offen offset:1024 sc1
  buffer_load_dwordx4 a[56:59], v7, s[20:23], s65 offen offset:2048 sc1
  buffer_load_dwordx4 a[60:63], v7, s[20:23], s65 offen offset:3072 sc1
  s_add_u32 s65, s5, 49152
  buffer_load_dwordx4 a[64:67], v7, s[20:23], s65 offen offset:0 sc1
  buffer_load_dwordx4 a[68:71], v7, s[20:23], s65 offen offset:1024 sc1
  buffer_load_dwordx4 a[72:75], v7, s[20:23], s65 offen offset:2048 sc1
  buffer_load_dwordx4 a[76:79], v7, s[20:23], s65 offen offset:3072 sc1
  s_add_u32 s65, s7, 49152
  buffer_load_dwordx4 a[80:83], v7, s[20:23], s65 offen offset:0 sc1
  buffer_load_dwordx4 a[84:87], v7, s[20:23], s65 offen offset:1024 sc1
  buffer_load_dwordx4 a[88:91], v7, s[20:23], s65 offen offset:2048 sc1
  buffer_load_dwordx4 a[92:95], v7, s[20:23], s65 offen offset:3072 sc1
  s_waitcnt vmcnt(0)
  v_accvgpr_read_b32 v6, a63
  v_accvgpr_read_b32 v3, a59
  v_accvgpr_read_b32 v2, a55
  v_max3_u32 v6, v6, v2, v3
  v_accvgpr_read_b32 v3, a51
  v_max_u32 v6, v6, v3
  v_cmp_eq_u32 vcc, -1, v6
  s_cbranch_vccnz L_slow_56
L_out_58:
  s_mov_b64 exec, -1
  s_nop 4
  s_branch L_ok_57
L_slow_59:
  s_add_u32 s57, s57, 1
  s_cmp_gt_u32 s57, 1000000
  s_cbranch_scc1 L_out_61
  s_mov_b64 exec, vcc
  s_mov_b64 exec, -1
  s_add_u32 s65, s5, 49152
  buffer_load_dwordx4 a[64:67], v7, s[20:23], s65 offen offset:0 sc1
  buffer_load_dwordx4 a[68:71], v7, s[20:23], s65 offen offset:1024 sc1
  buffer_load_dwordx4 a[72:75], v7, s[20:23], s65 offen offset:2048 sc1
  buffer_load_dwordx4 a[76:79], v7, s[20:23], s65 offen offset:3072 sc1
  s_add_u32 s65, s7, 49152
  buffer_load_dwordx4 a[80:83], v7, s[20:23], s65 offen offset:0 sc1
  buffer_load_dwordx4 a[84:87], v7, s[20:23], s65 offen offset:1024 sc1
  buffer_load_dwordx4 a[88:91], v7, s[20:23], s65 offen offset:2048 sc1
  buffer_load_dwordx4 a[92:95], v7, s[20:23], s65 offen offset:3072 sc1
  s_waitcnt vmcnt(0)
  v_accvgpr_read_b32 v6, a79
  v_accvgpr_read_b32 v3, a75
  v_accvgpr_read_b32 v2, a71
  v_max3_u32 v6, v6, v2, v3
  v_accvgpr_read_b32 v3, a67
  v_max_u32 v6, v6, v3
  v_cmp_eq_u32 vcc, -1, v6
  s_cbranch_vccnz L_slow_59
L_out_61:
  s_mov_b64 exec, -1
  s_nop 4
  s_branch L_ok_60
L_slow_62:
  s_add_u32 s57, s57, 1
  s_cmp_gt_u32 s57, 1000000
  s_cbranch_scc1 L_out_64
  s_mov_b64 exec, vcc
  s_mov_b64 exec, -1
  s_add_u32 s65, s7, 49152
  buffer_load_dwordx4 a[80:83], v7, s[20:23], s65 offen offset:0 sc1
  buffer_load_dwordx4 a[84:87], v7, s[20:23], s65 offen offset:1024 sc1
  buffer_load_dwordx4 a[88:91], v7, s[20:23], s65 offen offset:2048 sc1
  buffer_load_dwordx4 a[92:95], v7, s[20:23], s65 offen offset:3072 sc1
  s_waitcnt vmcnt(0)
  v_accvgpr_read_b32 v6, a95
  v_accvgpr_read_b32 v3, a91
  v_accvgpr_read_b32 v2, a87
  v_max3_u32 v6, v6, v2, v3
  v_accvgpr_read_b32 v3, a83
  v_max_u32 v6, v6, v3
  v_cmp_eq_u32 vcc, -1, v6
  s_cbranch_vccnz L_slow_62
L_out_64:
  s_mov_b64 exec, -1
  s_nop 4
  s_branch L_ok_63
L_slow_65:
  s_add_u32 s57, s57, 1
  s_cmp_gt_u32 s57, 1000000
  s_cbranch_scc1 L_out_67
  s_mov_b64 exec, vcc
  s_mov_b64 exec, -1
  s_add_u32 s65, s3, 98304
  buffer_load_dwordx4 a[96:99], v7, s[20:23], s65 offen offset:0 sc1
  buffer_load_dwordx4 a[100:103], v7, s[20:23], s65 offen offset:1024 sc1
  buffer_load_dwordx4 a[104:107], v7, s[20:23], s65 offen offset:2048 sc1
  buffer_load_dwordx4 a[108:111], v7, s[20:23], s65 offen offset:3072 sc1
  s_add_u32 s65, s5, 98304
  buffer_load_dwordx4 a[112:115], v7, s[20:23], s65 offen offset:0 sc1
  buffer_load_dwordx4 a[116:119], v7, s[20:23], s65 offen offset:1024 sc1
  buffer_load_dwordx4 a[120:123], v7, s[20:23], s65 offen offset:2048 sc1
  buffer_load_dwordx4 a[124:127], v7, s[20:23], s65 offen offset:3072 sc1
  s_add_u32 s65, s7, 98304
  buffer_load_dwordx4 a[128:131], v7, s[20:23], s65 offen offset:0 sc1
  buffer_load_dwordx4 a[132:135], v7, s[20:23], s65 offen offset:1024 sc1
  buffer_load_dwordx4 a[136:139], v7, s[20:23], s65 offen offset:2048 sc1
  buffer_load_dwordx4 a[140:143], v7, s[20:23], s65 offen offset:3072 sc1
  s_waitcnt vmcnt(0)
  v_accvgpr_read_b32 v6, a111
  v_accvgpr_read_b32 v3, a107
  v_accvgpr_read_b32 v2, a103
  v_max3_u32 v6, v6, v2, v3
  v_accvgpr_read_b32 v3, a99
  v_max_u32 v6, v6, v3
  v_cmp_eq_u32 vcc, -1, v6
  s_cbranch_vccnz L_slow_65
L_out_67:
  s_mov_b64 exec, -1
  s_nop 4
  s_branch L_ok_66
L_slow_68:
  s_add_u32 s57, s57, 1
  s_cmp_gt_u32 s57, 1000000
  s_cbranch_scc1 L_out_70
  s_mov_b64 exec, vcc
  s_mov_b64 exec, -1
  s_add_u32 s65, s5, 98304
  buffer_load_dwordx4 a[112:115], v7, s[20:23], s65 offen offset:0 sc1
  buffer_load_dwordx4 a[116:119], v7, s[20:23], s65 offen offset:1024 sc1
  buffer_load_dwordx4 a[120:123], v7, s[20:23], s65 offen offset:2048 sc1
  buffer_load_dwordx4 a[124:127], v7, s[20:23], s65 offen offset:3072 sc1
  s_add_u32 s65, s7, 98304
  buffer_load_dwordx4 a[128:131], v7, s[20:23], s65 offen offset:0 sc1
  buffer_load_dwordx4 a[132:135], v7, s[20:23], s65 offen offset:1024 sc1
  buffer_load_dwordx4 a[136:139], v7, s[20:23], s65 offen offset:2048 sc1
  buffer_load_dwordx4 a[140:143], v7, s[20:23], s65 offen offset:3072 sc1
  s_waitcnt vmcnt(0)
  v_accvgpr_read_b32 v6, a127
  v_accvgpr_read_b32 v3, a123
  v_accvgpr_read_b32 v2, a119
  v_max3_u32 v6, v6, v2, v3
  v_accvgpr_read_b32 v3, a115
  v_max_u32 v6, v6, v3
  v_cmp_eq_u32 vcc, -1, v6
  s_cbranch_vccnz L_slow_68
L_out_70:
  s_mov_b64 exec, -1
  s_nop 4
  s_branch L_ok_69
L_slow_71:
  s_add_u32 s57, s57, 1
  s_cmp_gt_u32 s57, 1000000
  s_cbranch_scc1 L_out_73
  s_mov_b64 exec, vcc
  s_mov_b64 exec, -1
  s_add_u32 s65, s7, 98304
  buffer_load_dwordx4 a[128:131], v7, s[20:23], s65 offen offset:0 sc1
  buffer_load_dwordx4 a[132:135], v7, s[20:23], s65 offen offset:1024 sc1
  buffer_load_dwordx4 a[136:139], v7, s[20:23], s65 offen offset:2048 sc1
  buffer_load_dwordx4 a[140:143], v7, s[20:23], s65 offen offset:3072 sc1
  s_waitcnt vmcnt(0)
  v_accvgpr_read_b32 v6, a143
  v_accvgpr_read_b32 v3, a139
  v_accvgpr_read_b32 v2, a135
  v_max3_u32 v6, v6, v2, v3
  v_accvgpr_read_b32 v3, a131
  v_max_u32 v6, v6, v3
  v_cmp_eq_u32 vcc, -1, v6
  s_cbranch_vccnz L_slow_71
L_out_73:
  s_mov_b64 exec, -1
  s_nop 4
  s_branch L_ok_72
L_slow_74:
  s_add_u32 s57, s57, 1
  s_cmp_gt_u32 s57, 1000000
  s_cbranch_scc1 L_out_76
  s_mov_b64 exec, vcc
  s_mov_b64 exec, -1
  s_add_u32 s65, s3, 147456
  buffer_load_dwordx4 a[0:3], v7, s[20:23], s65 offen offset:0 sc1
  buffer_load_dwordx4 a[4:7], v7, s[20:23], s65 offen offset:1024 sc1
  buffer_load_dwordx4 a[8:11], v7, s[20:23], s65 offen offset:2048 sc1
  buffer_load_dwordx4 a[12:15], v7, s[20:23], s65 offen offset:3072 sc1
  s_add_u32 s65, s5, 147456
  buffer_load_dwordx4 a[16:19], v7, s[20:23], s65 offen offset:0 sc1
  buffer_load_dwordx4 a[20:23], v7, s[20:23], s65 offen offset:1024 sc1
  buffer_load_dwordx4 a[24:27], v7, s[20:23], s65 offen offset:2048 sc1
  buffer_load_dwordx4 a[28:31], v7, s[20:23], s65 offen offset:3072 sc1
  s_add_u32 s65, s7, 147456
  buffer_load_dwordx4 a[32:35], v7, s[20:23], s65 offen offset:0 sc1
  buffer_load_dwordx4 a[36:39], v7, s[20:23], s65 offen offset:1024 sc1
  buffer_load_dwordx4 a[40:43], v7, s[20:23], s65 offen offset:2048 sc1
  buffer_load_dwordx4 a[44:47], v7, s[20:23], s65 offen offset:3072 sc1
  s_waitcnt vmcnt(0)
  v_accvgpr_read_b32 v6, a15
  v_accvgpr_read_b32 v3, a11
  v_accvgpr_read_b32 v2, a7
  v_max3_u32 v6, v6, v2, v3
  v_accvgpr_read_b32 v3, a3
  v_max_u32 v6, v6, v3
  v_cmp_eq_u32 vcc, -1, v6
  s_cbranch_vccnz L_slow_74
L_out_76:
  s_mov_b64 exec, -1
  s_nop 4
  s_branch L_ok_75
L_slow_77:
  s_add_u32 s57, s57, 1
  s_cmp_gt_u32 s57, 1000000
  s_cbranch_scc1 L_out_79
  s_mov_b64 exec, vcc
  s_mov_b64 exec, -1
  s_add_u32 s65, s5, 147456
  buffer_load_dwordx4 a[16:19], v7, s[20:23], s65 offen offset:0 sc1
  buffer_load_dwordx4 a[20:23], v7, s[20:23], s65 offen offset:1024 sc1
  buffer_load_dwordx4 a[24:27], v7, s[20:23], s65 offen offset:2048 sc1
  buffer_load_dwordx4 a[28:31], v7, s[20:23], s65 offen offset:3072 sc1
  s_add_u32 s65, s7, 147456
  buffer_load_dwordx4 a[32:35], v7, s[20:23], s65 offen offset:0 sc1
  buffer_load_dwordx4 a[36:39], v7, s[20:23], s65 offen offset:1024 sc1
  buffer_load_dwordx4 a[40:43], v7, s[20:23], s65 offen offset:2048 sc1
  buffer_load_dwordx4 a[44:47], v7, s[20:23], s65 offen offset:3072 sc1
  s_waitcnt vmcnt(0)
  v_accvgpr_read_b32 v6, a31
  v_accvgpr_read_b32 v3, a27
  v_accvgpr_read_b32 v2, a23
  v_max3_u32 v6, v6, v2, v3
  v_accvgpr_read_b32 v3, a19
  v_max_u32 v6, v6, v3
  v_cmp_eq_u32 vcc, -1, v6
  s_cbranch_vccnz L_slow_77
L_out_79:
  s_mov_b64 exec, -1
  s_nop 4
  s_branch L_ok_78
L_slow_80:
  s_add_u32 s57, s57, 1
  s_cmp_gt_u32 s57, 1000000
  s_cbranch_scc1 L_out_82
  s_mov_b64 exec, vcc
  s_mov_b64 exec, -1
  s_add_u32 s65, s7, 147456
  buffer_load_dwordx4 a[32:35], v7, s[20:23], s65 offen offset:0 sc1
  buffer_load_dwordx4 a[36:39], v7, s[20:23], s65 offen offset:1024 sc1
  buffer_load_dwordx4 a[40:43], v7, s[20:23], s65 offen offset:2048 sc1
  buffer_load_dwordx4 a[44:47], v7, s[20:23], s65 offen offset:3072 sc1
  s_waitcnt vmcnt(0)
  v_accvgpr_read_b32 v6, a47
  v_accvgpr_read_b32 v3, a43
  v_accvgpr_read_b32 v2, a39
  v_max3_u32 v6, v6, v2, v3
  v_accvgpr_read_b32 v3, a35
  v_max_u32 v6, v6, v3
  v_cmp_eq_u32 vcc, -1, v6
  s_cbranch_vccnz L_slow_80
L_out_82:
  s_mov_b64 exec, -1
  s_nop 4
  s_branch L_ok_81
.p2align 7
.type L_tab,@object
L_tab:
.long 0x0,0x62c40,0xc1c20,0x0,0x10,0x62c50,0xc1c30,0x8
.long 0x20,0x63800,0xc1c40,0x10,0x30,0x63810,0xc1c50,0x18
.long 0x40,0x63820,0x121000,0x60,0x50,0x63830,0x121010,0x68
.long 0xc00,0x63840,0x121020,0x70,0xc10,0x63850,0x121030,0x78
.long 0xc20,0x4400,0x121040,0xc0,0xc30,0x4410,0x121050,0xc8
.long 0xc40,0x4420,0x121c00,0xd0,0xc50,0x4430,0x121c10,0xd8
.long 0x60000,0x4440,0x121c20,0x120,0x60010,0x4450,0x121c30,0x128
.long 0x60020,0x5000,0x121c40,0x130,0x60030,0x5010,0x121c50,0x138
.long 0x60040,0x5020,0xc2800,0x180,0x60050,0x5030,0xc2810,0x188
.long 0x60c00,0x5040,0xc2820,0x190,0x60c10,0x5050,0xc2830,0x198
.long 0x60c20,0x64400,0xc2840,0x1e0,0x60c30,0x64410,0xc2850,0x1e8
.long 0x60c40,0x64420,0xc3400,0x1f0,0x60c50,0x64430,0xc3410,0x1f8
.long 0x1800,0x64440,0xc3420,0x240,0x1810,0x64450,0xc3430,0x248
.long 0x1820,0x65000,0xc3440,0x250,0x1830,0x65010,0xc3450,0x258
.long 0x1840,0x65020,0x122800,0x2a0,0x1850,0x65030,0x122810,0x2a8
.long 0x2400,0x65040,0x122820,0x2b0,0x2410,0x65050,0x122830,0x2b8
.long 0x2420,0xbfc00,0x122840,0x300,0x2430,0xbfc10,0x122850,0x308
.long 0x2440,0xbfc20,0x123400,0x310,0x2450,0xbfc30,0x123410,0x318
.long 0x61800,0xbfc40,0x123420,0x360,0x61810,0xbfc50,0x123430,0x368
.long 0x61820,0xc0800,0x123440,0x370,0x61830,0xc0810,0x123450,0x378
.long 0x61840,0xc0820,0xc4000,0x3c0,0x61850,0xc0830,0xc4010,0x3c8
.long 0x62400,0xc0840,0xc4020,0x3d0,0x62410,0xc0850,0xc4030,0x3d8
.long 0x62420,0x11fc00,0xc4040,0x420,0x62430,0x11fc10,0xc4050,0x428
.long 0x62440,0x11fc20,0xc4c00,0x430,0x62450,0x11fc30,0xc4c10,0x438
.long 0x3000,0x11fc40,0xc4c20,0x480,0x3010,0x11fc50,0xc4c30,0x488
.long 0x3020,0x120800,0xc4c40,0x490,0x3030,0x120810,0xc4c50,0x498
.long 0x3040,0x120820,0x124000,0x4e0,0x3050,0x120830,0x124010,0x4e8
.long 0x3c00,0x120840,0x124020,0x4f0,0x3c10,0x120850,0x124030,0x4f8
.long 0x3c20,0xc1400,0x124040,0x540,0x3c30,0xc1410,0x124050,0x548
.long 0x3c40,0xc1420,0x124c00,0x550,0x3c50,0xc1430,0x124c10,0x558
.long 0x63000,0xc1440,0x124c20,0x5a0,0x63010,0xc1450,0x124c30,0x5a8
.long 0x63020,0xc2000,0x124c40,0x5b0,0x63030,0xc2010,0x124c50,0x5b8
.long 0x0,0xd440,0x9420,0x0,0x10,0xd450,0x9430,0x10
.long 0x20,0xe000,0x9440,0x1410,0x30,0xe010,0x9450,0x1420
.long 0x40,0xe020,0xa000,0x2820,0x50,0xe030,0xa010,0x2830
.long 0xc00,0xe040,0xa020,0x3c30,0xc10,0xe050,0xa030,0x3c40
.long 0xc20,0x11c00,0xa040,0x5040,0xc30,0x11c10,0xa050,0x5050
.long 0xc40,0x11c20,0xac00,0x6450,0xc50,0x11c30,0xac10,0x6460
.long 0x1800,0x11c40,0xac20,0x7860,0x1810,0x11c50,0xac30,0x7870
.long 0x1820,0x12800,0xac40,0x8c70,0x1830,0x12810,0xac50,0x8c80
.long 0x1840,0x12820,0xe800,0xa080,0x1850,0x12830,0xe810,0xa090
.long 0x2400,0x12840,0xe820,0xb490,0x2410,0x12850,0xe830,0xb4a0
.long 0x2420,0x13400,0xe840,0xc8a0,0x2430,0x13410,0xe850,0xc8b0
.long 0x2440,0x13420,0xf400,0xdcb0,0x2450,0x13430,0xf410,0xdcc0
.long 0x6000,0x13440,0xf420,0xf0c0,0x6010,0x13450,0xf430,0xf0d0
.long 0x6020,0x14000,0xf440,0x104d0,0x6030,0x14010,0xf450,0x104e0
.long 0x6040,0x14020,0x10000,0x118e0,0x6050,0x14030,0x10010,0x118f0
.long 0x6c00,0x14040,0x10020,0x12cf0,0x6c10,0x14050,0x10030,0x12d00
.long 0x6c20,0x2c00,0x10040,0x14100,0x6c30,0x2c10,0x10050,0x14110
.long 0x6c40,0x2c20,0x10c00,0x15510,0x6c50,0x2c30,0x10c10,0x15520
.long 0x7800,0x2c40,0x10c20,0x16920,0x7810,0x2c50,0x10c30,0x16930
.long 0x7820,0x3800,0x10c40,0x17d30,0x7830,0x3810,0x10c50,0x17d40
.long 0x7840,0x3820,0x14800,0x19140,0x7850,0x3830,0x14810,0x19150
.long 0x8400,0x3840,0x14820,0x1a550,0x8410,0x3850,0x14830,0x1a560
.long 0x8420,0x4400,0x14840,0x1b960,0x8430,0x4410,0x14850,0x1b970
.long 0x8440,0x4420,0x15400,0x1cd70,0x8450,0x4430,0x15410,0x1cd80
.long 0xc000,0x4440,0x15420,0x1e180,0xc010,0x4450,0x15430,0x1e190
.long 0xc020,0x5000,0x15440,0x1f590,0xc030,0x5010,0x15450,0x1f5a0
.long 0xc040,0x5020,0x16000,0x209a0,0xc050,0x5030,0x16010,0x209b0
.long 0xcc00,0x5040,0x16020,0x21db0,0xcc10,0x5050,0x16030,0x21dc0
.long 0xcc20,0x8c00,0x16040,0x231c0,0xcc30,0x8c10,0x16050,0x231d0
.long 0xcc40,0x8c20,0x16c00,0x245d0,0xcc50,0x8c30,0x16c10,0x245e0
.long 0xd800,0x8c40,0x16c20,0x259e0,0xd810,0x8c50,0x16c30,0x259f0
.long 0xd820,0x9800,0x16c40,0x26df0,0xd830,0x9810,0x16c50,0x26e00
.long 0x0,0x8c,0x0,0x104,0x150,0x478,0x150,0x4f0
.long 0x2a0,0x328,0x2a0,0x3a0,0x3f0,0x1d8,0x3f0,0x250
.long 0x4,0x88,0x4,0x100,0x154,0x474,0x154,0x4ec
.long 0x2a4,0x324,0x2a4,0x39c,0x3f4,0x1d4,0x3f4,0x24c
.long 0x8,0x84,0x8,0xfc,0x158,0x470,0x158,0x4e8
.long 0x2a8,0x320,0x2a8,0x398,0x3f8,0x1d0,0x3f8,0x248
.long 0xc,0x80,0xc,0xf8,0x15c,0x46c,0x15c,0x4e4
.long 0x2ac,0x31c,0x2ac,0x394,0x3fc,0x1cc,0x3fc,0x244
.long 0x28,0x64,0x50,0xb4,0x178,0x450,0x1a0,0x4a0
.long 0x2c8,0x300,0x2f0,0x350,0x418,0x1b0,0x440,0x200
.long 0x2c,0x60,0x54,0xb0,0x17c,0x44c,0x1a4,0x49c
.long 0x2cc,0x2fc,0x2f4,0x34c,0x41c,0x1ac,0x444,0x1fc
.long 0x30,0x5c,0x58,0xac,0x180,0x448,0x1a8,0x498
.long 0x2d0,0x2f8,0x2f8,0x348,0x420,0x1a8,0x448,0x1f8
.long 0x34,0x58,0x5c,0xa8,0x184,0x444,0x1ac,0x494
.long 0x2d4,0x2f4,0x2fc,0x344,0x424,0x1a4,0x44c,0x1f4
.long 0x50,0x3c,0xa0,0x64,0x1a0,0x428,0x1f0,0x450
.long 0x2f0,0x2d8,0x340,0x300,0x440,0x188,0x490,0x1b0
.long 0x54,0x38,0xa4,0x60,0x1a4,0x424,0x1f4,0x44c
.long 0x2f4,0x2d4,0x344,0x2fc,0x444,0x184,0x494,0x1ac
.long 0x58,0x34,0xa8,0x5c,0x1a8,0x420,0x1f8,0x448
.long 0x2f8,0x2d0,0x348,0x2f8,0x448,0x180,0x498,0x1a8
.long 0x5c,0x30,0xac,0x58,0x1ac,0x41c,0x1fc,0x444
.long 0x2fc,0x2cc,0x34c,0x2f4,0x44c,0x17c,0x49c,0x1a4
.long 0x78,0x14,0xf0,0x14,0x1c8,0x400,0x240,0x400
.long 0x318,0x2b0,0x390,0x2b0,0x468,0x160,0x4e0,0x160
.long 0x7c,0x10,0xf4,0x10,0x1cc,0x3fc,0x244,0x3fc
.long 0x31c,0x2ac,0x394,0x2ac,0x46c,0x15c,0x4e4,0x15c
.long 0x80,0xc,0xf8,0xc,0x1d0,0x3f8,0x248,0x3f8
.long 0x320,0x2a8,0x398,0x2a8,0x470,0x158,0x4e8,0x158
.long 0x84,0x8,0xfc,0x8,0x1d4,0x3f4,0x24c,0x3f4
.long 0x324,0x2a4,0x39c,0x2a4,0x474,0x154,0x4ec,0x154
.long 0x0,0x0,0x0,0x0,0x10,0x10,0x40,0x20
.long 0x20,0x20,0x80,0x40,0x30,0x30,0xc0,0x60
.long 0x2c00,0x40,0x110,0x80,0x2c10,0x50,0x150,0xa0
.long 0x2c20,0x60,0x190,0xc0,0x2c30,0x70,0x1d0,0xe0
.long 0x5800,0x80,0x220,0x100,0x5810,0x90,0x260,0x120
.long 0x5820,0xa0,0x2a0,0x140,0x5830,0xb0,0x2e0,0x160
.long 0x8400,0xc0,0x330,0x180,0x8410,0xd0,0x370,0x1a0
.long 0x8420,0xe0,0x3b0,0x1c0,0x8430,0xf0,0x3f0,0x1e0
.long 0xb000,0x110,0x1000,0x800,0xb010,0x100,0x1040,0x820
.long 0xb020,0x130,0x1080,0x840,0xb030,0x120,0x10c0,0x860
.long 0xdc00,0x150,0x1110,0x880,0xdc10,0x140,0x1150,0x8a0
.long 0xdc20,0x170,0x1190,0x8c0,0xdc30,0x160,0x11d0,0x8e0
.long 0x10800,0x190,0x1220,0x900,0x10810,0x180,0x1260,0x920
.long 0x10820,0x1b0,0x12a0,0x940,0x10830,0x1a0,0x12e0,0x960
.long 0x13400,0x1d0,0x1330,0x980,0x13410,0x1c0,0x1370,0x9a0
.long 0x13420,0x1f0,0x13b0,0x9c0,0x13430,0x1e0,0x13f0,0x9e0
.long 0x16000,0x220,0x2000,0x1000,0x16010,0x230,0x2040,0x1020
.long 0x16020,0x200,0x2080,0x1040,0x16030,0x210,0x20c0,0x1060
.long 0x18c00,0x260,0x2110,0x1080,0x18c10,0x270,0x2150,0x10a0
.long 0x18c20,0x240,0x2190,0x10c0,0x18c30,0x250,0x21d0,0x10e0
.long 0x1b800,0x2a0,0x2220,0x1100,0x1b810,0x2b0,0x2260,0x1120
.long 0x1b820,0x280,0x22a0,0x1140,0x1b830,0x290,0x22e0,0x1160
.long 0x1e400,0x2e0,0x2330,0x1180,0x1e410,0x2f0,0x2370,0x11a0
.long 0x1e420,0x2c0,0x23b0,0x11c0,0x1e430,0x2d0,0x23f0,0x11e0
.long 0x21000,0x330,0x3000,0x1800,0x21010,0x320,0x3040,0x1820
.long 0x21020,0x310,0x3080,0x1840,0x21030,0x300,0x30c0,0x1860
.long 0x23c00,0x370,0x3110,0x1880,0x23c10,0x360,0x3150,0x18a0
.long 0x23c20,0x350,0x3190,0x18c0,0x23c30,0x340,0x31d0,0x18e0
.long 0x26800,0x3b0,0x3220,0x1900,0x26810,0x3a0,0x3260,0x1920
.long 0x26820,0x390,0x32a0,0x1940,0x26830,0x380,0x32e0,0x1960
.long 0x29400,0x3f0,0x3330,0x1980,0x29410,0x3e0,0x3370,0x19a0
.long 0x29420,0x3d0,0x33b0,0x19c0,0x29430,0x3c0,0x33f0,0x19e0
.long 0x3f803f80,0x3f803f80,0x3f80,0x0,0x3e9e3f80,0xbf4fbf4f,0x3e9e,0x0
.long 0xbf4f3f80,0x3e9e3e9e,0xbf4f,0x0,0xbf4f3f80,0x3e9e3e9e,0xbf4f,0x0
.long 0x3e9e3f80,0xbf4fbf4f,0x3e9e,0x0,0x3f803f80,0x3f803f80,0x3f80,0x0
.long 0x3e9e3f80,0xbf4fbf4f,0x3e9e,0x0,0xbf4f3f80,0x3e9e3e9e,0xbf4f,0x0
.long 0xbf4f3f80,0x3e9e3e9e,0xbf4f,0x0,0x3e9e3f80,0xbf4fbf4f,0x3e9e,0x0
.long 0x3f803f80,0x3f803f80,0x3f80,0x0,0x3e9e3f80,0xbf4fbf4f,0x3e9e,0x0
.long 0xbf4f3f80,0x3e9e3e9e,0xbf4f,0x0,0xbf4f3f80,0x3e9e3e9e,0xbf4f,0x0
.long 0x3e9e3f80,0xbf4fbf4f,0x3e9e,0x0,0x3f803f80,0x3f803f80,0x3f80,0x0
.long 0x3f803f80,0x3f803f80,0x3f80,0x0,0x3f73,0xbf16bf73,0x3f16,0x0
.long 0xbf803f4f,0xbe9e3f4f,0xbe9e,0x0,0x3f16,0x3f73bf16,0xbf73,0x0
.long 0x3f803e9e,0xbf4f3e9e,0xbf4f,0x0,0x0,0x0,0x0,0x0
.long 0xbf80be9e,0x3f4fbe9e,0x3f4f,0x0,0xbf16,0xbf733f16,0x3f73,0x0
.long 0x3f80bf4f,0x3e9ebf4f,0x3e9e,0x0,0xbf73,0x3f163f73,0xbf16,0x0
.long 0xbf80bf80,0xbf80bf80,0xbf80,0x0,0xbf73,0x3f163f73,0xbf16,0x0
.long 0x3f80bf4f,0x3e9ebf4f,0x3e9e,0x0,0xbf16,0xbf733f16,0x3f73,0x0
.long 0xbf80be9e,0x3f4fbe9e,0x3f4f,0x0,0x0,0x0,0x0,0x0
.long 0x3f803f80,0x3f803f80,0x3f80,0x0,0xbe9e3f4f,0xbe9ebf80,0x3f4f,0x0
.long 0xbf4f3e9e,0xbf4f3f80,0x3e9e,0x0,0x3f4fbe9e,0x3f4fbf80,0xbe9e,0x0
.long 0x3e9ebf4f,0x3e9e3f80,0xbf4f,0x0,0xbf80bf80,0xbf80bf80,0xbf80,0x0
.long 0x3e9ebf4f,0x3e9e3f80,0xbf4f,0x0,0x3f4fbe9e,0x3f4fbf80,0xbe9e,0x0
.long 0xbf4f3e9e,0xbf4f3f80,0x3e9e,0x0,0xbe9e3f4f,0xbe9ebf80,0x3f4f,0x0
.long 0x3f803f80,0x3f803f80,0x3f80,0x0,0xbe9e3f4f,0xbe9ebf80,0x3f4f,0x0
.long 0xbf4f3e9e,0xbf4f3f80,0x3e9e,0x0,0x3f4fbe9e,0x3f4fbf80,0xbe9e,0x0
.long 0x3e9ebf4f,0x3e9e3f80,0xbf4f,0x0,0xbf80bf80,0xbf80bf80,0xbf80,0x0
.long 0x3f803f80,0x3f803f80,0x3f80,0x0,0xbf163f16,0xbf73,0x3f73,0x0
.long 0xbe9ebe9e,0xbf803f4f,0x3f4f,0x0,0x3f73bf73,0xbf16,0x3f16,0x0
.long 0xbf4fbf4f,0x3f803e9e,0x3e9e,0x0,0x0,0x0,0x0,0x0
.long 0x3f4f3f4f,0xbf80be9e,0xbe9e,0x0,0xbf733f73,0x3f16,0xbf16,0x0
.long 0x3e9e3e9e,0x3f80bf4f,0xbf4f,0x0,0x3f16bf16,0x3f73,0xbf73,0x0
.long 0xbf80bf80,0xbf80bf80,0xbf80,0x0,0x3f16bf16,0x3f73,0xbf73,0x0
.long 0x3e9e3e9e,0x3f80bf4f,0xbf4f,0x0,0xbf733f73,0x3f16,0xbf16,0x0
.long 0x3f4f3f4f,0xbf80be9e,0xbe9e,0x0,0x0,0x0,0x0,0x0
.long 0x0,0x0,0x0,0x0,0xbf730000,0x3f16bf16,0x3f73,0x0
.long 0xbf160000,0xbf733f73,0x3f16,0x0,0x3f160000,0x3f73bf73,0xbf16,0x0
.long 0x3f730000,0xbf163f16,0xbf73,0x0,0x0,0x0,0x0,0x0
.long 0xbf730000,0x3f16bf16,0x3f73,0x0,0xbf160000,0xbf733f73,0x3f16,0x0
.long 0x3f160000,0x3f73bf73,0xbf16,0x0,0x3f730000,0xbf163f16,0xbf73,0x0
.long 0x0,0x0,0x0,0x0,0xbf730000,0x3f16bf16,0x3f73,0x0
.long 0xbf160000,0xbf733f73,0x3f16,0x0,0x3f160000,0x3f73bf73,0xbf16,0x0
.long 0x3f730000,0xbf163f16,0xbf73,0x0,0x0,0x0,0x0,0x0
.long 0x0,0x0,0x0,0x0,0xbf80be9e,0x3f4fbe9e,0x3f4f,0x0
.long 0xbf16,0xbf733f16,0x3f73,0x0,0x3f80bf4f,0x3e9ebf4f,0x3e9e,0x0
.long 0xbf73,0x3f163f73,0xbf16,0x0,0xbf80bf80,0xbf80bf80,0xbf80,0x0
.long 0xbf73,0x3f163f73,0xbf16,0x0,0x3f80bf4f,0x3e9ebf4f,0x3e9e,0x0
.long 0xbf16,0xbf733f16,0x3f73,0x0,0xbf80be9e,0x3f4fbe9e,0x3f4f,0x0
.long 0x0,0x0,0x0,0x0,0x3f803e9e,0xbf4f3e9e,0xbf4f,0x0
.long 0x3f16,0x3f73bf16,0xbf73,0x0,0xbf803f4f,0xbe9e3f4f,0xbe9e,0x0
.long 0x3f73,0xbf16bf73,0x3f16,0x0,0x3f803f80,0x3f803f80,0x3f80,0x0
.long 0x0,0x0,0x0,0x0,0xbf73bf16,0x3f730000,0x3f16,0x0
.long 0x3f16bf73,0xbf160000,0x3f73,0x0,0x3f16bf73,0xbf160000,0x3f73,0x0
.long 0xbf73bf16,0x3f730000,0x3f16,0x0,0x0,0x0,0x0,0x0
.long 0x3f733f16,0xbf730000,0xbf16,0x0,0xbf163f73,0x3f160000,0xbf73,0x0
.long 0xbf163f73,0x3f160000,0xbf73,0x0,0x3f733f16,0xbf730000,0xbf16,0x0
.long 0x0,0x0,0x0,0x0,0xbf73bf16,0x3f730000,0x3f16,0x0
.long 0x3f16bf73,0xbf160000,0x3f73,0x0,0x3f16bf73,0xbf160000,0x3f73,0x0
.long 0xbf73bf16,0x3f730000,0x3f16,0x0,0x0,0x0,0x0,0x0
.long 0x0,0x0,0x0,0x0,0xbf4fbf4f,0x3f803e9e,0x3e9e,0x0
.long 0x3f73bf73,0xbf16,0x3f16,0x0,0xbe9ebe9e,0xbf803f4f,0x3f4f,0x0
.long 0xbf163f16,0xbf73,0x3f73,0x0,0x3f803f80,0x3f803f80,0x3f80,0x0
.long 0xbf163f16,0xbf73,0x3f73,0x0,0xbe9ebe9e,0xbf803f4f,0x3f4f,0x0
.long 0x3f73bf73,0xbf16,0x3f16,0x0,0xbf4fbf4f,0x3f803e9e,0x3e9e,0x0
.long 0x0,0x0,0x0,0x0,0x3f4f3f4f,0xbf80be9e,0xbe9e,0x0
.long 0xbf733f73,0x3f16,0xbf16,0x0,0x3e9e3e9e,0x3f80bf4f,0xbf4f,0x0
.long 0x3f16bf16,0x3f73,0xbf73,0x0,0xbf80bf80,0xbf80bf80,0xbf80,0x0
.long 0x3f80,0x3f80,0x3f80,0x3f80,0x3f800000,0x3f800000,0x3f800000,0x3f800000
.long 0x3f80,0x3ec43f6d,0x3f353f35,0x3f6d3ec4,0x3f800000,0x3f6dbec4,0x3f35bf35,0x3ec4bf6d
.long 0x3f80,0x3f353f35,0x3f800000,0x3f35bf35,0x3f800000,0x3f35bf35,0xbf80,0xbf35bf35
.long 0x3f80,0x3f6d3ec4,0x3f35bf35,0xbec4bf6d,0x3f800000,0x3ec4bf6d,0xbf35bf35,0xbf6d3ec4
.long 0x3f80,0x3f800000,0xbf80,0xbf800000,0x3f800000,0xbf80,0xbf800000,0x3f80
.long 0x3f80,0x3f6dbec4,0xbf35bf35,0xbec43f6d,0x3f800000,0xbec4bf6d,0xbf353f35,0x3f6d3ec4
.long 0x3f80,0x3f35bf35,0xbf800000,0x3f353f35,0x3f800000,0xbf35bf35,0x3f80,0x3f35bf35
.long 0x3f80,0x3ec4bf6d,0xbf353f35,0x3f6dbec4,0x3f800000,0xbf6dbec4,0x3f353f35,0xbec4bf6d
.long 0x3f80,0x3f80,0x3f80,0x3f80,0x3f800000,0x3f800000,0x3f800000,0x3f800000
.long 0x3f800000,0x3f6dbec4,0x3f35bf35,0x3ec4bf6d,0xbf80,0xbec4bf6d,0xbf35bf35,0xbf6dbec4
.long 0xbf80,0xbf35bf35,0xbf800000,0xbf353f35,0xbf800000,0xbf353f35,0x3f80,0x3f353f35
.long 0xbf800000,0xbec43f6d,0x3f353f35,0x3f6dbec4,0x3f80,0x3f6d3ec4,0x3f35bf35,0xbec4bf6d
.long 0x3f80,0x3f800000,0xbf80,0xbf800000,0x3f800000,0xbf80,0xbf800000,0x3f80
.long 0x3f800000,0xbec4bf6d,0xbf353f35,0x3f6d3ec4,0xbf80,0xbf6d3ec4,0x3f353f35,0x3ec4bf6d
.long 0xbf80,0xbf353f35,0x3f800000,0xbf35bf35,0xbf800000,0x3f353f35,0xbf80,0xbf353f35
.long 0xbf800000,0x3f6d3ec4,0xbf35bf35,0x3ec43f6d,0x3f80,0x3ec4bf6d,0xbf353f35,0x3f6dbec4
.long 0x3f80,0x3f80,0x3f80,0x3f80,0x3f800000,0x3f800000,0x3f800000,0x3f800000
.long 0xbf80,0xbec4bf6d,0xbf35bf35,0xbf6dbec4,0xbf800000,0xbf6d3ec4,0xbf353f35,0xbec43f6d
.long 0x3f80,0x3f353f35,0x3f800000,0x3f35bf35,0x3f800000,0x3f35bf35,0xbf80,0xbf35bf35
.long 0xbf80,0xbf6dbec4,0xbf353f35,0x3ec43f6d,0xbf800000,0xbec43f6d,0x3f353f35,0x3f6dbec4
.long 0x3f80,0x3f800000,0xbf80,0xbf800000,0x3f800000,0xbf80,0xbf800000,0x3f80
.long 0xbf80,0xbf6d3ec4,0x3f353f35,0x3ec4bf6d,0xbf800000,0x3ec43f6d,0x3f35bf35,0xbf6dbec4
.long 0x3f80,0x3f35bf35,0xbf800000,0x3f353f35,0x3f800000,0xbf35bf35,0x3f80,0x3f35bf35
.long 0xbf80,0xbec43f6d,0x3f35bf35,0xbf6d3ec4,0xbf800000,0x3f6d3ec4,0xbf35bf35,0x3ec43f6d
.long 0x3f80,0x3f80,0x3f80,0x3f80,0x3f800000,0x3f800000,0x3f800000,0x3f800000
.long 0xbf800000,0xbf6d3ec4,0xbf353f35,0xbec43f6d,0x3f80,0x3ec43f6d,0x3f353f35,0x3f6d3ec4
.long 0xbf80,0xbf35bf35,0xbf800000,0xbf353f35,0xbf800000,0xbf353f35,0x3f80,0x3f353f35
.long 0x3f800000,0x3ec4bf6d,0xbf35bf35,0xbf6d3ec4,0xbf80,0xbf6dbec4,0xbf353f35,0x3ec43f6d
.long 0x3f80,0x3f800000,0xbf80,0xbf800000,0x3f800000,0xbf80,0xbf800000,0x3f80
.long 0xbf800000,0x3ec43f6d,0x3f35bf35,0xbf6dbec4,0x3f80,0x3f6dbec4,0xbf35bf35,0xbec43f6d
.long 0xbf80,0xbf353f35,0x3f800000,0xbf35bf35,0xbf800000,0x3f353f35,0xbf80,0xbf353f35
.long 0x3f800000,0xbf6dbec4,0x3f353f35,0xbec4bf6d,0xbf80,0xbec43f6d,0x3f35bf35,0xbf6d3ec4
.long 0x3f80,0x3f80,0x3f80,0x3f80,0x3f800000,0x3f800000,0x3f800000,0x3f800000
.long 0x3e483f7b,0x3f0e3f55,0x3f553f0e,0x3f7b3e48,0x3f7bbe48,0x3f55bf0e,0x3f0ebf55,0x3e48bf7b
.long 0x3ec43f6d,0x3f6d3ec4,0x3f6dbec4,0x3ec4bf6d,0x3f6dbec4,0x3ec4bf6d,0xbec4bf6d,0xbf6dbec4
.long 0x3f0e3f55,0x3f7bbe48,0x3e48bf7b,0xbf55bf0e,0x3f55bf0e,0xbe48bf7b,0xbf7bbe48,0xbf0e3f55
.long 0x3f353f35,0x3f35bf35,0xbf35bf35,0xbf353f35,0x3f35bf35,0xbf35bf35,0xbf353f35,0x3f353f35
.long 0x3f553f0e,0x3e48bf7b,0xbf7b3e48,0x3f0e3f55,0x3f0ebf55,0xbf7bbe48,0x3e483f7b,0x3f55bf0e
.long 0x3f6d3ec4,0xbec4bf6d,0xbec43f6d,0x3f6dbec4,0x3ec4bf6d,0xbf6d3ec4,0x3f6d3ec4,0xbec4bf6d
.long 0x3f7b3e48,0xbf55bf0e,0x3f0e3f55,0xbe48bf7b,0x3e48bf7b,0xbf0e3f55,0x3f55bf0e,0xbf7b3e48
.long 0x3f80,0x3f80,0x3f80,0x3f80,0x3f800000,0x3f800000,0x3f800000,0x3f800000
.long 0x3f7bbe48,0x3f55bf0e,0x3f0ebf55,0x3e48bf7b,0xbe48bf7b,0xbf0ebf55,0xbf55bf0e,0xbf7bbe48
.long 0xbec4bf6d,0xbf6dbec4,0xbf6d3ec4,0xbec43f6d,0xbf6d3ec4,0xbec43f6d,0x3ec43f6d,0x3f6d3ec4
.long 0xbf553f0e,0x3e483f7b,0x3f7b3e48,0x3f0ebf55,0x3f0e3f55,0x3f7bbe48,0x3e48bf7b,0xbf55bf0e
.long 0x3f353f35,0x3f35bf35,0xbf35bf35,0xbf353f35,0x3f35bf35,0xbf35bf35,0xbf353f35,0x3f353f35
.long 0x3f0ebf55,0xbf7bbe48,0x3e483f7b,0x3f55bf0e,0xbf55bf0e,0xbe483f7b,0x3f7bbe48,0xbf0ebf55
.long 0xbf6dbec4,0x3ec43f6d,0x3ec4bf6d,0xbf6d3ec4,0xbec43f6d,0x3f6dbec4,0xbf6dbec4,0x3ec43f6d
.long 0xbe483f7b,0x3f0ebf55,0xbf553f0e,0x3f7bbe48,0x3f7b3e48,0xbf55bf0e,0x3f0e3f55,0xbe48bf7b
.long 0x3f80,0x3f80,0x3f80,0x3f80,0x3f800000,0x3f800000,0x3f800000,0x3f800000
.long 0xbe48bf7b,0xbf0ebf55,0xbf55bf0e,0xbf7bbe48,0xbf7b3e48,0xbf553f0e,0xbf0e3f55,0xbe483f7b
.long 0x3ec43f6d,0x3f6d3ec4,0x3f6dbec4,0x3ec4bf6d,0x3f6dbec4,0x3ec4bf6d,0xbec4bf6d,0xbf6dbec4
.long 0xbf0ebf55,0xbf7b3e48,0xbe483f7b,0x3f553f0e,0xbf553f0e,0x3e483f7b,0x3f7b3e48,0x3f0ebf55
.long 0x3f353f35,0x3f35bf35,0xbf35bf35,0xbf353f35,0x3f35bf35,0xbf35bf35,0xbf353f35,0x3f353f35
.long 0xbf55bf0e,0xbe483f7b,0x3f7bbe48,0xbf0ebf55,0xbf0e3f55,0x3f7b3e48,0xbe48bf7b,0xbf553f0e
.long 0x3f6d3ec4,0xbec4bf6d,0xbec43f6d,0x3f6dbec4,0x3ec4bf6d,0xbf6d3ec4,0x3f6d3ec4,0xbec4bf6d
.long 0xbf7bbe48,0x3f553f0e,0xbf0ebf55,0x3e483f7b,0xbe483f7b,0x3f0ebf55,0xbf553f0e,0x3f7bbe48
.long 0x3f80,0x3f80,0x3f80,0x3f80,0x3f800000,0x3f800000,0x3f800000,0x3f800000
.long 0xbf7b3e48,0xbf553f0e,0xbf0e3f55,0xbe483f7b,0x3e483f7b,0x3f0e3f55,0x3f553f0e,0x3f7b3e48
.long 0xbec4bf6d,0xbf6dbec4,0xbf6d3ec4,0xbec43f6d,0xbf6d3ec4,0xbec43f6d,0x3ec43f6d,0x3f6d3ec4
.long 0x3f55bf0e,0xbe48bf7b,0xbf7bbe48,0xbf0e3f55,0xbf0ebf55,0xbf7b3e48,0xbe483f7b,0x3f553f0e
.long 0x3f353f35,0x3f35bf35,0xbf35bf35,0xbf353f35,0x3f35bf35,0xbf35bf35,0xbf353f35,0x3f353f35
.long 0xbf0e3f55,0x3f7b3e48,0xbe48bf7b,0xbf553f0e,0x3f553f0e,0x3e48bf7b,0xbf7b3e48,0x3f0e3f55
.long 0xbf6dbec4,0x3ec43f6d,0x3ec4bf6d,0xbf6d3ec4,0xbec43f6d,0x3f6dbec4,0xbf6dbec4,0x3ec43f6d
.long 0x3e48bf7b,0xbf0e3f55,0x3f55bf0e,0xbf7b3e48,0xbf7bbe48,0x3f553f0e,0xbf0ebf55,0x3e483f7b
.long 0x3f80,0xbf80,0x3f80,0xbf80,0x3f800000,0xbf800000,0x3f800000,0xbf800000
.long 0x3f80,0xbec4bf6d,0x3f353f35,0xbf6dbec4,0x3f800000,0xbf6d3ec4,0x3f35bf35,0xbec43f6d
.long 0x3f80,0xbf35bf35,0x3f800000,0xbf353f35,0x3f800000,0xbf353f35,0xbf80,0x3f353f35
.long 0x3f80,0xbf6dbec4,0x3f35bf35,0x3ec43f6d,0x3f800000,0xbec43f6d,0xbf35bf35,0x3f6dbec4
.long 0x3f80,0xbf800000,0xbf80,0x3f800000,0x3f800000,0x3f80,0xbf800000,0xbf80
.long 0x3f80,0xbf6d3ec4,0xbf35bf35,0x3ec4bf6d,0x3f800000,0x3ec43f6d,0xbf353f35,0xbf6dbec4
.long 0x3f80,0xbf353f35,0xbf800000,0xbf35bf35,0x3f800000,0x3f353f35,0x3f80,0xbf353f35
.long 0x3f80,0xbec43f6d,0xbf353f35,0xbf6d3ec4,0x3f800000,0x3f6d3ec4,0x3f353f35,0x3ec43f6d
.long 0x3f80,0xbf80,0x3f80,0xbf80,0x3f800000,0xbf800000,0x3f800000,0xbf800000
.long 0x3f800000,0xbf6d3ec4,0x3f35bf35,0xbec43f6d,0xbf80,0x3ec43f6d,0xbf35bf35,0x3f6d3ec4
.long 0xbf80,0x3f353f35,0xbf800000,0x3f35bf35,0xbf800000,0x3f35bf35,0x3f80,0xbf35bf35
.long 0xbf800000,0x3ec4bf6d,0x3f353f35,0xbf6d3ec4,0x3f80,0xbf6dbec4,0x3f35bf35,0x3ec43f6d
.long 0x3f80,0xbf800000,0xbf80,0x3f800000,0x3f800000,0x3f80,0xbf800000,0xbf80
.long 0x3f800000,0x3ec43f6d,0xbf353f35,0xbf6dbec4,0xbf80,0x3f6dbec4,0x3f353f35,0xbec43f6d
.long 0xbf80,0x3f35bf35,0x3f800000,0x3f353f35,0xbf800000,0xbf35bf35,0xbf80,0x3f35bf35
.long 0xbf800000,0xbf6dbec4,0xbf35bf35,0xbec4bf6d,0x3f80,0xbec43f6d,0xbf353f35,0xbf6d3ec4
.long 0x3f80,0xbf80,0x3f80,0xbf80,0x3f800000,0xbf800000,0x3f800000,0xbf800000
.long 0xbf80,0x3ec43f6d,0xbf35bf35,0x3f6d3ec4,0xbf800000,0x3f6dbec4,0xbf353f35,0x3ec4bf6d
.long 0x3f80,0xbf35bf35,0x3f800000,0xbf353f35,0x3f800000,0xbf353f35,0xbf80,0x3f353f35
.long 0xbf80,0x3f6d3ec4,0xbf353f35,0xbec4bf6d,0xbf800000,0x3ec4bf6d,0x3f353f35,0xbf6d3ec4
.long 0x3f80,0xbf800000,0xbf80,0x3f800000,0x3f800000,0x3f80,0xbf800000,0xbf80
.long 0xbf80,0x3f6dbec4,0x3f353f35,0xbec43f6d,0xbf800000,0xbec4bf6d,0x3f35bf35,0x3f6d3ec4
.long 0x3f80,0xbf353f35,0xbf800000,0xbf35bf35,0x3f800000,0x3f353f35,0x3f80,0xbf353f35
.long 0xbf80,0x3ec4bf6d,0x3f35bf35,0x3f6dbec4,0xbf800000,0xbf6dbec4,0xbf35bf35,0xbec4bf6d
.long 0x3f80,0xbf80,0x3f80,0xbf80,0x3f800000,0xbf800000,0x3f800000,0xbf800000
.long 0xbf800000,0x3f6dbec4,0xbf353f35,0x3ec4bf6d,0x3f80,0xbec4bf6d,0x3f353f35,0xbf6dbec4
.long 0xbf80,0x3f353f35,0xbf800000,0x3f35bf35,0xbf800000,0x3f35bf35,0x3f80,0xbf35bf35
.long 0x3f800000,0xbec43f6d,0xbf35bf35,0x3f6dbec4,0xbf80,0x3f6d3ec4,0xbf353f35,0xbec4bf6d
.long 0x3f80,0xbf800000,0xbf80,0x3f800000,0x3f800000,0x3f80,0xbf800000,0xbf80
.long 0xbf800000,0xbec4bf6d,0x3f35bf35,0x3f6d3ec4,0x3f80,0xbf6d3ec4,0xbf35bf35,0x3ec4bf6d
.long 0xbf80,0x3f35bf35,0x3f800000,0x3f353f35,0xbf800000,0xbf35bf35,0xbf80,0x3f35bf35
.long 0x3f800000,0x3f6d3ec4,0x3f353f35,0x3ec43f6d,0xbf80,0x3ec4bf6d,0x3f35bf35,0x3f6dbec4
.long 0x3f800000,0xbf800000,0x3f800000,0xbf800000,0xbf80,0x3f80,0xbf80,0x3f80
.long 0x3f7bbe48,0xbf553f0e,0x3f0ebf55,0xbe483f7b,0xbe48bf7b,0x3f0e3f55,0xbf55bf0e,0x3f7b3e48
.long 0x3f6dbec4,0xbec43f6d,0xbec4bf6d,0x3f6d3ec4,0xbec4bf6d,0x3f6d3ec4,0xbf6d3ec4,0x3ec4bf6d
.long 0x3f55bf0e,0x3e483f7b,0xbf7bbe48,0x3f0ebf55,0xbf0ebf55,0x3f7bbe48,0xbe483f7b,0xbf55bf0e
.long 0x3f35bf35,0x3f353f35,0xbf353f35,0xbf35bf35,0xbf35bf35,0x3f35bf35,0x3f353f35,0xbf353f35
.long 0x3f0ebf55,0x3f7b3e48,0x3e483f7b,0xbf553f0e,0xbf55bf0e,0x3e48bf7b,0x3f7bbe48,0x3f0e3f55
.long 0x3ec4bf6d,0x3f6dbec4,0x3f6d3ec4,0x3ec43f6d,0xbf6dbec4,0xbec4bf6d,0x3ec4bf6d,0x3f6dbec4
.long 0x3e48bf7b,0x3f0ebf55,0x3f55bf0e,0x3f7bbe48,0xbf7bbe48,0xbf55bf0e,0xbf0ebf55,0xbe48bf7b
.long 0x3f800000,0xbf800000,0x3f800000,0xbf800000,0xbf80,0x3f80,0xbf80,0x3f80
.long 0xbe48bf7b,0x3f0e3f55,0xbf55bf0e,0x3f7b3e48,0xbf7b3e48,0x3f55bf0e,0xbf0e3f55,0x3e48bf7b
.long 0xbf6d3ec4,0x3ec4bf6d,0x3ec43f6d,0xbf6dbec4,0x3ec43f6d,0xbf6dbec4,0x3f6dbec4,0xbec43f6d
.long 0x3f0e3f55,0xbf7b3e48,0x3e48bf7b,0x3f553f0e,0x3f55bf0e,0x3e483f7b,0xbf7bbe48,0x3f0ebf55
.long 0x3f35bf35,0x3f353f35,0xbf353f35,0xbf35bf35,0xbf35bf35,0x3f35bf35,0x3f353f35,0xbf353f35
.long 0xbf55bf0e,0x3e48bf7b,0x3f7bbe48,0x3f0e3f55,0xbf0e3f55,0xbf7bbe48,0xbe48bf7b,0x3f55bf0e
.long 0xbec43f6d,0xbf6d3ec4,0xbf6dbec4,0xbec4bf6d,0x3f6d3ec4,0x3ec43f6d,0xbec43f6d,0xbf6d3ec4
.long 0x3f7b3e48,0x3f553f0e,0x3f0e3f55,0x3e483f7b,0x3e48bf7b,0x3f0ebf55,0x3f55bf0e,0x3f7bbe48
.long 0x3f800000,0xbf800000,0x3f800000,0xbf800000,0xbf80,0x3f80,0xbf80,0x3f80
.long 0xbf7b3e48,0x3f55bf0e,0xbf0e3f55,0x3e48bf7b,0x3e483f7b,0xbf0ebf55,0x3f553f0e,0xbf7bbe48
.long 0x3f6dbec4,0xbec43f6d,0xbec4bf6d,0x3f6d3ec4,0xbec4bf6d,0x3f6d3ec4,0xbf6d3ec4,0x3ec4bf6d
.long 0xbf553f0e,0xbe48bf7b,0x3f7b3e48,0xbf0e3f55,0x3f0e3f55,0xbf7b3e48,0x3e48bf7b,0x3f553f0e
.long 0x3f35bf35,0x3f353f35,0xbf353f35,0xbf35bf35,0xbf35bf35,0x3f35bf35,0x3f353f35,0xbf353f35
.long 0xbf0e3f55,0xbf7bbe48,0xbe48bf7b,0x3f55bf0e,0x3f553f0e,0xbe483f7b,0xbf7b3e48,0xbf0ebf55
.long 0x3ec4bf6d,0x3f6dbec4,0x3f6d3ec4,0x3ec43f6d,0xbf6dbec4,0xbec4bf6d,0x3ec4bf6d,0x3f6dbec4
.long 0xbe483f7b,0xbf0e3f55,0xbf553f0e,0xbf7b3e48,0x3f7b3e48,0x3f553f0e,0x3f0e3f55,0x3e483f7b
.long 0x3f800000,0xbf800000,0x3f800000,0xbf800000,0xbf80,0x3f80,0xbf80,0x3f80
.long 0x3e483f7b,0xbf0ebf55,0x3f553f0e,0xbf7bbe48,0x3f7bbe48,0xbf553f0e,0x3f0ebf55,0xbe483f7b
.long 0xbf6d3ec4,0x3ec4bf6d,0x3ec43f6d,0xbf6dbec4,0x3ec43f6d,0xbf6dbec4,0x3f6dbec4,0xbec43f6d
.long 0xbf0ebf55,0x3f7bbe48,0xbe483f7b,0xbf55bf0e,0xbf553f0e,0xbe48bf7b,0x3f7b3e48,0xbf0e3f55
.long 0x3f35bf35,0x3f353f35,0xbf353f35,0xbf35bf35,0xbf35bf35,0x3f35bf35,0x3f353f35,0xbf353f35
.long 0x3f553f0e,0xbe483f7b,0xbf7b3e48,0xbf0ebf55,0x3f0ebf55,0x3f7b3e48,0x3e483f7b,0xbf553f0e
.long 0xbec43f6d,0xbf6d3ec4,0xbf6dbec4,0xbec4bf6d,0x3f6d3ec4,0x3ec43f6d,0xbec43f6d,0xbf6d3ec4
.long 0xbf7bbe48,0xbf55bf0e,0xbf0ebf55,0xbe48bf7b,0xbe483f7b,0xbf0e3f55,0xbf553f0e,0xbf7b3e48
.long 0x3f80,0x3f80,0x3f80,0x3f80,0x3f80,0x3ec43f6d,0x3f353f35,0x3f6d3ec4
.long 0x3f80,0x3f353f35,0x3f800000,0x3f35bf35,0x3f80,0x3f6d3ec4,0x3f35bf35,0xbec4bf6d
.long 0x3f80,0x3f800000,0xbf80,0xbf800000,0x3f80,0x3f6dbec4,0xbf35bf35,0xbec43f6d
.long 0x3f80,0x3f35bf35,0xbf800000,0x3f353f35,0x3f80,0x3ec4bf6d,0xbf353f35,0x3f6dbec4
.long 0x3f80,0xbf80,0x3f80,0xbf80,0x3f80,0xbec4bf6d,0x3f353f35,0xbf6dbec4
.long 0x3f80,0xbf35bf35,0x3f800000,0xbf353f35,0x3f80,0xbf6dbec4,0x3f35bf35,0x3ec43f6d
.long 0x3f80,0xbf800000,0xbf80,0x3f800000,0x3f80,0xbf6d3ec4,0xbf35bf35,0x3ec4bf6d
.long 0x3f80,0xbf353f35,0xbf800000,0xbf35bf35,0x3f80,0xbec43f6d,0xbf353f35,0xbf6d3ec4
.long 0x3f80,0x3f80,0x3f80,0x3f80,0x3f800000,0x3f6dbec4,0x3f35bf35,0x3ec4bf6d
.long 0xbf80,0xbf35bf35,0xbf800000,0xbf353f35,0xbf800000,0xbec43f6d,0x3f353f35,0x3f6dbec4
.long 0x3f80,0x3f800000,0xbf80,0xbf800000,0x3f800000,0xbec4bf6d,0xbf353f35,0x3f6d3ec4
.long 0xbf80,0xbf353f35,0x3f800000,0xbf35bf35,0xbf800000,0x3f6d3ec4,0xbf35bf35,0x3ec43f6d
.long 0x3f80,0xbf80,0x3f80,0xbf80,0x3f800000,0xbf6d3ec4,0x3f35bf35,0xbec43f6d
.long 0xbf80,0x3f353f35,0xbf800000,0x3f35bf35,0xbf800000,0x3ec4bf6d,0x3f353f35,0xbf6d3ec4
.long 0x3f80,0xbf800000,0xbf80,0x3f800000,0x3f800000,0x3ec43f6d,0xbf353f35,0xbf6dbec4
.long 0xbf80,0x3f35bf35,0x3f800000,0x3f353f35,0xbf800000,0xbf6dbec4,0xbf35bf35,0xbec4bf6d
.long 0x3f80,0x3f80,0x3f80,0x3f80,0xbf80,0xbec4bf6d,0xbf35bf35,0xbf6dbec4
.long 0x3f80,0x3f353f35,0x3f800000,0x3f35bf35,0xbf80,0xbf6dbec4,0xbf353f35,0x3ec43f6d
.long 0x3f80,0x3f800000,0xbf80,0xbf800000,0xbf80,0xbf6d3ec4,0x3f353f35,0x3ec4bf6d
.long 0x3f80,0x3f35bf35,0xbf800000,0x3f353f35,0xbf80,0xbec43f6d,0x3f35bf35,0xbf6d3ec4
.long 0x3f80,0xbf80,0x3f80,0xbf80,0xbf80,0x3ec43f6d,0xbf35bf35,0x3f6d3ec4
.long 0x3f80,0xbf35bf35,0x3f800000,0xbf353f35,0xbf80,0x3f6d3ec4,0xbf353f35,0xbec4bf6d
.long 0x3f80,0xbf800000,0xbf80,0x3f800000,0xbf80,0x3f6dbec4,0x3f353f35,0xbec43f6d
.long 0x3f80,0xbf353f35,0xbf800000,0xbf35bf35,0xbf80,0x3ec4bf6d,0x3f35bf35,0x3f6dbec4
.long 0x3f80,0x3f80,0x3f80,0x3f80,0xbf800000,0xbf6d3ec4,0xbf353f35,0xbec43f6d
.long 0xbf80,0xbf35bf35,0xbf800000,0xbf353f35,0x3f800000,0x3ec4bf6d,0xbf35bf35,0xbf6d3ec4
.long 0x3f80,0x3f800000,0xbf80,0xbf800000,0xbf800000,0x3ec43f6d,0x3f35bf35,0xbf6dbec4
.long 0xbf80,0xbf353f35,0x3f800000,0xbf35bf35,0x3f800000,0xbf6dbec4,0x3f353f35,0xbec4bf6d
.long 0x3f80,0xbf80,0x3f80,0xbf80,0xbf800000,0x3f6dbec4,0xbf353f35,0x3ec4bf6d
.long 0xbf80,0x3f353f35,0xbf800000,0x3f35bf35,0x3f800000,0xbec43f6d,0xbf35bf35,0x3f6dbec4
.long 0x3f80,0xbf800000,0xbf80,0x3f800000,0xbf800000,0xbec4bf6d,0x3f35bf35,0x3f6d3ec4
.long 0xbf80,0x3f35bf35,0x3f800000,0x3f353f35,0x3f800000,0x3f6d3ec4,0x3f353f35,0x3ec43f6d
.long 0x3f800000,0x3f800000,0x3f800000,0x3f800000,0x3f800000,0x3f6dbec4,0x3f35bf35,0x3ec4bf6d
.long 0x3f800000,0x3f35bf35,0xbf80,0xbf35bf35,0x3f800000,0x3ec4bf6d,0xbf35bf35,0xbf6d3ec4
.long 0x3f800000,0xbf80,0xbf800000,0x3f80,0x3f800000,0xbec4bf6d,0xbf353f35,0x3f6d3ec4
.long 0x3f800000,0xbf35bf35,0x3f80,0x3f35bf35,0x3f800000,0xbf6dbec4,0x3f353f35,0xbec4bf6d
.long 0x3f800000,0xbf800000,0x3f800000,0xbf800000,0x3f800000,0xbf6d3ec4,0x3f35bf35,0xbec43f6d
.long 0x3f800000,0xbf353f35,0xbf80,0x3f353f35,0x3f800000,0xbec43f6d,0xbf35bf35,0x3f6dbec4
.long 0x3f800000,0x3f80,0xbf800000,0xbf80,0x3f800000,0x3ec43f6d,0xbf353f35,0xbf6dbec4
.long 0x3f800000,0x3f353f35,0x3f80,0xbf353f35,0x3f800000,0x3f6d3ec4,0x3f353f35,0x3ec43f6d
.long 0x3f800000,0x3f800000,0x3f800000,0x3f800000,0xbf80,0xbec4bf6d,0xbf35bf35,0xbf6dbec4
.long 0xbf800000,0xbf353f35,0x3f80,0x3f353f35,0x3f80,0x3f6d3ec4,0x3f35bf35,0xbec4bf6d
.long 0x3f800000,0xbf80,0xbf800000,0x3f80,0xbf80,0xbf6d3ec4,0x3f353f35,0x3ec4bf6d
.long 0xbf800000,0x3f353f35,0xbf80,0xbf353f35,0x3f80,0x3ec4bf6d,0xbf353f35,0x3f6dbec4
.long 0x3f800000,0xbf800000,0x3f800000,0xbf800000,0xbf80,0x3ec43f6d,0xbf35bf35,0x3f6d3ec4
.long 0xbf800000,0x3f35bf35,0x3f80,0xbf35bf35,0x3f80,0xbf6dbec4,0x3f35bf35,0x3ec43f6d
.long 0x3f800000,0x3f80,0xbf800000,0xbf80,0xbf80,0x3f6dbec4,0x3f353f35,0xbec43f6d
.long 0xbf800000,0xbf35bf35,0xbf80,0x3f35bf35,0x3f80,0xbec43f6d,0xbf353f35,0xbf6d3ec4
.long 0x3f800000,0x3f800000,0x3f800000,0x3f800000,0xbf800000,0xbf6d3ec4,0xbf353f35,0xbec43f6d
.long 0x3f800000,0x3f35bf35,0xbf80,0xbf35bf35,0xbf800000,0xbec43f6d,0x3f353f35,0x3f6dbec4
.long 0x3f800000,0xbf80,0xbf800000,0x3f80,0xbf800000,0x3ec43f6d,0x3f35bf35,0xbf6dbec4
.long 0x3f800000,0xbf35bf35,0x3f80,0x3f35bf35,0xbf800000,0x3f6d3ec4,0xbf35bf35,0x3ec43f6d
.long 0x3f800000,0xbf800000,0x3f800000,0xbf800000,0xbf800000,0x3f6dbec4,0xbf353f35,0x3ec4bf6d
.long 0x3f800000,0xbf353f35,0xbf80,0x3f353f35,0xbf800000,0x3ec4bf6d,0x3f353f35,0xbf6d3ec4
.long 0x3f800000,0x3f80,0xbf800000,0xbf80,0xbf800000,0xbec4bf6d,0x3f35bf35,0x3f6d3ec4
.long 0x3f800000,0x3f353f35,0x3f80,0xbf353f35,0xbf800000,0xbf6dbec4,0xbf35bf35,0xbec4bf6d
.long 0x3f800000,0x3f800000,0x3f800000,0x3f800000,0x3f80,0x3ec43f6d,0x3f353f35,0x3f6d3ec4
.long 0xbf800000,0xbf353f35,0x3f80,0x3f353f35,0xbf80,0xbf6dbec4,0xbf353f35,0x3ec43f6d
.long 0x3f800000,0xbf80,0xbf800000,0x3f80,0x3f80,0x3f6dbec4,0xbf35bf35,0xbec43f6d
.long 0xbf800000,0x3f353f35,0xbf80,0xbf353f35,0xbf80,0xbec43f6d,0x3f35bf35,0xbf6d3ec4
.long 0x3f800000,0xbf800000,0x3f800000,0xbf800000,0x3f80,0xbec4bf6d,0x3f353f35,0xbf6dbec4
.long 0xbf800000,0x3f35bf35,0x3f80,0xbf35bf35,0xbf80,0x3f6d3ec4,0xbf353f35,0xbec4bf6d
.long 0x3f800000,0x3f80,0xbf800000,0xbf80,0x3f80,0xbf6d3ec4,0xbf35bf35,0x3ec4bf6d
.long 0xbf800000,0xbf35bf35,0xbf80,0x3f35bf35,0xbf80,0x3ec4bf6d,0x3f35bf35,0x3f6dbec4
.long 0x3f80,0x3f80,0x3f80,0x3f80,0x3f80,0xbec43f6d,0xbf353f35,0xbf6d3ec4
.long 0x3f80,0xbf353f35,0xbf800000,0xbf35bf35,0x3f80,0xbf6d3ec4,0xbf35bf35,0x3ec4bf6d
.long 0x3f80,0xbf800000,0xbf80,0x3f800000,0x3f80,0xbf6dbec4,0x3f35bf35,0x3ec43f6d
.long 0x3f80,0xbf35bf35,0x3f800000,0xbf353f35,0x3f80,0xbec4bf6d,0x3f353f35,0xbf6dbec4
.long 0x3f80,0xbf80,0x3f80,0xbf80,0x3f80,0x3ec4bf6d,0xbf353f35,0x3f6dbec4
.long 0x3f80,0x3f35bf35,0xbf800000,0x3f353f35,0x3f80,0x3f6dbec4,0xbf35bf35,0xbec43f6d
.long 0x3f80,0x3f800000,0xbf80,0xbf800000,0x3f80,0x3f6d3ec4,0x3f35bf35,0xbec4bf6d
.long 0x3f80,0x3f353f35,0x3f800000,0x3f35bf35,0x3f80,0x3ec43f6d,0x3f353f35,0x3f6d3ec4
.long 0x3f80,0x3f80,0x3f80,0x3f80,0xbf800000,0xbf6dbec4,0xbf35bf35,0xbec4bf6d
.long 0xbf80,0x3f35bf35,0x3f800000,0x3f353f35,0x3f800000,0x3ec43f6d,0xbf353f35,0xbf6dbec4
.long 0x3f80,0xbf800000,0xbf80,0x3f800000,0xbf800000,0x3ec4bf6d,0x3f353f35,0xbf6d3ec4
.long 0xbf80,0x3f353f35,0xbf800000,0x3f35bf35,0x3f800000,0xbf6d3ec4,0x3f35bf35,0xbec43f6d
.long 0x3f80,0xbf80,0x3f80,0xbf80,0xbf800000,0x3f6d3ec4,0xbf35bf35,0x3ec43f6d
.long 0xbf80,0xbf353f35,0x3f800000,0xbf35bf35,0x3f800000,0xbec4bf6d,0xbf353f35,0x3f6d3ec4
.long 0x3f80,0x3f800000,0xbf80,0xbf800000,0xbf800000,0xbec43f6d,0x3f353f35,0x3f6dbec4
.long 0xbf80,0xbf35bf35,0xbf800000,0xbf353f35,0x3f800000,0x3f6dbec4,0x3f35bf35,0x3ec4bf6d
.long 0x3f80,0x3f80,0x3f80,0x3f80,0xbf80,0x3ec4bf6d,0x3f35bf35,0x3f6dbec4
.long 0x3f80,0xbf353f35,0xbf800000,0xbf35bf35,0xbf80,0x3f6dbec4,0x3f353f35,0xbec43f6d
.long 0x3f80,0xbf800000,0xbf80,0x3f800000,0xbf80,0x3f6d3ec4,0xbf353f35,0xbec4bf6d
.long 0x3f80,0xbf35bf35,0x3f800000,0xbf353f35,0xbf80,0x3ec43f6d,0xbf35bf35,0x3f6d3ec4
.long 0x3f80,0xbf80,0x3f80,0xbf80,0xbf80,0xbec43f6d,0x3f35bf35,0xbf6d3ec4
.long 0x3f80,0x3f35bf35,0xbf800000,0x3f353f35,0xbf80,0xbf6d3ec4,0x3f353f35,0x3ec4bf6d
.long 0x3f80,0x3f800000,0xbf80,0xbf800000,0xbf80,0xbf6dbec4,0xbf353f35,0x3ec43f6d
.long 0x3f80,0x3f353f35,0x3f800000,0x3f35bf35,0xbf80,0xbec4bf6d,0xbf35bf35,0xbf6dbec4
.long 0x3f80,0x3f80,0x3f80,0x3f80,0x3f800000,0x3f6d3ec4,0x3f353f35,0x3ec43f6d
.long 0xbf80,0x3f35bf35,0x3f800000,0x3f353f35,0xbf800000,0xbec4bf6d,0x3f35bf35,0x3f6d3ec4
.long 0x3f80,0xbf800000,0xbf80,0x3f800000,0x3f800000,0xbec43f6d,0xbf35bf35,0x3f6dbec4
.long 0xbf80,0x3f353f35,0xbf800000,0x3f35bf35,0xbf800000,0x3f6dbec4,0xbf353f35,0x3ec4bf6d
.long 0x3f80,0xbf80,0x3f80,0xbf80,0x3f800000,0xbf6dbec4,0x3f353f35,0xbec4bf6d
.long 0xbf80,0xbf353f35,0x3f800000,0xbf35bf35,0xbf800000,0x3ec43f6d,0x3f35bf35,0xbf6dbec4
.long 0x3f80,0x3f800000,0xbf80,0xbf800000,0x3f800000,0x3ec4bf6d,0xbf35bf35,0xbf6d3ec4
.long 0xbf80,0xbf35bf35,0xbf800000,0xbf353f35,0xbf800000,0xbf6d3ec4,0xbf353f35,0xbec43f6d
.long 0x3f800000,0x3f800000,0x3f800000,0x3f800000,0x3f800000,0x3f6d3ec4,0x3f353f35,0x3ec43f6d
.long 0x3f800000,0x3f353f35,0x3f80,0xbf353f35,0x3f800000,0x3ec43f6d,0xbf353f35,0xbf6dbec4
.long 0x3f800000,0x3f80,0xbf800000,0xbf80,0x3f800000,0xbec43f6d,0xbf35bf35,0x3f6dbec4
.long 0x3f800000,0xbf353f35,0xbf80,0x3f353f35,0x3f800000,0xbf6d3ec4,0x3f35bf35,0xbec43f6d
.long 0x3f800000,0xbf800000,0x3f800000,0xbf800000,0x3f800000,0xbf6dbec4,0x3f353f35,0xbec4bf6d
.long 0x3f800000,0xbf35bf35,0x3f80,0x3f35bf35,0x3f800000,0xbec4bf6d,0xbf353f35,0x3f6d3ec4
.long 0x3f800000,0xbf80,0xbf800000,0x3f80,0x3f800000,0x3ec4bf6d,0xbf35bf35,0xbf6d3ec4
.long 0x3f800000,0x3f35bf35,0xbf80,0xbf35bf35,0x3f800000,0x3f6dbec4,0x3f35bf35,0x3ec4bf6d
.long 0x3f800000,0x3f800000,0x3f800000,0x3f800000,0x3f80,0xbec43f6d,0xbf353f35,0xbf6d3ec4
.long 0xbf800000,0xbf35bf35,0xbf80,0x3f35bf35,0xbf80,0x3f6dbec4,0x3f353f35,0xbec43f6d
.long 0x3f800000,0x3f80,0xbf800000,0xbf80,0x3f80,0xbf6dbec4,0x3f35bf35,0x3ec43f6d
.long 0xbf800000,0x3f35bf35,0x3f80,0xbf35bf35,0xbf80,0x3ec43f6d,0xbf35bf35,0x3f6d3ec4
.long 0x3f800000,0xbf800000,0x3f800000,0xbf800000,0x3f80,0x3ec4bf6d,0xbf353f35,0x3f6dbec4
.long 0xbf800000,0x3f353f35,0xbf80,0xbf353f35,0xbf80,0xbf6d3ec4,0x3f353f35,0x3ec4bf6d
.long 0x3f800000,0xbf80,0xbf800000,0x3f80,0x3f80,0x3f6d3ec4,0x3f35bf35,0xbec4bf6d
.long 0xbf800000,0xbf353f35,0x3f80,0x3f353f35,0xbf80,0xbec4bf6d,0xbf35bf35,0xbf6dbec4
.long 0x3f800000,0x3f800000,0x3f800000,0x3f800000,0xbf800000,0xbf6dbec4,0xbf35bf35,0xbec4bf6d
.long 0x3f800000,0x3f353f35,0x3f80,0xbf353f35,0xbf800000,0xbec4bf6d,0x3f35bf35,0x3f6d3ec4
.long 0x3f800000,0x3f80,0xbf800000,0xbf80,0xbf800000,0x3ec4bf6d,0x3f353f35,0xbf6d3ec4
.long 0x3f800000,0xbf353f35,0xbf80,0x3f353f35,0xbf800000,0x3f6dbec4,0xbf353f35,0x3ec4bf6d
.long 0x3f800000,0xbf800000,0x3f800000,0xbf800000,0xbf800000,0x3f6d3ec4,0xbf35bf35,0x3ec43f6d
.long 0x3f800000,0xbf35bf35,0x3f80,0x3f35bf35,0xbf800000,0x3ec43f6d,0x3f35bf35,0xbf6dbec4
.long 0x3f800000,0xbf80,0xbf800000,0x3f80,0xbf800000,0xbec43f6d,0x3f353f35,0x3f6dbec4
.long 0x3f800000,0x3f35bf35,0xbf80,0xbf35bf35,0xbf800000,0xbf6d3ec4,0xbf353f35,0xbec43f6d
.long 0x3f800000,0x3f800000,0x3f800000,0x3f800000,0xbf80,0x3ec4bf6d,0x3f35bf35,0x3f6dbec4
.long 0xbf800000,0xbf35bf35,0xbf80,0x3f35bf35,0x3f80,0xbf6d3ec4,0xbf35bf35,0x3ec4bf6d
.long 0x3f800000,0x3f80,0xbf800000,0xbf80,0xbf80,0x3f6d3ec4,0xbf353f35,0xbec4bf6d
.long 0xbf800000,0x3f35bf35,0x3f80,0xbf35bf35,0x3f80,0xbec4bf6d,0x3f353f35,0xbf6dbec4
.long 0x3f800000,0xbf800000,0x3f800000,0xbf800000,0xbf80,0xbec43f6d,0x3f35bf35,0xbf6d3ec4
.long 0xbf800000,0x3f353f35,0xbf80,0xbf353f35,0x3f80,0x3f6dbec4,0xbf35bf35,0xbec43f6d
.long 0x3f800000,0xbf80,0xbf800000,0x3f80,0xbf80,0xbf6dbec4,0xbf353f35,0x3ec43f6d
.long 0xbf800000,0xbf353f35,0x3f80,0x3f353f35,0x3f80,0x3ec43f6d,0x3f353f35,0x3f6d3ec4
.long 0x3f80,0xbe483f7b,0xbec43f6d,0xbf0e3f55,0x3f80,0xbf0e3f55,0xbf6d3ec4,0xbf7bbe48
.long 0x3f80,0xbf553f0e,0xbf6dbec4,0xbe48bf7b,0x3f80,0xbf7b3e48,0xbec4bf6d,0x3f55bf0e
.long 0x3f80,0xbf7bbe48,0x3ec4bf6d,0x3f553f0e,0x3f80,0xbf55bf0e,0x3f6dbec4,0xbe483f7b
.long 0x3f80,0xbf0ebf55,0x3f6d3ec4,0xbf7b3e48,0x3f80,0xbe48bf7b,0x3ec43f6d,0xbf0ebf55
.long 0x3f80,0x3e48bf7b,0xbec43f6d,0x3f0ebf55,0x3f80,0x3f0ebf55,0xbf6d3ec4,0x3f7b3e48
.long 0x3f80,0x3f55bf0e,0xbf6dbec4,0x3e483f7b,0x3f80,0x3f7bbe48,0xbec4bf6d,0xbf553f0e
.long 0x3f80,0x3f7b3e48,0x3ec4bf6d,0xbf55bf0e,0x3f80,0x3f553f0e,0x3f6dbec4,0x3e48bf7b
.long 0x3f80,0x3f0e3f55,0x3f6d3ec4,0x3f7bbe48,0x3f80,0x3e483f7b,0x3ec43f6d,0x3f0e3f55
.long 0xbf353f35,0xbf553f0e,0xbf6d3ec4,0xbf7b3e48,0xbf35bf35,0xbe48bf7b,0x3ec4bf6d,0x3f55bf0e
.long 0x3f35bf35,0x3f7b3e48,0x3ec43f6d,0xbf0e3f55,0x3f353f35,0xbf0e3f55,0xbf6dbec4,0x3e48bf7b
.long 0xbf353f35,0xbf0ebf55,0x3f6dbec4,0x3e483f7b,0xbf35bf35,0x3f7bbe48,0xbec43f6d,0xbf0ebf55
.long 0x3f35bf35,0xbe483f7b,0xbec4bf6d,0x3f553f0e,0x3f353f35,0xbf55bf0e,0x3f6d3ec4,0xbf7bbe48
.long 0xbf353f35,0x3f55bf0e,0xbf6d3ec4,0x3f7bbe48,0xbf35bf35,0x3e483f7b,0x3ec4bf6d,0xbf553f0e
.long 0x3f35bf35,0xbf7bbe48,0x3ec43f6d,0x3f0ebf55,0x3f353f35,0x3f0ebf55,0xbf6dbec4,0xbe483f7b
.long 0xbf353f35,0x3f0e3f55,0x3f6dbec4,0xbe48bf7b,0xbf35bf35,0xbf7b3e48,0xbec43f6d,0x3f0e3f55
.long 0x3f35bf35,0x3e48bf7b,0xbec4bf6d,0xbf55bf0e,0x3f353f35,0x3f553f0e,0x3f6d3ec4,0x3f7b3e48
.long 0xbf800000,0xbf7bbe48,0xbf6dbec4,0xbf55bf0e,0x3f800000,0x3f553f0e,0x3ec43f6d,0xbe483f7b
.long 0xbf800000,0xbf0ebf55,0x3ec4bf6d,0x3f7bbe48,0x3f800000,0x3e483f7b,0xbf6d3ec4,0xbf0ebf55
.long 0xbf800000,0x3e48bf7b,0x3f6d3ec4,0xbf0e3f55,0x3f800000,0xbf0e3f55,0xbec4bf6d,0x3f7b3e48
.long 0xbf800000,0x3f55bf0e,0xbec43f6d,0xbe48bf7b,0x3f800000,0xbf7b3e48,0x3f6dbec4,0xbf553f0e
.long 0xbf800000,0x3f7b3e48,0xbf6dbec4,0x3f553f0e,0x3f800000,0xbf55bf0e,0x3ec43f6d,0x3e48bf7b
.long 0xbf800000,0x3f0e3f55,0x3ec4bf6d,0xbf7b3e48,0x3f800000,0xbe48bf7b,0xbf6d3ec4,0x3f0e3f55
.long 0xbf800000,0xbe483f7b,0x3f6d3ec4,0x3f0ebf55,0x3f800000,0x3f0ebf55,0xbec4bf6d,0xbf7bbe48
.long 0xbf800000,0xbf553f0e,0xbec43f6d,0x3e483f7b,0x3f800000,0x3f7bbe48,0x3f6dbec4,0x3f55bf0e
.long 0xbf35bf35,0xbf0ebf55,0xbec4bf6d,0xbe48bf7b,0xbf353f35,0xbf7b3e48,0xbf6dbec4,0xbf0ebf55
.long 0x3f353f35,0xbe483f7b,0xbf6d3ec4,0xbf55bf0e,0x3f35bf35,0x3f553f0e,0xbec43f6d,0xbf7bbe48
.long 0xbf35bf35,0x3f55bf0e,0x3ec43f6d,0xbf7b3e48,0xbf353f35,0xbe48bf7b,0x3f6d3ec4,0xbf553f0e
.long 0x3f353f35,0xbf7bbe48,0x3f6dbec4,0xbf0e3f55,0x3f35bf35,0xbf0e3f55,0x3ec4bf6d,0xbe483f7b
.long 0xbf35bf35,0x3f0e3f55,0xbec4bf6d,0x3e483f7b,0xbf353f35,0x3f7bbe48,0xbf6dbec4,0x3f0e3f55
.long 0x3f353f35,0x3e48bf7b,0xbf6d3ec4,0x3f553f0e,0x3f35bf35,0xbf55bf0e,0xbec43f6d,0x3f7b3e48
.long 0xbf35bf35,0xbf553f0e,0x3ec43f6d,0x3f7bbe48,0xbf353f35,0x3e483f7b,0x3f6d3ec4,0x3f55bf0e
.long 0x3f353f35,0x3f7b3e48,0x3f6dbec4,0x3f0ebf55,0x3f35bf35,0x3f0ebf55,0x3ec4bf6d,0x3e48bf7b
.long 0x3f800000,0x3f7b3e48,0x3f6d3ec4,0x3f553f0e,0x3f800000,0x3f553f0e,0x3ec43f6d,0xbe483f7b
.long 0x3f800000,0x3f0e3f55,0xbec43f6d,0xbf7b3e48,0x3f800000,0x3e483f7b,0xbf6d3ec4,0xbf0ebf55
.long 0x3f800000,0xbe483f7b,0xbf6dbec4,0x3f0ebf55,0x3f800000,0xbf0e3f55,0xbec4bf6d,0x3f7b3e48
.long 0x3f800000,0xbf553f0e,0x3ec4bf6d,0x3e483f7b,0x3f800000,0xbf7b3e48,0x3f6dbec4,0xbf553f0e
.long 0x3f800000,0xbf7bbe48,0x3f6d3ec4,0xbf55bf0e,0x3f800000,0xbf55bf0e,0x3ec43f6d,0x3e48bf7b
.long 0x3f800000,0xbf0ebf55,0xbec43f6d,0x3f7bbe48,0x3f800000,0xbe48bf7b,0xbf6d3ec4,0x3f0e3f55
.long 0x3f800000,0x3e48bf7b,0xbf6dbec4,0xbf0e3f55,0x3f800000,0x3f0ebf55,0xbec4bf6d,0xbf7bbe48
.long 0x3f800000,0x3f55bf0e,0x3ec4bf6d,0xbe48bf7b,0x3f800000,0x3f7bbe48,0x3f6dbec4,0x3f55bf0e
.long 0x3f353f35,0x3f0e3f55,0x3ec43f6d,0x3e483f7b,0xbf353f35,0xbf7b3e48,0xbf6dbec4,0xbf0ebf55
.long 0xbf35bf35,0x3e48bf7b,0x3f6dbec4,0x3f553f0e,0x3f35bf35,0x3f553f0e,0xbec43f6d,0xbf7bbe48
.long 0x3f353f35,0xbf553f0e,0xbec4bf6d,0x3f7bbe48,0xbf353f35,0xbe48bf7b,0x3f6d3ec4,0xbf553f0e
.long 0xbf35bf35,0x3f7b3e48,0xbf6d3ec4,0x3f0ebf55,0x3f35bf35,0xbf0e3f55,0x3ec4bf6d,0xbe483f7b
.long 0x3f353f35,0xbf0ebf55,0x3ec43f6d,0xbe48bf7b,0xbf353f35,0x3f7bbe48,0xbf6dbec4,0x3f0e3f55
.long 0xbf35bf35,0xbe483f7b,0x3f6dbec4,0xbf55bf0e,0x3f35bf35,0xbf55bf0e,0xbec43f6d,0x3f7b3e48
.long 0x3f353f35,0x3f55bf0e,0xbec4bf6d,0xbf7b3e48,0xbf353f35,0x3e483f7b,0x3f6d3ec4,0x3f55bf0e
.long 0xbf35bf35,0xbf7bbe48,0xbf6d3ec4,0xbf0e3f55,0x3f35bf35,0x3f0ebf55,0x3ec4bf6d,0x3e48bf7b
.long 0x3f80,0xbe483f7b,0xbec43f6d,0xbf0e3f55,0xbf80,0x3f0ebf55,0x3f6dbec4,0x3f7b3e48
.long 0x3f80,0xbf553f0e,0xbf6dbec4,0xbe48bf7b,0xbf80,0x3f7bbe48,0x3ec43f6d,0xbf553f0e
.long 0x3f80,0xbf7bbe48,0x3ec4bf6d,0x3f553f0e,0xbf80,0x3f553f0e,0xbf6d3ec4,0x3e48bf7b
.long 0x3f80,0xbf0ebf55,0x3f6d3ec4,0xbf7b3e48,0xbf80,0x3e483f7b,0xbec4bf6d,0x3f0e3f55
.long 0x3f80,0x3e48bf7b,0xbec43f6d,0x3f0ebf55,0xbf80,0xbf0e3f55,0x3f6dbec4,0xbf7bbe48
.long 0x3f80,0x3f55bf0e,0xbf6dbec4,0x3e483f7b,0xbf80,0xbf7b3e48,0x3ec43f6d,0x3f55bf0e
.long 0x3f80,0x3f7b3e48,0x3ec4bf6d,0xbf55bf0e,0xbf80,0xbf55bf0e,0xbf6d3ec4,0xbe483f7b
.long 0x3f80,0x3f0e3f55,0x3f6d3ec4,0x3f7bbe48,0xbf80,0xbe48bf7b,0xbec4bf6d,0xbf0ebf55
.long 0xbf353f35,0xbf553f0e,0xbf6d3ec4,0xbf7b3e48,0x3f353f35,0x3e483f7b,0xbec43f6d,0xbf553f0e
.long 0x3f35bf35,0x3f7b3e48,0x3ec43f6d,0xbf0e3f55,0xbf35bf35,0x3f0ebf55,0x3f6d3ec4,0xbe483f7b
.long 0xbf353f35,0xbf0ebf55,0x3f6dbec4,0x3e483f7b,0x3f353f35,0xbf7b3e48,0x3ec4bf6d,0x3f0e3f55
.long 0x3f35bf35,0xbe483f7b,0xbec4bf6d,0x3f553f0e,0xbf35bf35,0x3f553f0e,0xbf6dbec4,0x3f7b3e48
.long 0xbf353f35,0x3f55bf0e,0xbf6d3ec4,0x3f7bbe48,0x3f353f35,0xbe48bf7b,0xbec43f6d,0x3f55bf0e
.long 0x3f35bf35,0xbf7bbe48,0x3ec43f6d,0x3f0ebf55,0xbf35bf35,0xbf0e3f55,0x3f6d3ec4,0x3e48bf7b
.long 0xbf353f35,0x3f0e3f55,0x3f6dbec4,0xbe48bf7b,0x3f353f35,0x3f7bbe48,0x3ec4bf6d,0xbf0ebf55
.long 0x3f35bf35,0x3e48bf7b,0xbec4bf6d,0xbf55bf0e,0xbf35bf35,0xbf55bf0e,0xbf6dbec4,0xbf7bbe48
.long 0x3f80,0x3f80,0x3f80,0x3f80,0x3f80,0x3ec43f6d,0x3f353f35,0x3f6d3ec4
.long 0x3f80,0x3f353f35,0x3f800000,0x3f35bf35,0x3f80,0x3f6d3ec4,0x3f35bf35,0xbec4bf6d
.long 0x3f80,0x3f800000,0xbf80,0xbf800000,0x3f80,0x3f6dbec4,0xbf35bf35,0xbec43f6d
.long 0x3f80,0x3f35bf35,0xbf800000,0x3f353f35,0x3f80,0x3ec4bf6d,0xbf353f35,0x3f6dbec4
.long 0x3f80,0xbf80,0x3f80,0xbf80,0x3f80,0xbec4bf6d,0x3f353f35,0xbf6dbec4
.long 0x3f80,0xbf35bf35,0x3f800000,0xbf353f35,0x3f80,0xbf6dbec4,0x3f35bf35,0x3ec43f6d
.long 0x3f80,0xbf800000,0xbf80,0x3f800000,0x3f80,0xbf6d3ec4,0xbf35bf35,0x3ec4bf6d
.long 0x3f80,0xbf353f35,0xbf800000,0xbf35bf35,0x3f80,0xbec43f6d,0xbf353f35,0xbf6d3ec4
.long 0x3f80,0x3f80,0x3f80,0x3f80,0x3f800000,0x3f6dbec4,0x3f35bf35,0x3ec4bf6d
.long 0xbf80,0xbf35bf35,0xbf800000,0xbf353f35,0xbf800000,0xbec43f6d,0x3f353f35,0x3f6dbec4
.long 0x3f80,0x3f800000,0xbf80,0xbf800000,0x3f800000,0xbec4bf6d,0xbf353f35,0x3f6d3ec4
.long 0xbf80,0xbf353f35,0x3f800000,0xbf35bf35,0xbf800000,0x3f6d3ec4,0xbf35bf35,0x3ec43f6d
.long 0x3f80,0xbf80,0x3f80,0xbf80,0x3f800000,0xbf6d3ec4,0x3f35bf35,0xbec43f6d
.long 0xbf80,0x3f353f35,0xbf800000,0x3f35bf35,0xbf800000,0x3ec4bf6d,0x3f353f35,0xbf6d3ec4
.long 0x3f80,0xbf800000,0xbf80,0x3f800000,0x3f800000,0x3ec43f6d,0xbf353f35,0xbf6dbec4
.long 0xbf80,0x3f35bf35,0x3f800000,0x3f353f35,0xbf800000,0xbf6dbec4,0xbf35bf35,0xbec4bf6d
.long 0x3f80,0x3f80,0x3f80,0x3f80,0xbf80,0xbec4bf6d,0xbf35bf35,0xbf6dbec4
.long 0x3f80,0x3f353f35,0x3f800000,0x3f35bf35,0xbf80,0xbf6dbec4,0xbf353f35,0x3ec43f6d
.long 0x3f80,0x3f800000,0xbf80,0xbf800000,0xbf80,0xbf6d3ec4,0x3f353f35,0x3ec4bf6d
.long 0x3f80,0x3f35bf35,0xbf800000,0x3f353f35,0xbf80,0xbec43f6d,0x3f35bf35,0xbf6d3ec4
.long 0x3f80,0xbf80,0x3f80,0xbf80,0xbf80,0x3ec43f6d,0xbf35bf35,0x3f6d3ec4
.long 0x3f80,0xbf35bf35,0x3f800000,0xbf353f35,0xbf80,0x3f6d3ec4,0xbf353f35,0xbec4bf6d
.long 0x3f80,0xbf800000,0xbf80,0x3f800000,0xbf80,0x3f6dbec4,0x3f353f35,0xbec43f6d
.long 0x3f80,0xbf353f35,0xbf800000,0xbf35bf35,0xbf80,0x3ec4bf6d,0x3f35bf35,0x3f6dbec4
.long 0x3f80,0x3f80,0x3f80,0x3f80,0xbf800000,0xbf6d3ec4,0xbf353f35,0xbec43f6d
.long 0xbf80,0xbf35bf35,0xbf800000,0xbf353f35,0x3f800000,0x3ec4bf6d,0xbf35bf35,0xbf6d3ec4
.long 0x3f80,0x3f800000,0xbf80,0xbf800000,0xbf800000,0x3ec43f6d,0x3f35bf35,0xbf6dbec4
.long 0xbf80,0xbf353f35,0x3f800000,0xbf35bf35,0x3f800000,0xbf6dbec4,0x3f353f35,0xbec4bf6d
.long 0x3f80,0xbf80,0x3f80,0xbf80,0xbf800000,0x3f6dbec4,0xbf353f35,0x3ec4bf6d
.long 0xbf80,0x3f353f35,0xbf800000,0x3f35bf35,0x3f800000,0xbec43f6d,0xbf35bf35,0x3f6dbec4
.long 0x3f80,0xbf800000,0xbf80,0x3f800000,0xbf800000,0xbec4bf6d,0x3f35bf35,0x3f6d3ec4
.long 0xbf80,0x3f35bf35,0x3f800000,0x3f353f35,0x3f800000,0x3f6d3ec4,0x3f353f35,0x3ec43f6d
.long 0xbf800000,0xbf800000,0xbf800000,0xbf800000,0xbf800000,0xbf6d3ec4,0xbf353f35,0xbec43f6d
.long 0xbf800000,0xbf353f35,0x3f80,0x3f353f35,0xbf800000,0xbec43f6d,0x3f353f35,0x3f6dbec4
.long 0xbf800000,0x3f80,0x3f800000,0xbf80,0xbf800000,0x3ec43f6d,0x3f35bf35,0xbf6dbec4
.long 0xbf800000,0x3f353f35,0xbf80,0xbf353f35,0xbf800000,0x3f6d3ec4,0xbf35bf35,0x3ec43f6d
.long 0xbf800000,0x3f800000,0xbf800000,0x3f800000,0xbf800000,0x3f6dbec4,0xbf353f35,0x3ec4bf6d
.long 0xbf800000,0x3f35bf35,0x3f80,0xbf35bf35,0xbf800000,0x3ec4bf6d,0x3f353f35,0xbf6d3ec4
.long 0xbf800000,0xbf80,0x3f800000,0x3f80,0xbf800000,0xbec4bf6d,0x3f35bf35,0x3f6d3ec4
.long 0xbf800000,0xbf35bf35,0xbf80,0x3f35bf35,0xbf800000,0xbf6dbec4,0xbf35bf35,0xbec4bf6d
.long 0xbf800000,0xbf800000,0xbf800000,0xbf800000,0x3f80,0x3ec43f6d,0x3f353f35,0x3f6d3ec4
.long 0x3f800000,0x3f35bf35,0xbf80,0xbf35bf35,0xbf80,0xbf6dbec4,0xbf353f35,0x3ec43f6d
.long 0xbf800000,0x3f80,0x3f800000,0xbf80,0x3f80,0x3f6dbec4,0xbf35bf35,0xbec43f6d
.long 0x3f800000,0xbf35bf35,0x3f80,0x3f35bf35,0xbf80,0xbec43f6d,0x3f35bf35,0xbf6d3ec4
.long 0xbf800000,0x3f800000,0xbf800000,0x3f800000,0x3f80,0xbec4bf6d,0x3f353f35,0xbf6dbec4
.long 0x3f800000,0xbf353f35,0xbf80,0x3f353f35,0xbf80,0x3f6d3ec4,0xbf353f35,0xbec4bf6d
.long 0xbf800000,0xbf80,0x3f800000,0x3f80,0x3f80,0xbf6d3ec4,0xbf35bf35,0x3ec4bf6d
.long 0x3f800000,0x3f353f35,0x3f80,0xbf353f35,0xbf80,0x3ec4bf6d,0x3f35bf35,0x3f6dbec4
.long 0xbf800000,0xbf800000,0xbf800000,0xbf800000,0x3f800000,0x3f6dbec4,0x3f35bf35,0x3ec4bf6d
.long 0xbf800000,0xbf353f35,0x3f80,0x3f353f35,0x3f800000,0x3ec4bf6d,0xbf35bf35,0xbf6d3ec4
.long 0xbf800000,0x3f80,0x3f800000,0xbf80,0x3f800000,0xbec4bf6d,0xbf353f35,0x3f6d3ec4
.long 0xbf800000,0x3f353f35,0xbf80,0xbf353f35,0x3f800000,0xbf6dbec4,0x3f353f35,0xbec4bf6d
.long 0xbf800000,0x3f800000,0xbf800000,0x3f800000,0x3f800000,0xbf6d3ec4,0x3f35bf35,0xbec43f6d
.long 0xbf800000,0x3f35bf35,0x3f80,0xbf35bf35,0x3f800000,0xbec43f6d,0xbf35bf35,0x3f6dbec4
.long 0xbf800000,0xbf80,0x3f800000,0x3f80,0x3f800000,0x3ec43f6d,0xbf353f35,0xbf6dbec4
.long 0xbf800000,0xbf35bf35,0xbf80,0x3f35bf35,0x3f800000,0x3f6d3ec4,0x3f353f35,0x3ec43f6d
.long 0xbf800000,0xbf800000,0xbf800000,0xbf800000,0xbf80,0xbec4bf6d,0xbf35bf35,0xbf6dbec4
.long 0x3f800000,0x3f35bf35,0xbf80,0xbf35bf35,0x3f80,0x3f6d3ec4,0x3f35bf35,0xbec4bf6d
.long 0xbf800000,0x3f80,0x3f800000,0xbf80,0xbf80,0xbf6d3ec4,0x3f353f35,0x3ec4bf6d
.long 0x3f800000,0xbf35bf35,0x3f80,0x3f35bf35,0x3f80,0x3ec4bf6d,0xbf353f35,0x3f6dbec4
.long 0xbf800000,0x3f800000,0xbf800000,0x3f800000,0xbf80,0x3ec43f6d,0xbf35bf35,0x3f6d3ec4
.long 0x3f800000,0xbf353f35,0xbf80,0x3f353f35,0x3f80,0xbf6dbec4,0x3f35bf35,0x3ec43f6d
.long 0xbf800000,0xbf80,0x3f800000,0x3f80,0xbf80,0x3f6dbec4,0x3f353f35,0xbec43f6d
.long 0x3f800000,0x3f353f35,0x3f80,0xbf353f35,0x3f80,0xbec43f6d,0xbf353f35,0xbf6d3ec4
.long 0xbf80,0xbe48bf7b,0xbec4bf6d,0xbf0ebf55,0xbf80,0xbf0ebf55,0xbf6dbec4,0xbf7b3e48
.long 0xbf80,0xbf55bf0e,0xbf6d3ec4,0xbe483f7b,0xbf80,0xbf7bbe48,0xbec43f6d,0x3f553f0e
.long 0xbf80,0xbf7b3e48,0x3ec43f6d,0x3f55bf0e,0xbf80,0xbf553f0e,0x3f6d3ec4,0xbe48bf7b
.long 0xbf80,0xbf0e3f55,0x3f6dbec4,0xbf7bbe48,0xbf80,0xbe483f7b,0x3ec4bf6d,0xbf0e3f55
.long 0xbf80,0x3e483f7b,0xbec4bf6d,0x3f0e3f55,0xbf80,0x3f0e3f55,0xbf6dbec4,0x3f7bbe48
.long 0xbf80,0x3f553f0e,0xbf6d3ec4,0x3e48bf7b,0xbf80,0x3f7b3e48,0xbec43f6d,0xbf55bf0e
.long 0xbf80,0x3f7bbe48,0x3ec43f6d,0xbf553f0e,0xbf80,0x3f55bf0e,0x3f6d3ec4,0x3e483f7b
.long 0xbf80,0x3f0ebf55,0x3f6dbec4,0x3f7b3e48,0xbf80,0x3e48bf7b,0x3ec4bf6d,0x3f0ebf55
.long 0xbf35bf35,0xbf55bf0e,0xbf6dbec4,0xbf7bbe48,0xbf353f35,0xbe483f7b,0x3ec43f6d,0x3f553f0e
.long 0x3f353f35,0x3f7bbe48,0x3ec4bf6d,0xbf0ebf55,0x3f35bf35,0xbf0ebf55,0xbf6d3ec4,0x3e483f7b
.long 0xbf35bf35,0xbf0e3f55,0x3f6d3ec4,0x3e48bf7b,0xbf353f35,0x3f7b3e48,0xbec4bf6d,0xbf0e3f55
.long 0x3f353f35,0xbe48bf7b,0xbec43f6d,0x3f55bf0e,0x3f35bf35,0xbf553f0e,0x3f6dbec4,0xbf7b3e48
.long 0xbf35bf35,0x3f553f0e,0xbf6dbec4,0x3f7b3e48,0xbf353f35,0x3e48bf7b,0x3ec43f6d,0xbf55bf0e
.long 0x3f353f35,0xbf7b3e48,0x3ec4bf6d,0x3f0e3f55,0x3f35bf35,0x3f0e3f55,0xbf6d3ec4,0xbe48bf7b
.long 0xbf35bf35,0x3f0ebf55,0x3f6d3ec4,0xbe483f7b,0xbf353f35,0xbf7bbe48,0xbec4bf6d,0x3f0ebf55
.long 0x3f353f35,0x3e483f7b,0xbec43f6d,0xbf553f0e,0x3f35bf35,0x3f55bf0e,0x3f6dbec4,0x3f7bbe48
.long 0xbf800000,0xbf7b3e48,0xbf6d3ec4,0xbf553f0e,0x3f800000,0x3f55bf0e,0x3ec4bf6d,0xbe48bf7b
.long 0xbf800000,0xbf0e3f55,0x3ec43f6d,0x3f7b3e48,0x3f800000,0x3e48bf7b,0xbf6dbec4,0xbf0e3f55
.long 0xbf800000,0x3e483f7b,0x3f6dbec4,0xbf0ebf55,0x3f800000,0xbf0ebf55,0xbec43f6d,0x3f7bbe48
.long 0xbf800000,0x3f553f0e,0xbec4bf6d,0xbe483f7b,0x3f800000,0xbf7bbe48,0x3f6d3ec4,0xbf55bf0e
.long 0xbf800000,0x3f7bbe48,0xbf6d3ec4,0x3f55bf0e,0x3f800000,0xbf553f0e,0x3ec4bf6d,0x3e483f7b
.long 0xbf800000,0x3f0ebf55,0x3ec43f6d,0xbf7bbe48,0x3f800000,0xbe483f7b,0xbf6dbec4,0x3f0ebf55
.long 0xbf800000,0xbe48bf7b,0x3f6dbec4,0x3f0e3f55,0x3f800000,0x3f0e3f55,0xbec43f6d,0xbf7b3e48
.long 0xbf800000,0xbf55bf0e,0xbec4bf6d,0x3e48bf7b,0x3f800000,0x3f7b3e48,0x3f6d3ec4,0x3f553f0e
.long 0xbf353f35,0xbf0e3f55,0xbec43f6d,0xbe483f7b,0xbf35bf35,0xbf7bbe48,0xbf6d3ec4,0xbf0e3f55
.long 0x3f35bf35,0xbe48bf7b,0xbf6dbec4,0xbf553f0e,0x3f353f35,0x3f55bf0e,0xbec4bf6d,0xbf7b3e48
.long 0xbf353f35,0x3f553f0e,0x3ec4bf6d,0xbf7bbe48,0xbf35bf35,0xbe483f7b,0x3f6dbec4,0xbf55bf0e
.long 0x3f35bf35,0xbf7b3e48,0x3f6d3ec4,0xbf0ebf55,0x3f353f35,0xbf0ebf55,0x3ec43f6d,0xbe48bf7b
.long 0xbf353f35,0x3f0ebf55,0xbec43f6d,0x3e48bf7b,0xbf35bf35,0x3f7b3e48,0xbf6d3ec4,0x3f0ebf55
.long 0x3f35bf35,0x3e483f7b,0xbf6dbec4,0x3f55bf0e,0x3f353f35,0xbf553f0e,0xbec4bf6d,0x3f7bbe48
.long 0xbf353f35,0xbf55bf0e,0x3ec4bf6d,0x3f7b3e48,0xbf35bf35,0x3e48bf7b,0x3f6dbec4,0x3f553f0e
.long 0x3f35bf35,0x3f7bbe48,0x3f6d3ec4,0x3f0e3f55,0x3f353f35,0x3f0e3f55,0x3ec43f6d,0x3e483f7b
.long 0x3f800000,0x3f7bbe48,0x3f6dbec4,0x3f55bf0e,0x3f800000,0x3f55bf0e,0x3ec4bf6d,0xbe48bf7b
.long 0x3f800000,0x3f0ebf55,0xbec4bf6d,0xbf7bbe48,0x3f800000,0x3e48bf7b,0xbf6dbec4,0xbf0e3f55
.long 0x3f800000,0xbe48bf7b,0xbf6d3ec4,0x3f0e3f55,0x3f800000,0xbf0ebf55,0xbec43f6d,0x3f7bbe48
.long 0x3f800000,0xbf55bf0e,0x3ec43f6d,0x3e48bf7b,0x3f800000,0xbf7bbe48,0x3f6d3ec4,0xbf55bf0e
.long 0x3f800000,0xbf7b3e48,0x3f6dbec4,0xbf553f0e,0x3f800000,0xbf553f0e,0x3ec4bf6d,0x3e483f7b
.long 0x3f800000,0xbf0e3f55,0xbec4bf6d,0x3f7b3e48,0x3f800000,0xbe483f7b,0xbf6dbec4,0x3f0ebf55
.long 0x3f800000,0x3e483f7b,0xbf6d3ec4,0xbf0ebf55,0x3f800000,0x3f0e3f55,0xbec43f6d,0xbf7b3e48
.long 0x3f800000,0x3f553f0e,0x3ec43f6d,0xbe483f7b,0x3f800000,0x3f7b3e48,0x3f6d3ec4,0x3f553f0e
.long 0x3f35bf35,0x3f0ebf55,0x3ec4bf6d,0x3e48bf7b,0xbf35bf35,0xbf7bbe48,0xbf6d3ec4,0xbf0e3f55
.long 0xbf353f35,0x3e483f7b,0x3f6d3ec4,0x3f55bf0e,0x3f353f35,0x3f55bf0e,0xbec4bf6d,0xbf7b3e48
.long 0x3f35bf35,0xbf55bf0e,0xbec43f6d,0x3f7b3e48,0xbf35bf35,0xbe483f7b,0x3f6dbec4,0xbf55bf0e
.long 0xbf353f35,0x3f7bbe48,0xbf6dbec4,0x3f0e3f55,0x3f353f35,0xbf0ebf55,0x3ec43f6d,0xbe48bf7b
.long 0x3f35bf35,0xbf0e3f55,0x3ec4bf6d,0xbe483f7b,0xbf35bf35,0x3f7b3e48,0xbf6d3ec4,0x3f0ebf55
.long 0xbf353f35,0xbe48bf7b,0x3f6d3ec4,0xbf553f0e,0x3f353f35,0xbf553f0e,0xbec4bf6d,0x3f7bbe48
.long 0x3f35bf35,0x3f553f0e,0xbec43f6d,0xbf7bbe48,0xbf35bf35,0x3e48bf7b,0x3f6dbec4,0x3f553f0e
.long 0xbf353f35,0xbf7b3e48,0xbf6dbec4,0xbf0ebf55,0x3f353f35,0x3f0e3f55,0x3ec43f6d,0x3e483f7b
.long 0xbf80,0xbe48bf7b,0xbec4bf6d,0xbf0ebf55,0x3f80,0x3f0e3f55,0x3f6d3ec4,0x3f7bbe48
.long 0xbf80,0xbf55bf0e,0xbf6d3ec4,0xbe483f7b,0x3f80,0x3f7b3e48,0x3ec4bf6d,0xbf55bf0e
.long 0xbf80,0xbf7b3e48,0x3ec43f6d,0x3f55bf0e,0x3f80,0x3f55bf0e,0xbf6dbec4,0x3e483f7b
.long 0xbf80,0xbf0e3f55,0x3f6dbec4,0xbf7bbe48,0x3f80,0x3e48bf7b,0xbec43f6d,0x3f0ebf55
.long 0xbf80,0x3e483f7b,0xbec4bf6d,0x3f0e3f55,0x3f80,0xbf0ebf55,0x3f6d3ec4,0xbf7b3e48
.long 0xbf80,0x3f553f0e,0xbf6d3ec4,0x3e48bf7b,0x3f80,0xbf7bbe48,0x3ec4bf6d,0x3f553f0e
.long 0xbf80,0x3f7bbe48,0x3ec43f6d,0xbf553f0e,0x3f80,0xbf553f0e,0xbf6dbec4,0xbe48bf7b
.long 0xbf80,0x3f0ebf55,0x3f6dbec4,0x3f7b3e48,0x3f80,0xbe483f7b,0xbec43f6d,0xbf0e3f55
.long 0xbf35bf35,0xbf55bf0e,0xbf6dbec4,0xbf7bbe48,0x3f35bf35,0x3e48bf7b,0xbec4bf6d,0xbf55bf0e
.long 0x3f353f35,0x3f7bbe48,0x3ec4bf6d,0xbf0ebf55,0xbf353f35,0x3f0e3f55,0x3f6dbec4,0xbe48bf7b
.long 0xbf35bf35,0xbf0e3f55,0x3f6d3ec4,0x3e48bf7b,0x3f35bf35,0xbf7bbe48,0x3ec43f6d,0x3f0ebf55
.long 0x3f353f35,0xbe48bf7b,0xbec43f6d,0x3f55bf0e,0xbf353f35,0x3f55bf0e,0xbf6d3ec4,0x3f7bbe48
.long 0xbf35bf35,0x3f553f0e,0xbf6dbec4,0x3f7b3e48,0x3f35bf35,0xbe483f7b,0xbec4bf6d,0x3f553f0e
.long 0x3f353f35,0xbf7b3e48,0x3ec4bf6d,0x3f0e3f55,0xbf353f35,0xbf0ebf55,0x3f6dbec4,0x3e483f7b
.long 0xbf35bf35,0x3f0ebf55,0x3f6d3ec4,0xbe483f7b,0x3f35bf35,0x3f7b3e48,0x3ec43f6d,0xbf0e3f55
.long 0x3f353f35,0x3e483f7b,0xbec43f6d,0xbf553f0e,0xbf353f35,0xbf553f0e,0xbf6d3ec4,0xbf7b3e48
.long 0x3f80,0x3f80,0x3f80,0x3f80,0x3f80,0xbf733e9e,0xbf16bf4f,0x3f16bf4f
.long 0x3f80,0xbf16bf4f,0x3f733e9e,0xbf733e9e,0x3f80,0x3f16bf4f,0xbf733e9e,0x3f733e9e
.long 0x3f80,0xbe9e3f73,0xbf163f4f,0xbf4f3f16,0x3f80,0xbf800000,0xbf80,0x3f800000
.long 0x3f80,0xbe9ebf73,0x3f163f4f,0xbf4fbf16,0x3f80,0x3f4fbf16,0xbf73be9e,0x3e9e3f73
.long 0x3f80,0xbf163f4f,0xbf733e9e,0xbf73be9e,0x3f80,0xbf73be9e,0x3f16bf4f,0x3f163f4f
.long 0x3f80,0xbf80,0x3f80,0xbf80,0x3f80,0x3f73be9e,0xbf16bf4f,0xbf163f4f
.long 0x3f80,0xbf4f3f16,0xbf73be9e,0xbe9ebf73,0x3f80,0xbf4fbf16,0x3f73be9e,0xbe9e3f73
.long 0x3f80,0x3e9ebf73,0xbf163f4f,0x3f4fbf16,0x3f80,0x3f800000,0xbf80,0xbf800000
.long 0x3f80,0x3f80,0x3f80,0x3f80,0x3f733e9e,0x3f80,0xbf733e9e,0xbf16bf4f
.long 0x3f16bf4f,0x3f80,0xbf16bf4f,0x3f733e9e,0xbf16bf4f,0x3f80,0x3f16bf4f,0xbf733e9e
.long 0xbf733e9e,0xbf800000,0xbf73be9e,0xbf4fbf16,0x3f80,0xbf800000,0xbf80,0x3f800000
.long 0x3f733e9e,0xbf800000,0x3f73be9e,0xbf4f3f16,0x3f16bf4f,0xbf800000,0x3f163f4f,0x3e9ebf73
.long 0xbf16bf4f,0xbf80,0x3f16bf4f,0x3f73be9e,0xbf733e9e,0xbf80,0x3f733e9e,0xbf163f4f
.long 0x3f80,0xbf80,0x3f80,0xbf80,0x3f733e9e,0xbf80,0xbf733e9e,0x3f163f4f
.long 0x3f16bf4f,0x3f800000,0x3f163f4f,0xbe9e3f73,0xbf16bf4f,0x3f800000,0xbf163f4f,0xbe9ebf73
.long 0xbf733e9e,0x3f800000,0xbf73be9e,0x3f4f3f16,0x3f80,0x3f800000,0xbf80,0xbf800000
.long 0x3f80,0x3f80,0x3f80,0x3f80,0x3f16bf4f,0x3f733e9e,0x3f80,0xbf733e9e
.long 0xbf733e9e,0x3f16bf4f,0x3f80,0xbf16bf4f,0x3f733e9e,0xbf16bf4f,0x3f80,0x3f16bf4f
.long 0xbf16bf4f,0xbe9ebf73,0xbf80,0x3e9ebf73,0x3f80,0xbf800000,0xbf80,0x3f800000
.long 0x3f16bf4f,0xbe9e3f73,0xbf80,0x3e9e3f73,0xbf733e9e,0x3f4f3f16,0xbf80,0xbf4f3f16
.long 0x3f733e9e,0x3f163f4f,0x3f80,0xbf163f4f,0xbf16bf4f,0x3f73be9e,0x3f80,0xbf73be9e
.long 0x3f80,0xbf80,0x3f80,0xbf80,0x3f16bf4f,0xbf73be9e,0x3f80,0x3f73be9e
.long 0xbf733e9e,0xbf4fbf16,0xbf80,0x3f4fbf16,0x3f733e9e,0xbf4f3f16,0xbf80,0x3f4f3f16
.long 0xbf16bf4f,0x3e9e3f73,0xbf80,0xbe9e3f73,0x3f80,0x3f800000,0xbf80,0xbf800000
.long 0x3f80,0x3f80,0x3f80,0x3f80,0xbf16bf4f,0x3f16bf4f,0x3f733e9e,0x3f80
.long 0x3f733e9e,0xbf733e9e,0x3f16bf4f,0x3f80,0xbf733e9e,0x3f733e9e,0xbf16bf4f,0x3f80
.long 0x3f16bf4f,0x3f4fbf16,0x3f73be9e,0x3f800000,0x3f80,0xbf800000,0xbf80,0x3f800000
.long 0xbf16bf4f,0x3f4f3f16,0xbf73be9e,0x3f800000,0x3f733e9e,0xbe9ebf73,0xbf163f4f,0x3f800000
.long 0xbf733e9e,0xbf73be9e,0xbf16bf4f,0xbf80,0x3f16bf4f,0x3f163f4f,0xbf733e9e,0xbf80
.long 0x3f80,0xbf80,0x3f80,0xbf80,0xbf16bf4f,0xbf163f4f,0x3f733e9e,0xbf80
.long 0x3f733e9e,0x3e9e3f73,0xbf163f4f,0xbf800000,0xbf733e9e,0x3e9ebf73,0x3f163f4f,0xbf800000
.long 0x3f16bf4f,0xbf4f3f16,0x3f73be9e,0xbf800000,0x3f80,0x3f800000,0xbf80,0xbf800000
.long 0x3f80,0x3f733e9e,0x3f16bf4f,0xbf16bf4f,0x0,0x0,0x0,0x0
.long 0x0,0x0,0x0,0x0,0x0,0x0,0x0,0x0
.long 0x3f80,0x3f4f3f16,0x3f73be9e,0x3e9ebf73,0x0,0x0,0x0,0x0
.long 0x0,0x0,0x0,0x0,0x0,0x0,0x0,0x0
.long 0x3f80,0x3f163f4f,0x3f733e9e,0x3f73be9e,0x0,0x0,0x0,0x0
.long 0x0,0x0,0x0,0x0,0x0,0x0,0x0,0x0
.long 0x3f80,0x3e9e3f73,0x3f163f4f,0x3f4f3f16,0x0,0x0,0x0,0x0
.long 0x0,0x0,0x0,0x0,0x0,0x0,0x0,0x0
.long 0xbf733e9e,0x3f80,0x3f733e9e,0x3f16bf4f,0x0,0x0,0x0,0x0
.long 0x0,0x0,0x0,0x0,0x0,0x0,0x0,0x0
.long 0xbf16bf4f,0xbf800000,0xbf163f4f,0x3e9e3f73,0x0,0x0,0x0,0x0
.long 0x0,0x0,0x0,0x0,0x0,0x0,0x0,0x0
.long 0x3f16bf4f,0xbf80,0xbf16bf4f,0xbf73be9e,0x0,0x0,0x0,0x0
.long 0x0,0x0,0x0,0x0,0x0,0x0,0x0,0x0
.long 0x3f733e9e,0x3f800000,0x3f73be9e,0x3f4fbf16,0x0,0x0,0x0,0x0
.long 0x0,0x0,0x0,0x0,0x0,0x0,0x0,0x0
.long 0xbf16bf4f,0xbf733e9e,0x3f80,0x3f733e9e,0x0,0x0,0x0,0x0
.long 0x0,0x0,0x0,0x0,0x0,0x0,0x0,0x0
.long 0x3f733e9e,0x3f4fbf16,0xbf80,0xbf4fbf16,0x0,0x0,0x0,0x0
.long 0x0,0x0,0x0,0x0,0x0,0x0,0x0,0x0
.long 0xbf733e9e,0xbf163f4f,0x3f80,0x3f163f4f,0x0,0x0,0x0,0x0
.long 0x0,0x0,0x0,0x0,0x0,0x0,0x0,0x0
.long 0x3f16bf4f,0x3e9ebf73,0xbf80,0xbe9ebf73,0x0,0x0,0x0,0x0
.long 0x0,0x0,0x0,0x0,0x0,0x0,0x0,0x0
.long 0x3f16bf4f,0xbf16bf4f,0xbf733e9e,0x3f80,0x0,0x0,0x0,0x0
.long 0x0,0x0,0x0,0x0,0x0,0x0,0x0,0x0
.long 0xbf733e9e,0xbe9e3f73,0x3f163f4f,0x3f800000,0x0,0x0,0x0,0x0
.long 0x0,0x0,0x0,0x0,0x0,0x0,0x0,0x0
.long 0x3f733e9e,0x3f73be9e,0x3f16bf4f,0xbf80,0x0,0x0,0x0,0x0
.long 0x0,0x0,0x0,0x0,0x0,0x0,0x0,0x0
.long 0xbf16bf4f,0xbf4fbf16,0xbf73be9e,0xbf800000,0x0,0x0,0x0,0x0
.long 0x0,0x0,0x0,0x0,0x0,0x0,0x0,0x0
.long 0x0,0x0,0x0,0x0,0x3f80,0x3f733e9e,0x3f16bf4f,0xbf16bf4f
.long 0x0,0x0,0x0,0x0,0x0,0x0,0x0,0x0
.long 0x0,0x0,0x0,0x0,0x3f80,0x3f4f3f16,0x3f73be9e,0x3e9ebf73
.long 0x0,0x0,0x0,0x0,0x0,0x0,0x0,0x0
.long 0x0,0x0,0x0,0x0,0x3f80,0x3f163f4f,0x3f733e9e,0x3f73be9e
.long 0x0,0x0,0x0,0x0,0x0,0x0,0x0,0x0
.long 0x0,0x0,0x0,0x0,0x3f80,0x3e9e3f73,0x3f163f4f,0x3f4f3f16
.long 0x0,0x0,0x0,0x0,0x0,0x0,0x0,0x0
.long 0x0,0x0,0x0,0x0,0xbf733e9e,0x3f80,0x3f733e9e,0x3f16bf4f
.long 0x0,0x0,0x0,0x0,0x0,0x0,0x0,0x0
.long 0x0,0x0,0x0,0x0,0xbf16bf4f,0xbf800000,0xbf163f4f,0x3e9e3f73
.long 0x0,0x0,0x0,0x0,0x0,0x0,0x0,0x0
.long 0x0,0x0,0x0,0x0,0x3f16bf4f,0xbf80,0xbf16bf4f,0xbf73be9e
.long 0x0,0x0,0x0,0x0,0x0,0x0,0x0,0x0
.long 0x0,0x0,0x0,0x0,0x3f733e9e,0x3f800000,0x3f73be9e,0x3f4fbf16
.long 0x0,0x0,0x0,0x0,0x0,0x0,0x0,0x0
.long 0x0,0x0,0x0,0x0,0xbf16bf4f,0xbf733e9e,0x3f80,0x3f733e9e
.long 0x0,0x0,0x0,0x0,0x0,0x0,0x0,0x0
.long 0x0,0x0,0x0,0x0,0x3f733e9e,0x3f4fbf16,0xbf80,0xbf4fbf16
.long 0x0,0x0,0x0,0x0,0x0,0x0,0x0,0x0
.long 0x0,0x0,0x0,0x0,0xbf733e9e,0xbf163f4f,0x3f80,0x3f163f4f
.long 0x0,0x0,0x0,0x0,0x0,0x0,0x0,0x0
.long 0x0,0x0,0x0,0x0,0x3f16bf4f,0x3e9ebf73,0xbf80,0xbe9ebf73
.long 0x0,0x0,0x0,0x0,0x0,0x0,0x0,0x0
.long 0x0,0x0,0x0,0x0,0x3f16bf4f,0xbf16bf4f,0xbf733e9e,0x3f80
.long 0x0,0x0,0x0,0x0,0x0,0x0,0x0,0x0
.long 0x0,0x0,0x0,0x0,0xbf733e9e,0xbe9e3f73,0x3f163f4f,0x3f800000
.long 0x0,0x0,0x0,0x0,0x0,0x0,0x0,0x0
.long 0x0,0x0,0x0,0x0,0x3f733e9e,0x3f73be9e,0x3f16bf4f,0xbf80
.long 0x0,0x0,0x0,0x0,0x0,0x0,0x0,0x0
.long 0x0,0x0,0x0,0x0,0xbf16bf4f,0xbf4fbf16,0xbf73be9e,0xbf800000
.long 0x0,0x0,0x0,0x0,0x0,0x0,0x0,0x0
.fill 256, 4, 0
L_tabend:
.size L_tab, L_tabend-L_tab
.section .rodata,"a"
.p2align 6
.amdhsa_kernel adaLN_cond__spectral_gfnet__mixer_channel_mlp__prompt_kernel
  .amdhsa_next_free_vgpr 512
  .amdhsa_next_free_sgpr 102
  .amdhsa_accum_offset 256
  .amdhsa_group_segment_fixed_size 0
  .amdhsa_kernarg_size 104
  .amdhsa_user_sgpr_count 2
  .amdhsa_user_sgpr_kernarg_segment_ptr 1
  .amdhsa_system_sgpr_workgroup_id_x 1
  .amdhsa_float_denorm_mode_32 3
.end_amdhsa_kernel
```
